```python
import torch

def _softmax(x, axis=-1):
    return torch.softmax(x, dim=axis)
def _gelu(x):
    return torch.nn.functional.gelu(x, approximate="tanh")
def _silu(x):
    return torch.nn.functional.silu(x)
def _sigmoid(x):
    return torch.sigmoid(x)
def _layernorm(x, axis=-1, eps=1e-5):
    m = x.mean(dim=axis, keepdim=True)
    v = x.var(dim=axis, keepdim=True, unbiased=False)
    return (x - m) / torch.sqrt(v + eps)
def _scatter_add(tgt, idx, src, axis=0):
    return tgt.clone().index_add_(axis, idx, src)
def _segment_sum(src, seg, n):
    out = torch.zeros((n,) + src.shape[1:], dtype=src.dtype)
    return out.index_add_(0, seg, src)
def _pad(x, pw):
    flat = tuple(v for pair in reversed(pw) for v in pair)
    return torch.nn.functional.pad(x, flat)

kernel_name = 'interleave_layers__ssm_conv_h3__geglu_ffn__prompt'

def setup_inputs():

    _w = (lambda a: (lambda t: t.to(torch.bfloat16) if t.is_floating_point() else t)(torch.as_tensor(a)))
    def _A_setup():
        B, S, D = 1, 2048, 576
        ks = 4
        return {
            "q": _w((lambda *s: torch.randn(*s, dtype=torch.bfloat16) * 0.05)(B, S, D)),
            "k": _w((lambda *s: torch.randn(*s, dtype=torch.bfloat16) * 0.8)(B, S, D)),
            "v": _w((lambda *s: torch.randn(*s, dtype=torch.bfloat16) * 0.8)(B, S, D)),
            "shift_k": _w((lambda *s: torch.randn(*s, dtype=torch.bfloat16) * 0.8)(D, ks) * 0.5),
            "ssm_k": _w((lambda *s: torch.randn(*s, dtype=torch.bfloat16) * 0.8)(D, S) * (1.0 / S ** 0.5)),
            "ssm_D": _w((lambda *s: torch.randn(*s, dtype=torch.bfloat16) * 0.8)(D)),
        }
    _A_in = _A_setup()

    def _B_setup():
        B, S, D, F = 1, 2048, 576, 4608
        return {
            "x": _w((lambda *s: torch.randn(*s, dtype=torch.bfloat16) * 0.05)(B, S, D)),
            "w_gate": _w((lambda *s: torch.randn(*s, dtype=torch.bfloat16) * 0.05)(D, F)),
            "w_up": _w((lambda *s: torch.randn(*s, dtype=torch.bfloat16) * 0.05)(D, F)),
            "w_down": _w((lambda *s: torch.randn(*s, dtype=torch.bfloat16) * 0.05)(F, D)),
        }
    _B_in = _B_setup()

    return {
        "A_q": _A_in["q"],
        "A_k": _A_in["k"],
        "A_v": _A_in["v"],
        "A_shift_k": _A_in["shift_k"],
        "A_ssm_k": _A_in["ssm_k"],
        "A_ssm_D": _A_in["ssm_D"],
        "B_x": _B_in["x"],
        "B_w_gate": _B_in["w_gate"],
        "B_w_up": _B_in["w_up"],
        "B_w_down": _B_in["w_down"],
    }

def reference(A_q, A_k, A_v, A_shift_k, A_ssm_k, A_ssm_D, B_x, B_w_gate, B_w_up, B_w_down):
    def _A_ref(q, k, v, shift_k, ssm_k, ssm_D):
        B, S, D = q.shape
        ks = shift_k.shape[-1]
        k_pad = _pad(k, ((0, 0), (ks - 1, 0), (0, 0)))
        k_shift = torch.zeros_like(k)
        for t in range(ks):
            k_shift = k_shift + k_pad[:, t:t + S, :] * shift_k[:, ks - 1 - t][None, None, :]
        kv = k_shift * v
        L = 2 * S
        kv_pad = _pad(kv, ((0, 0), (0, S), (0, 0)))
        kf_pad = _pad(ssm_k, ((0, 0), (0, S)))
        kv_f = (lambda x, axes=(-2,-1): torch.fft.rfft2(x.float(), dim=axes))(kv_pad[:, None, :, :], axes=(1, 2))
        kf_f = (lambda x, axes=(-2,-1): torch.fft.rfft2(x.float(), dim=axes))(kf_pad[:, None, :], axes=(1, 2))
        kf_f = (lambda x, *d: x.permute(*d))(kf_f, 1, 2, 0)
        y_f = kv_f * kf_f[None, :, :, :]
        y = (lambda x, s, axes=(-2,-1): torch.fft.irfft2(x, s=s, dim=axes).to(torch.bfloat16))(y_f, (1, L), axes=(1, 2))[:, 0, :S, :]
        y = y + kv * ssm_D[None, None, :]
        return q * y

    def _B_ref(x, w_gate, w_up, w_down):
        return (_gelu(x @ w_gate) * (x @ w_up)) @ w_down

    x = A_q
    x = x + _A_ref(_layernorm(x, axis=-1), A_k, A_v, A_shift_k, A_ssm_k, A_ssm_D)
    x = x + _B_ref(_layernorm(x, axis=-1), B_w_gate, B_w_up, B_w_down)
    x = x + _A_ref(_layernorm(x, axis=-1), A_k, A_v, A_shift_k, A_ssm_k, A_ssm_D)
    x = x + _B_ref(_layernorm(x, axis=-1), B_w_gate, B_w_up, B_w_down)
    return x
```

```asm
; @launch grid=(256,1,1) block=(512,1,1) lds=161856
.amdgcn_target "amdgcn-amd-amdhsa--gfx950"
.text
.globl interleave_layers__ssm_conv_h3__geglu_ffn__prompt_kernel
.p2align 8
.type interleave_layers__ssm_conv_h3__geglu_ffn__prompt_kernel,@function
interleave_layers__ssm_conv_h3__geglu_ffn__prompt_kernel:
  s_load_dwordx8 s[12:19], s[0:1], 8
  s_getpc_b64 s[36:37]
fr_pc:
  s_lshr_b32 s38, s2, 3
  s_lshl_b32 s38, s38, 13
  v_lshlrev_b32 v240, 4, v0
  v_add_u32 v240, s38, v240
  v_min_u32 v240, per_end-fr_pc-16, v240
  global_load_dwordx4 v[244:247], v240, s[36:37]
  s_cmp_ge_u32 s2, 144
  s_cbranch_scc1 fr_rl
  s_load_dwordx2 s[24:25], s[0:1], 40
  s_load_dwordx4 s[44:47], s[0:1], 88
  v_lshrrev_b32 v1, 6, v0
  v_and_b32 v2, 63, v0
  v_readfirstlane_b32 s3, v1
  s_mul_i32 s33, s2, 7282
  s_lshr_b32 s33, s33, 16
  s_mul_i32 s34, s33, 9
  s_sub_u32 s34, s2, s34
  s_mul_i32 s6, s33, 147456
  s_lshl_b32 s7, s34, 7
  s_add_u32 s6, s6, s7
  v_lshrrev_b32 v6, 3, v0
  v_and_b32 v10, 7, v0
  v_mul_u32_u24 v6, 1152, v6
  v_lshl_add_u32 v6, v10, 4, v6
  v_add_u32 v6, s6, v6
  s_lshl_b32 s5, s3, 10
  s_mov_b32 s4, 73728
  s_mov_b32 s30, 2359296
  s_mov_b32 s31, 131072
  s_add_u32 m0, s5, 1024
  s_waitcnt lgkmcnt(0)
  s_mov_b32 s28, s14
  s_mov_b32 s29, s15
  s_mov_b32 s14, 2359296
  s_mov_b32 s15, 131072
  buffer_load_dwordx4 v6, s[12:15], 0 offen nt lds
  s_add_u32 m0, s5, 9216
  s_nop 0
  buffer_load_dwordx4 v6, s[12:15], s4 offen nt lds
  s_add_u32 m0, s5, 17408
  s_nop 0
  buffer_load_dwordx4 v6, s[28:31], 0 offen nt lds
  s_add_u32 m0, s5, 25600
  s_nop 0
  buffer_load_dwordx4 v6, s[28:31], s4 offen nt lds
  s_cmp_gt_u32 s3, 1
  s_cbranch_scc1 fr_nx
  s_cmp_eq_u32 s3, 0
  s_cbranch_scc0 fr_w1
  v_subrev_u32 v7, 9216, v6
  s_mov_b32 m0, 0
  s_nop 0
  buffer_load_dwordx4 v7, s[12:15], 0 offen nt lds
  s_branch fr_nx
fr_w1:
  s_lshl_b32 s7, s34, 9
  s_mov_b32 s40, s16
  s_mov_b32 s41, s17
  s_mov_b32 s42, 4608
  s_mov_b32 s43, 131072
  v_lshlrev_b32 v7, 4, v2
  v_add_u32 v7, s7, v7
  s_mov_b32 m0, 33792
  s_nop 0
  buffer_load_dwordx4 v7, s[40:43], 0 offen lds
fr_nx:
  v_lshlrev_b32 v3, 4, v2
  v_mov_b32 v14, 0
  v_mov_b32 v15, 0
  v_mov_b32 v13, 161824
  ds_write_b64 v13, v[14:15]
  s_barrier
  s_cmp_ge_u32 s3, 4
  s_cbranch_scc1 fr_nh
  s_lshl_b32 s4, s2, 2
  s_add_u32 s4, s4, s3
  s_lshl_b32 s6, s4, 12
  s_add_u32 s20, s18, s6
  s_addc_u32 s21, s19, 0
  s_mov_b32 s22, 4096
  s_mov_b32 s23, 131072
  s_mov_b32 s26, 1152
  s_mov_b32 s27, 131072
  v_add_u32 v11, 16, v3
  s_lshl_b32 s7, s4, 1
  v_mov_b32 v12, s7
  buffer_load_dwordx4 v[64:67], v3, s[20:23], 0 offen offset:0 nt
  buffer_load_dwordx4 v[72:75], v3, s[20:23], 0 offen offset:1024 nt
  buffer_load_dwordx4 v[80:83], v3, s[20:23], 0 offen offset:2048 nt
  buffer_load_dwordx4 v[88:91], v3, s[20:23], 0 offen offset:3072 nt
  buffer_load_dword v68, v11, s[20:23], 0 offen offset:0 nt
  buffer_load_dword v76, v11, s[20:23], 0 offen offset:1024 nt
  buffer_load_dword v84, v11, s[20:23], 0 offen offset:2048 nt
  buffer_load_dword v92, v11, s[20:23], 0 offen offset:3072 nt
  buffer_load_ushort v8, v12, s[24:27], 0 offen
  s_branch fr_nh2
fr_nh:
  s_mov_b32 s8, s46
  s_mov_b32 s9, s47
  s_mov_b32 s10, 268435456
  s_mov_b32 s11, 131072
  s_sub_u32 s7, s3, 5
  s_mul_i32 s7, s7, 144
  s_add_u32 s7, s7, s2
  s_cmp_ge_u32 s3, 6
  s_cselect_b32 s6, 112, 0
  s_add_u32 s7, s7, s6
  s_min_u32 s7, s7, 511
  s_lshl_b32 s7, s7, 7
  s_add_u32 s7, s7, 70123520
  v_mov_b32 v12, 0
  s_cmp_eq_u32 s3, 5
  s_cbranch_scc0 fr_t0
  s_lshl_b32 s7, s2, 7
  s_add_u32 s7, s7, 7077888
  v_and_b32 v12, 3, v0
  v_mul_u32_u24 v12, 18432, v12
  v_mov_b32 v13, 63045632
  v_cmp_eq_u32 vcc, 63, v2
  s_nop 1
  v_cndmask_b32 v12, v12, v13, vcc
fr_t0:
  s_cmp_eq_u32 s3, 4
  s_cbranch_scc0 fr_t1
  s_lshr_b32 s7, s2, 4
  s_lshl_b32 s7, s7, 7
  s_add_u32 s7, s7, 70189056
  v_and_b32 v12, 15, v0
  v_mul_u32_u24 v12, 1152, v12
fr_t1:
  buffer_load_dword v59, v12, s[8:11], s7 offen sc1
fr_nh2:
  v_lshrrev_b32 v1, 4, v0
  v_and_b32 v4, 15, v0
  s_mov_b32 s8, s46
  s_mov_b32 s9, s47
  s_mov_b32 s46, 256
  s_mov_b32 s47, 131072
  s_mov_b32 s10, 268435456
  s_mov_b32 s11, 131072
  v_lshlrev_b32 v6, 9, v1
  v_lshl_add_u32 v6, v4, 3, v6
  v_lshlrev_b32 v10, 5, v4
  v_lshrrev_b32 v18, 1, v1
  v_sub_u32 v18, 15, v18
  v_xor_b32 v18, v18, v4
  v_lshlrev_b32 v18, 4, v18
  v_lshl_add_u32 v18, v4, 10, v18
  v_and_b32 v11, 1, v1
  v_lshlrev_b32 v11, 3, v11
  v_sub_u32 v18, v18, v11
  v_add_u32 v18, 89352, v18
  v_xor_b32 v19, s3, v4
  v_lshlrev_b32 v19, 4, v19
  v_lshl_add_u32 v19, v1, 8, v19
  v_xor_b32 v20, 128, v19
  v_add_u32 v19, 89344, v19
  v_add_u32 v20, 97536, v20
  v_lshlrev_b32 v23, 12, v1
  v_lshl_add_u32 v23, v4, 4, v23
  s_lshl_b32 s35, s34, 18
  s_lshl_b32 s7, s33, 8
  s_sub_u32 s35, s35, s7
  s_add_u32 s35, s35, 3840
  s_add_u32 s36, s35, 131072
  s_mov_b32 s38, 84148480
  s_mov_b32 s39, 117834498
  v_mov_b32 v58, 0
  s_and_b32 s43, s3, 6
  s_cmp_ge_u32 s3, 4
  s_cbranch_scc1 fr_w0
  s_waitcnt vmcnt(9)
  s_branch fr_w9
fr_w0:
  s_waitcnt vmcnt(1)
fr_w9:
  s_barrier
  s_cmp_eq_u32 s43, 4
  s_cbranch_scc0 fr_nt
  buffer_load_dwordx2 v[60:61], v58, s[44:47], 0 offen sc1
fr_nt:
  ds_read_b64 v[100:101], v6 offset:640
  ds_read_b64 v[102:103], v6 offset:768
  ds_read_b64 v[104:105], v6 offset:896
  ds_read_b64 v[106:107], v6 offset:1024
  ds_read_b64 v[108:109], v6 offset:1152
  ds_read_b64 v[110:111], v6 offset:1280
  ds_read_b64 v[112:113], v6 offset:1408
  ds_read_b128 v[124:127], v10 offset:33792
  ds_read_b128 v[128:131], v10 offset:33808
  ds_read_b64 v[116:117], v6 offset:17408
  ds_read_b64 v[118:119], v6 offset:17536
  ds_read_b64 v[120:121], v6 offset:17664
  ds_read_b64 v[122:123], v6 offset:17792
  s_waitcnt lgkmcnt(11)
  v_perm_b32 v133, v100, v102, s38
  s_waitcnt lgkmcnt(10)
  v_perm_b32 v134, v102, v104, s38
  s_waitcnt lgkmcnt(9)
  v_perm_b32 v135, v104, v106, s38
  s_waitcnt lgkmcnt(8)
  v_perm_b32 v136, v106, v108, s38
  s_waitcnt lgkmcnt(7)
  v_perm_b32 v137, v108, v110, s38
  s_waitcnt lgkmcnt(6)
  v_perm_b32 v138, v110, v112, s38
  s_waitcnt lgkmcnt(5)
  v_dot2_f32_bf16 v148, v133, v125, 0
  v_dot2_f32_bf16 v149, v134, v125, 0
  v_dot2_f32_bf16 v150, v135, v125, 0
  v_dot2_f32_bf16 v151, v136, v125, 0
  s_waitcnt lgkmcnt(3)
  v_lshlrev_b32 v152, 16, v116
  s_waitcnt lgkmcnt(2)
  v_lshlrev_b32 v153, 16, v118
  s_waitcnt lgkmcnt(1)
  v_lshlrev_b32 v154, 16, v120
  s_waitcnt lgkmcnt(0)
  v_lshlrev_b32 v155, 16, v122
  v_dot2_f32_bf16 v148, v135, v124, v148
  v_dot2_f32_bf16 v149, v136, v124, v149
  v_dot2_f32_bf16 v150, v137, v124, v150
  v_dot2_f32_bf16 v151, v138, v124, v151
  v_mul_f32 v148, v148, v152
  v_mul_f32 v149, v149, v153
  v_mul_f32 v150, v150, v154
  v_mul_f32 v151, v151, v155
  v_cvt_pk_bf16_f32 v164, v151, v150
  v_cvt_pk_bf16_f32 v165, v149, v148
  v_perm_b32 v141, v100, v102, s39
  v_perm_b32 v142, v102, v104, s39
  v_perm_b32 v143, v104, v106, s39
  v_perm_b32 v144, v106, v108, s39
  v_perm_b32 v145, v108, v110, s39
  v_perm_b32 v146, v110, v112, s39
  v_dot2_f32_bf16 v156, v141, v127, 0
  v_dot2_f32_bf16 v157, v142, v127, 0
  v_dot2_f32_bf16 v158, v143, v127, 0
  v_dot2_f32_bf16 v159, v144, v127, 0
  v_and_b32 v160, 4294901760, v116
  v_and_b32 v161, 4294901760, v118
  v_and_b32 v162, 4294901760, v120
  v_and_b32 v163, 4294901760, v122
  v_dot2_f32_bf16 v156, v143, v126, v156
  v_dot2_f32_bf16 v157, v144, v126, v157
  v_dot2_f32_bf16 v158, v145, v126, v158
  v_dot2_f32_bf16 v159, v146, v126, v159
  ds_write_b64 v18, v[164:165] offset:0
  v_mul_f32 v156, v156, v160
  v_mul_f32 v157, v157, v161
  v_mul_f32 v158, v158, v162
  v_mul_f32 v159, v159, v163
  v_cvt_pk_bf16_f32 v166, v159, v158
  v_cvt_pk_bf16_f32 v167, v157, v156
  v_perm_b32 v133, v101, v103, s38
  v_perm_b32 v134, v103, v105, s38
  v_perm_b32 v135, v105, v107, s38
  v_perm_b32 v136, v107, v109, s38
  v_perm_b32 v137, v109, v111, s38
  v_perm_b32 v138, v111, v113, s38
  v_dot2_f32_bf16 v148, v133, v129, 0
  v_dot2_f32_bf16 v149, v134, v129, 0
  v_dot2_f32_bf16 v150, v135, v129, 0
  v_dot2_f32_bf16 v151, v136, v129, 0
  v_lshlrev_b32 v152, 16, v117
  v_lshlrev_b32 v153, 16, v119
  v_lshlrev_b32 v154, 16, v121
  v_lshlrev_b32 v155, 16, v123
  v_dot2_f32_bf16 v148, v135, v128, v148
  v_dot2_f32_bf16 v149, v136, v128, v149
  v_dot2_f32_bf16 v150, v137, v128, v150
  v_dot2_f32_bf16 v151, v138, v128, v151
  ds_write_b64 v18, v[166:167] offset:256
  v_mul_f32 v148, v148, v152
  v_mul_f32 v149, v149, v153
  v_mul_f32 v150, v150, v154
  v_mul_f32 v151, v151, v155
  v_cvt_pk_bf16_f32 v168, v151, v150
  v_cvt_pk_bf16_f32 v169, v149, v148
  v_perm_b32 v141, v101, v103, s39
  v_perm_b32 v142, v103, v105, s39
  v_perm_b32 v143, v105, v107, s39
  v_perm_b32 v144, v107, v109, s39
  v_perm_b32 v145, v109, v111, s39
  v_perm_b32 v146, v111, v113, s39
  v_dot2_f32_bf16 v156, v141, v131, 0
  v_dot2_f32_bf16 v157, v142, v131, 0
  v_dot2_f32_bf16 v158, v143, v131, 0
  v_dot2_f32_bf16 v159, v144, v131, 0
  v_and_b32 v160, 4294901760, v117
  v_and_b32 v161, 4294901760, v119
  v_and_b32 v162, 4294901760, v121
  v_and_b32 v163, 4294901760, v123
  v_dot2_f32_bf16 v156, v143, v130, v156
  v_dot2_f32_bf16 v157, v144, v130, v157
  v_dot2_f32_bf16 v158, v145, v130, v158
  v_dot2_f32_bf16 v159, v146, v130, v159
  ds_write_b64 v18, v[168:169] offset:512
  v_mul_f32 v156, v156, v160
  v_mul_f32 v157, v157, v161
  v_mul_f32 v158, v158, v162
  v_mul_f32 v159, v159, v163
  v_cvt_pk_bf16_f32 v170, v159, v158
  v_cvt_pk_bf16_f32 v171, v157, v156
  ds_write_b64 v18, v[170:171] offset:768
  s_waitcnt lgkmcnt(0)
  s_barrier
  ds_read_b128 v[100:103], v19
  ds_read_b128 v[104:107], v20
  s_waitcnt lgkmcnt(1)
  buffer_store_dwordx4 v[100:103], v23, s[8:11], s35 offen sc1
  s_waitcnt lgkmcnt(0)
  buffer_store_dwordx4 v[104:107], v23, s[8:11], s36 offen sc1
  s_cmp_lt_u32 s3, 4
  s_cbranch_scc1 fr_cv
  s_load_dwordx4 s[12:15], s[0:1], 56
  s_load_dwordx2 s[20:21], s[0:1], 72
  s_lshl_b32 s7, s2, 7
  v_mov_b32 v56, s7
  s_lshr_b32 s7, s2, 4
  s_lshl_b32 s7, s7, 7
  v_mul_u32_u24 v57, 1152, v4
  v_add_u32 v57, s7, v57
  s_mov_b32 s42, 70189056
  s_waitcnt vmcnt(0)
  s_cmp_eq_u32 s43, 4
  s_cbranch_scc0 fr_tge
  s_mov_b32 s43, 0x40000
fr_tg:
  v_cmp_eq_u32 vcc, 0, v61
  s_cbranch_vccz fr_tgw
  buffer_load_dwordx2 v[60:61], v58, s[44:47], 0 offen sc1
  s_waitcnt vmcnt(0)
  s_sub_u32 s43, s43, 1
  s_cbranch_scc0 fr_tg
fr_tgw:
  v_mov_b32 v62, 161832
  ds_write_b64 v62, v[60:61]
  s_waitcnt lgkmcnt(0)
fr_tge:
  s_barrier
  s_cmp_lg_u32 s3, 4
  s_cbranch_scc1 fr_nf
  s_mov_b64 exec, 1
  buffer_store_dwordx2 v[60:61], v56, s[8:11], s42 offen sc1
  s_mov_b64 exec, -1
fr_nf:
  s_cmp_lg_u32 s3, 5
  s_cbranch_scc1 fr_np
  s_mov_b64 exec, 0xffff
  s_mov_b32 s43, 0x40000
fr_poll:
  buffer_load_dwordx2 v[62:63], v57, s[8:11], s42 offen sc1
  s_waitcnt vmcnt(0)
  v_cmp_ne_u64 vcc, v[60:61], v[62:63]
  s_cbranch_vccz fr_pe
  s_sleep 1
  s_sub_u32 s43, s43, 1
  s_cbranch_scc0 fr_poll
fr_pe:
  s_mov_b64 exec, -1
  s_barrier
fr_np:
  s_sub_u32 s6, s3, 4
  s_mul_i32 s37, s6, 9216
  s_add_u32 s37, s37, 105984
  s_mul_i32 s6, s6, 18
  s_lshr_b32 s7, s2, 3
  s_add_u32 s6, s6, s7
  v_and_b32 v217, 63, v0
  v_lshlrev_b32 v216, 4, v217
  v_lshrrev_b32 v218, 3, v217
  v_and_b32 v219, 7, v217
  v_lshrrev_b32 v220, 4, v217
  v_bfe_u32 v221, v217, 2, 2
  v_lshl_add_u32 v220, v220, 3, v221
  v_and_b32 v221, 3, v217
  v_mul_u32_u24 v208, 1152, v218
  v_lshl_add_u32 v208, v219, 4, v208
  v_mul_u32_u24 v211, 144, v218
  v_lshl_add_u32 v211, v219, 4, v211
  v_add_u32 v211, s37, v211
  v_mul_u32_u24 v212, 144, v220
  v_lshl_add_u32 v212, v221, 4, v212
  v_add_u32 v212, s37, v212
  s_and_b32 s24, s2, 7
  s_mul_i32 s24, s24, 9
  s_add_u32 s27, s6, 0
  s_mul_i32 s25, s27, 7282
  s_lshr_b32 s25, s25, 16
  s_mul_i32 s26, s25, 9
  s_sub_u32 s26, s27, s26
  s_add_u32 s25, s25, s24
  s_mul_i32 s48, s25, 73728
  s_lshl_b32 s27, s26, 7
  s_add_u32 s48, s48, s27
  s_mul_i32 s27, s25, 18
  s_add_u32 s27, s27, s26
  s_lshl_b32 s27, s27, 12
  s_add_u32 s49, s27, 23199744
  s_add_u32 s27, s6, 72
  s_mul_i32 s25, s27, 7282
  s_lshr_b32 s25, s25, 16
  s_mul_i32 s26, s25, 9
  s_sub_u32 s26, s27, s26
  s_add_u32 s25, s25, s24
  s_mul_i32 s50, s25, 73728
  s_lshl_b32 s27, s26, 7
  s_add_u32 s50, s50, s27
  s_mul_i32 s27, s25, 18
  s_add_u32 s27, s27, s26
  s_lshl_b32 s27, s27, 12
  s_add_u32 s51, s27, 23199744
  s_waitcnt lgkmcnt(0)
  s_mov_b32 s16, s14
  s_mov_b32 s17, s15
  s_mov_b32 s18, 5308416
  s_mov_b32 s19, 131072
  s_mov_b32 s14, 5308416
  s_mov_b32 s15, 131072
  s_mov_b32 s22, 5308416
  s_mov_b32 s23, 131072
  s_cmp_eq_u32 s3, 5
  s_cbranch_scc1 fr_pd
  s_barrier
fr_pd:
  s_cmp_ge_u32 s6, 9
  s_cbranch_scc1 fr_h_v1
  s_add_u32 s28, s48, 0
  buffer_load_dwordx4 v[16:19], v208, s[20:23], s28 offen nt
  s_add_u32 s29, s48, 9216
  buffer_load_dwordx4 v[20:23], v208, s[20:23], s29 offen nt
  s_add_u32 s28, s48, 18432
  buffer_load_dwordx4 v[24:27], v208, s[20:23], s28 offen nt
  s_add_u32 s29, s48, 27648
  buffer_load_dwordx4 v[28:31], v208, s[20:23], s29 offen nt
  s_add_u32 s28, s48, 36864
  buffer_load_dwordx4 v[32:35], v208, s[20:23], s28 offen nt
  s_add_u32 s29, s48, 46080
  buffer_load_dwordx4 v[36:39], v208, s[20:23], s29 offen nt
  s_add_u32 s28, s48, 55296
  buffer_load_dwordx4 v[40:43], v208, s[20:23], s28 offen nt
  s_add_u32 s29, s48, 64512
  buffer_load_dwordx4 v[44:47], v208, s[20:23], s29 offen nt
  s_add_u32 s28, s50, 0
  buffer_load_dwordx4 v[48:51], v208, s[20:23], s28 offen nt
  s_add_u32 s29, s50, 9216
  buffer_load_dwordx4 v[52:55], v208, s[20:23], s29 offen nt
  s_add_u32 s28, s50, 18432
  buffer_load_dwordx4 v[56:59], v208, s[20:23], s28 offen nt
  s_add_u32 s29, s50, 27648
  buffer_load_dwordx4 v[60:63], v208, s[20:23], s29 offen nt
  s_add_u32 s28, s50, 36864
  buffer_load_dwordx4 v[64:67], v208, s[20:23], s28 offen nt
  s_add_u32 s29, s50, 46080
  buffer_load_dwordx4 v[68:71], v208, s[20:23], s29 offen nt
  s_add_u32 s28, s50, 55296
  buffer_load_dwordx4 v[72:75], v208, s[20:23], s28 offen nt
  s_add_u32 s29, s50, 64512
  buffer_load_dwordx4 v[76:79], v208, s[20:23], s29 offen nt
  s_load_dwordx2 s[32:33], s[0:1], 0
  s_and_b32 s24, s2, 240
  s_and_b32 s25, s2, 7
  s_lshl_b32 s25, s25, 1
  s_add_u32 s24, s24, s25
  s_bfe_u32 s25, s2, 65539
  s_add_u32 s24, s24, s25
  s_mul_i32 s24, s24, 9216
  s_and_b32 s25, s3, 3
  s_mul_i32 s25, s25, 2304
  s_add_u32 s24, s24, s25
  v_add_u32 v220, s24, v216
  s_mov_b32 s34, 2359296
  s_mov_b32 s35, 131072
  s_waitcnt lgkmcnt(0)
  buffer_load_dwordx4 v[224:227], v220, s[32:35], 0 offen offset:0
  buffer_load_dwordx4 v[228:231], v220, s[32:35], 0 offen offset:1024
  buffer_load_dwordx4 v[232:235], v220, s[32:35], 0 offen offset:1280
  s_waitcnt vmcnt(18)
  ds_write_b128 v211, v[16:19] offset:0
  s_waitcnt vmcnt(17)
  ds_write_b128 v211, v[20:23] offset:1152
  s_waitcnt vmcnt(16)
  ds_write_b128 v211, v[24:27] offset:2304
  s_waitcnt vmcnt(15)
  ds_write_b128 v211, v[28:31] offset:3456
  s_waitcnt vmcnt(14)
  ds_write_b128 v211, v[32:35] offset:4608
  s_waitcnt vmcnt(13)
  ds_write_b128 v211, v[36:39] offset:5760
  s_waitcnt vmcnt(12)
  ds_write_b128 v211, v[40:43] offset:6912
  s_waitcnt vmcnt(11)
  ds_write_b128 v211, v[44:47] offset:8064
  ds_read_b64_tr_b16 v[16:17], v212 offset:0
  ds_read_b64_tr_b16 v[18:19], v212 offset:576
  ds_read_b64_tr_b16 v[20:21], v212 offset:8
  ds_read_b64_tr_b16 v[22:23], v212 offset:584
  ds_read_b64_tr_b16 v[24:25], v212 offset:64
  ds_read_b64_tr_b16 v[26:27], v212 offset:640
  ds_read_b64_tr_b16 v[28:29], v212 offset:72
  ds_read_b64_tr_b16 v[30:31], v212 offset:648
  ds_read_b64_tr_b16 v[32:33], v212 offset:4608
  ds_read_b64_tr_b16 v[34:35], v212 offset:5184
  ds_read_b64_tr_b16 v[36:37], v212 offset:4616
  ds_read_b64_tr_b16 v[38:39], v212 offset:5192
  ds_read_b64_tr_b16 v[40:41], v212 offset:4672
  ds_read_b64_tr_b16 v[42:43], v212 offset:5248
  ds_read_b64_tr_b16 v[44:45], v212 offset:4680
  ds_read_b64_tr_b16 v[46:47], v212 offset:5256
  s_mov_b32 s37, s49
  s_waitcnt vmcnt(10)
  ds_write_b128 v211, v[48:51] offset:0
  s_waitcnt vmcnt(9)
  ds_write_b128 v211, v[52:55] offset:1152
  s_waitcnt vmcnt(8)
  ds_write_b128 v211, v[56:59] offset:2304
  s_waitcnt vmcnt(7)
  ds_write_b128 v211, v[60:63] offset:3456
  s_waitcnt vmcnt(6)
  ds_write_b128 v211, v[64:67] offset:4608
  s_waitcnt vmcnt(5)
  ds_write_b128 v211, v[68:71] offset:5760
  s_waitcnt vmcnt(4)
  ds_write_b128 v211, v[72:75] offset:6912
  s_waitcnt vmcnt(3)
  ds_write_b128 v211, v[76:79] offset:8064
  ds_read_b64_tr_b16 v[48:49], v212 offset:0
  ds_read_b64_tr_b16 v[50:51], v212 offset:576
  ds_read_b64_tr_b16 v[52:53], v212 offset:8
  ds_read_b64_tr_b16 v[54:55], v212 offset:584
  ds_read_b64_tr_b16 v[56:57], v212 offset:64
  ds_read_b64_tr_b16 v[58:59], v212 offset:640
  ds_read_b64_tr_b16 v[60:61], v212 offset:72
  ds_read_b64_tr_b16 v[62:63], v212 offset:648
  ds_read_b64_tr_b16 v[64:65], v212 offset:4608
  ds_read_b64_tr_b16 v[66:67], v212 offset:5184
  ds_read_b64_tr_b16 v[68:69], v212 offset:4616
  ds_read_b64_tr_b16 v[70:71], v212 offset:5192
  ds_read_b64_tr_b16 v[72:73], v212 offset:4672
  ds_read_b64_tr_b16 v[74:75], v212 offset:5248
  ds_read_b64_tr_b16 v[76:77], v212 offset:4680
  ds_read_b64_tr_b16 v[78:79], v212 offset:5256
  s_mov_b32 s38, s51
  s_waitcnt vmcnt(0)
  s_mov_b32 s39, 2
  s_waitcnt lgkmcnt(0)
  s_branch per_entry
fr_h_v1:
  s_add_u32 s28, s48, 0
  buffer_load_dwordx4 v[16:19], v208, s[20:23], s28 offen nt
  s_add_u32 s29, s48, 9216
  buffer_load_dwordx4 v[20:23], v208, s[20:23], s29 offen nt
  s_add_u32 s28, s48, 18432
  buffer_load_dwordx4 v[24:27], v208, s[20:23], s28 offen nt
  s_add_u32 s29, s48, 27648
  buffer_load_dwordx4 v[28:31], v208, s[20:23], s29 offen nt
  s_add_u32 s28, s48, 36864
  buffer_load_dwordx4 v[32:35], v208, s[20:23], s28 offen nt
  s_add_u32 s29, s48, 46080
  buffer_load_dwordx4 v[36:39], v208, s[20:23], s29 offen nt
  s_add_u32 s28, s48, 55296
  buffer_load_dwordx4 v[40:43], v208, s[20:23], s28 offen nt
  s_add_u32 s29, s48, 64512
  buffer_load_dwordx4 v[44:47], v208, s[20:23], s29 offen nt
  s_load_dwordx2 s[32:33], s[0:1], 0
  s_and_b32 s24, s2, 240
  s_and_b32 s25, s2, 7
  s_lshl_b32 s25, s25, 1
  s_add_u32 s24, s24, s25
  s_bfe_u32 s25, s2, 65539
  s_add_u32 s24, s24, s25
  s_mul_i32 s24, s24, 9216
  s_and_b32 s25, s3, 3
  s_mul_i32 s25, s25, 2304
  s_add_u32 s24, s24, s25
  v_add_u32 v220, s24, v216
  s_mov_b32 s34, 2359296
  s_mov_b32 s35, 131072
  s_waitcnt lgkmcnt(0)
  buffer_load_dwordx4 v[224:227], v220, s[32:35], 0 offen offset:0
  buffer_load_dwordx4 v[228:231], v220, s[32:35], 0 offen offset:1024
  buffer_load_dwordx4 v[232:235], v220, s[32:35], 0 offen offset:1280
  s_waitcnt vmcnt(10)
  ds_write_b128 v211, v[16:19] offset:0
  s_waitcnt vmcnt(9)
  ds_write_b128 v211, v[20:23] offset:1152
  s_waitcnt vmcnt(8)
  ds_write_b128 v211, v[24:27] offset:2304
  s_waitcnt vmcnt(7)
  ds_write_b128 v211, v[28:31] offset:3456
  s_waitcnt vmcnt(6)
  ds_write_b128 v211, v[32:35] offset:4608
  s_waitcnt vmcnt(5)
  ds_write_b128 v211, v[36:39] offset:5760
  s_waitcnt vmcnt(4)
  ds_write_b128 v211, v[40:43] offset:6912
  s_waitcnt vmcnt(3)
  ds_write_b128 v211, v[44:47] offset:8064
  ds_read_b64_tr_b16 v[16:17], v212 offset:0
  ds_read_b64_tr_b16 v[18:19], v212 offset:576
  ds_read_b64_tr_b16 v[20:21], v212 offset:8
  ds_read_b64_tr_b16 v[22:23], v212 offset:584
  ds_read_b64_tr_b16 v[24:25], v212 offset:64
  ds_read_b64_tr_b16 v[26:27], v212 offset:640
  ds_read_b64_tr_b16 v[28:29], v212 offset:72
  ds_read_b64_tr_b16 v[30:31], v212 offset:648
  ds_read_b64_tr_b16 v[32:33], v212 offset:4608
  ds_read_b64_tr_b16 v[34:35], v212 offset:5184
  ds_read_b64_tr_b16 v[36:37], v212 offset:4616
  ds_read_b64_tr_b16 v[38:39], v212 offset:5192
  ds_read_b64_tr_b16 v[40:41], v212 offset:4672
  ds_read_b64_tr_b16 v[42:43], v212 offset:5248
  ds_read_b64_tr_b16 v[44:45], v212 offset:4680
  ds_read_b64_tr_b16 v[46:47], v212 offset:5256
  s_mov_b32 s37, s49
  s_waitcnt vmcnt(0)
  s_mov_b32 s39, 1
  s_waitcnt lgkmcnt(0)
  s_branch per_entry
.p2align 6
fr_cv:
  s_lshl_b32 s6, s4, 12
  s_mul_i32 s5, s3, 22336
  v_lshrrev_b32 v5, 4, v2
  v_mov_b32 v12, 0
  v_mov_b32 v13, 0
  v_mov_b32 v14, 0
  v_mov_b32 v15, 0
  v_add_u32 v9, s5, v3
  s_mov_b32 exec_hi, 0
  ds_write_b128 v9, v[12:15] offset:21792
  s_mov_b64 exec, 31
  ds_write_b128 v9, v[12:15] offset:0
  ds_write_b128 v9, v[12:15] offset:4144
  ds_write_b128 v9, v[12:15] offset:4416
  ds_write_b128 v9, v[12:15] offset:8560
  ds_write_b128 v9, v[12:15] offset:8832
  ds_write_b128 v9, v[12:15] offset:12976
  ds_write_b128 v9, v[12:15] offset:13248
  ds_write_b128 v9, v[12:15] offset:17392
  s_mov_b64 exec, 3
  ds_write_b128 v9, v[12:15] offset:17664
  s_mov_b64 exec, -1
  s_lshl_b32 s7, s3, 2
  s_add_u32 s7, s7, 142848
  v_mov_b32 v21, s7
  ds_write_b32 v21, v12
  s_add_u32 m0, s5, 17696
  s_add_u32 s7, s6, 0
  v_and_b32 v22, 3, v2
  v_lshlrev_b32 v22, 2, v22
  v_add_u32 v22, 142848, v22
  v_add_u32 v11, 1, v4
  v_and_b32 v16, 3, v11
  v_mul_u32_u24 v16, 4416, v16
  v_lshrrev_b32 v11, 2, v11
  v_lshl_add_u32 v16, v11, 3, v16
  v_lshl_add_u32 v16, v5, 4, v16
  v_add_u32 v16, s5, v16
  v_lshlrev_b32 v11, 5, v4
  v_lshlrev_b32 v17, 4, v5
  v_sub_u32 v17, v17, v11
  s_add_u32 s24, s5, 18144
  v_add_u32 v17, s24, v17
  s_mul_i32 s24, s3, 4160
  s_add_u32 s24, s24, 89344
  v_lshlrev_b32 v96, 5, v4
  v_lshl_add_u32 v96, v5, 3, v96
  v_add_u32 v96, s24, v96
  v_bfe_u32 v11, v2, 2, 2
  v_mul_u32_u24 v97, 4160, v11
  v_lshl_add_u32 v97, v5, 5, v97
  v_and_b32 v11, 3, v2
  v_lshl_add_u32 v97, v11, 3, v97
  s_lshl_b32 s24, s3, 10
  s_add_u32 s24, s24, 89344
  v_add_u32 v97, s24, v97
  v_mul_u32_u24 v98, 18432, v5
  v_lshl_add_u32 v98, v4, 3, v98
  s_mul_i32 s32, s3, 589824
  s_mul_i32 s24, s2, 128
  s_add_u32 s32, s32, s24
  s_add_u32 s32, s32, 2359296
  s_waitcnt vmcnt(0)
  s_barrier
  v_lshlrev_b32 v11, 16, v64
  v_add_u32 v116, 8832, v9
  v_add_u32 v120, 13248, v9
  ds_write_b128 v9, v[64:67] offset:64
  ds_write2_b32 v116, v64, v65 offset0:15 offset1:16
  ds_write2_b32 v116, v66, v67 offset0:17 offset1:18
  v_add_u32 v117, 9856, v9
  v_add_u32 v121, 14272, v9
  ds_write_b128 v9, v[72:75] offset:1088
  ds_write2_b32 v117, v72, v73 offset0:15 offset1:16
  ds_write2_b32 v117, v74, v75 offset0:17 offset1:18
  v_add_u32 v118, 10880, v9
  v_add_u32 v122, 15296, v9
  ds_write_b128 v9, v[80:83] offset:2112
  ds_write2_b32 v118, v80, v81 offset0:15 offset1:16
  ds_write2_b32 v118, v82, v83 offset0:17 offset1:18
  v_add_u32 v119, 11904, v9
  v_add_u32 v123, 16320, v9
  ds_write_b128 v9, v[88:91] offset:3136
  ds_write2_b32 v119, v88, v89 offset0:15 offset1:16
  ds_write2_b32 v119, v90, v91 offset0:17 offset1:18
  v_alignbyte_b32 v64, v65, v64, 2
  v_alignbyte_b32 v65, v66, v65, 2
  v_alignbyte_b32 v66, v67, v66, 2
  v_alignbyte_b32 v67, v68, v67, 2
  ds_write_b128 v9, v[64:67] offset:4480
  ds_write2_b32 v120, v64, v65 offset0:15 offset1:16
  ds_write2_b32 v120, v66, v67 offset0:17 offset1:18
  v_alignbyte_b32 v72, v73, v72, 2
  v_alignbyte_b32 v73, v74, v73, 2
  v_alignbyte_b32 v74, v75, v74, 2
  v_alignbyte_b32 v75, v76, v75, 2
  ds_write_b128 v9, v[72:75] offset:5504
  ds_write2_b32 v121, v72, v73 offset0:15 offset1:16
  ds_write2_b32 v121, v74, v75 offset0:17 offset1:18
  v_alignbyte_b32 v80, v81, v80, 2
  v_alignbyte_b32 v81, v82, v81, 2
  v_alignbyte_b32 v82, v83, v82, 2
  v_alignbyte_b32 v83, v84, v83, 2
  ds_write_b128 v9, v[80:83] offset:6528
  ds_write2_b32 v122, v80, v81 offset0:15 offset1:16
  ds_write2_b32 v122, v82, v83 offset0:17 offset1:18
  v_alignbyte_b32 v88, v89, v88, 2
  v_alignbyte_b32 v89, v90, v89, 2
  v_alignbyte_b32 v90, v91, v90, 2
  v_alignbyte_b32 v91, v92, v91, 2
  ds_write_b128 v9, v[88:91] offset:7552
  ds_write2_b32 v123, v88, v89 offset0:15 offset1:16
  ds_write2_b32 v123, v90, v91 offset0:17 offset1:18
  s_mov_b64 exec, 1
  ds_write_b32 v9, v11 offset:4476
  ds_write_b32 v9, v11 offset:13304
  s_mov_b64 exec, -1
  v_lshlrev_b32 v10, 3, v5
  v_add_u32 v10, v10, v4
  v_sub_u32 v10, 31, v10
  v_lshlrev_b32 v11, 16, v8
  v_cmp_eq_u32 vcc, 0, v10
  s_nop 1
  v_cndmask_b32 v24, 0, v8, vcc
  v_cmp_eq_u32 vcc, 1, v10
  s_nop 1
  v_cndmask_b32 v24, v24, v11, vcc
  v_cmp_eq_u32 vcc, 2, v10
  s_nop 1
  v_cndmask_b32 v25, 0, v8, vcc
  v_cmp_eq_u32 vcc, 3, v10
  s_nop 1
  v_cndmask_b32 v25, v25, v11, vcc
  v_cmp_eq_u32 vcc, 4, v10
  s_nop 1
  v_cndmask_b32 v26, 0, v8, vcc
  v_cmp_eq_u32 vcc, 5, v10
  s_nop 1
  v_cndmask_b32 v26, v26, v11, vcc
  v_cmp_eq_u32 vcc, 6, v10
  s_nop 1
  v_cndmask_b32 v27, 0, v8, vcc
  v_cmp_eq_u32 vcc, 7, v10
  s_nop 1
  v_cndmask_b32 v27, v27, v11, vcc
  ds_read_b64 v[100:101], v16 offset:0
  ds_read_b64 v[102:103], v16 offset:8
  ds_read_b64 v[112:113], v16 offset:512
  ds_read_b64 v[114:115], v16 offset:520
  ds_read_b64 v[120:121], v16 offset:1024
  ds_read_b64 v[122:123], v16 offset:1032
  ds_read_b64 v[128:129], v16 offset:1536
  ds_read_b64 v[130:131], v16 offset:1544
  ds_read_b64 v[136:137], v16 offset:2048
  ds_read_b64 v[138:139], v16 offset:2056
  s_waitcnt lgkmcnt(0)
  s_barrier
  buffer_load_dwordx4 v3, s[8:11], s7 offen offset:0 sc1 lds
  buffer_load_dwordx4 v3, s[8:11], s7 offen offset:1024 sc1 lds
  buffer_load_dwordx4 v3, s[8:11], s7 offen offset:2048 sc1 lds
  buffer_load_dwordx4 v3, s[8:11], s7 offen offset:3072 sc1 lds
  s_setprio 2
  s_waitcnt vmcnt(0)
  ds_read_b128 v[104:107], v17 offset:3584
  ds_read_b128 v[108:111], v17 offset:3072
  ds_read_b128 v[116:119], v17 offset:2560
  ds_read_b128 v[124:127], v17 offset:2048
  ds_read_b128 v[132:135], v17 offset:1536
  s_waitcnt lgkmcnt(4)
  v_mfma_f32_16x16x32_bf16 v[28:31], v[100:103], v[104:107], 0
  s_waitcnt lgkmcnt(3)
  v_mfma_f32_16x16x32_bf16 v[32:35], v[100:103], v[108:111], 0
  v_mfma_f32_16x16x32_bf16 v[36:39], v[112:115], v[108:111], 0
  v_mfma_f32_16x16x32_bf16 v[28:31], v[24:27], v[104:107], v[28:31]
  v_mfma_f32_16x16x32_bf16 v[32:35], v[112:115], v[104:107], v[32:35]
  s_waitcnt lgkmcnt(2)
  v_mfma_f32_16x16x32_bf16 v[36:39], v[100:103], v[116:119], v[36:39]
  ds_read_b128 v[140:143], v17 offset:1024
  v_mfma_f32_16x16x32_bf16 v[40:43], v[112:115], v[116:119], 0
  v_mfma_f32_16x16x32_bf16 v[32:35], v[24:27], v[108:111], v[32:35]
  v_mfma_f32_16x16x32_bf16 v[36:39], v[120:123], v[104:107], v[36:39]
  ds_read_b64 v[144:145], v16 offset:2560
  v_mfma_f32_16x16x32_bf16 v[40:43], v[120:123], v[108:111], v[40:43]
  ds_read_b64 v[146:147], v16 offset:2568
  v_mfma_f32_16x16x32_bf16 v[44:47], v[120:123], v[116:119], 0
  v_mfma_f32_16x16x32_bf16 v[36:39], v[24:27], v[116:119], v[36:39]
  s_waitcnt lgkmcnt(4)
  v_mfma_f32_16x16x32_bf16 v[40:43], v[100:103], v[124:127], v[40:43]
  ds_read_b128 v[148:151], v17 offset:512
  v_mfma_f32_16x16x32_bf16 v[44:47], v[112:115], v[124:127], v[44:47]
  v_mfma_f32_16x16x32_bf16 v[48:51], v[120:123], v[124:127], 0
  ds_read_b128 v[152:155], v17 offset:4096
  v_mfma_f32_16x16x32_bf16 v[40:43], v[128:131], v[104:107], v[40:43]
  ds_read_b64 v[156:157], v16 offset:3072
  v_mfma_f32_16x16x32_bf16 v[44:47], v[128:131], v[108:111], v[44:47]
  ds_read_b64 v[158:159], v16 offset:3080
  v_mfma_f32_16x16x32_bf16 v[48:51], v[128:131], v[116:119], v[48:51]
  v_mfma_f32_16x16x32_bf16 v[52:55], v[128:131], v[124:127], 0
  v_mfma_f32_16x16x32_bf16 v[40:43], v[24:27], v[124:127], v[40:43]
  ds_read_b128 v[160:163], v17 offset:0
  s_waitcnt lgkmcnt(8)
  v_mfma_f32_16x16x32_bf16 v[44:47], v[100:103], v[132:135], v[44:47]
  v_mfma_f32_16x16x32_bf16 v[48:51], v[112:115], v[132:135], v[48:51]
  v_mfma_f32_16x16x32_bf16 v[52:55], v[120:123], v[132:135], v[52:55]
  ds_read_b64 v[164:165], v16 offset:3584
  v_mfma_f32_16x16x32_bf16 v[56:59], v[128:131], v[132:135], 0
  ds_read_b64 v[166:167], v16 offset:3592
  v_mfma_f32_16x16x32_bf16 v[44:47], v[136:139], v[104:107], v[44:47]
  v_mfma_f32_16x16x32_bf16 v[48:51], v[136:139], v[108:111], v[48:51]
  v_mfma_f32_16x16x32_bf16 v[52:55], v[136:139], v[116:119], v[52:55]
  v_mfma_f32_16x16x32_bf16 v[56:59], v[136:139], v[124:127], v[56:59]
  ds_read_b64 v[168:169], v16 offset:64
  v_mfma_f32_16x16x32_bf16 v[44:47], v[24:27], v[132:135], v[44:47]
  ds_read_b64 v[170:171], v16 offset:72
  s_waitcnt lgkmcnt(11)
  v_mfma_f32_16x16x32_bf16 v[48:51], v[100:103], v[140:143], v[48:51]
  ds_read_b128 v[172:175], v17 offset:3648
  v_mfma_f32_16x16x32_bf16 v[52:55], v[112:115], v[140:143], v[52:55]
  ds_read_b64 v[176:177], v16 offset:4096
  v_mfma_f32_16x16x32_bf16 v[56:59], v[120:123], v[140:143], v[56:59]
  ds_read_b64 v[178:179], v16 offset:4104
  s_waitcnt lgkmcnt(12)
  v_mfma_f32_16x16x32_bf16 v[48:51], v[144:147], v[104:107], v[48:51]
  ds_read_b128 v[180:183], v17 offset:3136
  v_mfma_f32_16x16x32_bf16 v[52:55], v[144:147], v[108:111], v[52:55]
  ds_read_b64 v[184:185], v16 offset:576
  v_mfma_f32_16x16x32_bf16 v[56:59], v[144:147], v[116:119], v[56:59]
  ds_read_b64 v[186:187], v16 offset:584
  v_mfma_f32_16x16x32_bf16 v[48:51], v[24:27], v[140:143], v[48:51]
  s_waitcnt lgkmcnt(14)
  v_mfma_f32_16x16x32_bf16 v[52:55], v[100:103], v[148:151], v[52:55]
  ds_read_b128 v[188:191], v17 offset:2624
  v_mfma_f32_16x16x32_bf16 v[56:59], v[112:115], v[148:151], v[56:59]
  s_waitcnt lgkmcnt(14)
  v_mfma_f32_16x16x32_bf16 v[28:31], v[112:115], v[152:155], v[28:31]
  ds_read_b64 v[192:193], v16 offset:1088
  s_waitcnt lgkmcnt(13)
  v_mfma_f32_16x16x32_bf16 v[52:55], v[156:159], v[104:107], v[52:55]
  ds_read_b64 v[194:195], v16 offset:1096
  v_mfma_f32_16x16x32_bf16 v[56:59], v[156:159], v[108:111], v[56:59]
  ds_read_b128 v[196:199], v17 offset:2112
  v_mfma_f32_16x16x32_bf16 v[32:35], v[120:123], v[152:155], v[32:35]
  v_mfma_f32_16x16x32_bf16 v[52:55], v[24:27], v[148:151], v[52:55]
  s_waitcnt lgkmcnt(14)
  v_mfma_f32_16x16x32_bf16 v[56:59], v[100:103], v[160:163], v[56:59]
  ds_read_b64 v[200:201], v16 offset:1600
  v_mfma_f32_16x16x32_bf16 v[36:39], v[128:131], v[152:155], v[36:39]
  v_mfma_f32_16x16x32_bf16 v[40:43], v[136:139], v[152:155], v[40:43]
  s_waitcnt lgkmcnt(13)
  v_mfma_f32_16x16x32_bf16 v[56:59], v[164:167], v[104:107], v[56:59]
  ds_read_b64 v[202:203], v16 offset:1608
  v_mfma_f32_16x16x32_bf16 v[44:47], v[144:147], v[152:155], v[44:47]
  ds_read_b128 v[204:207], v17 offset:1600
  v_mfma_f32_16x16x32_bf16 v[48:51], v[156:159], v[152:155], v[48:51]
  v_mfma_f32_16x16x32_bf16 v[56:59], v[24:27], v[160:163], v[56:59]
  v_mfma_f32_16x16x32_bf16 v[52:55], v[164:167], v[152:155], v[52:55]
  s_waitcnt lgkmcnt(12)
  v_mfma_f32_16x16x32_bf16 v[28:31], v[168:171], v[172:175], v[28:31]
  ds_read_b64 v[208:209], v16 offset:2112
  s_waitcnt lgkmcnt(11)
  v_mfma_f32_16x16x32_bf16 v[56:59], v[176:179], v[152:155], v[56:59]
  ds_read_b64 v[210:211], v16 offset:2120
  s_waitcnt lgkmcnt(11)
  v_mfma_f32_16x16x32_bf16 v[32:35], v[168:171], v[180:183], v[32:35]
  ds_read_b128 v[212:215], v17 offset:1088
  s_waitcnt lgkmcnt(10)
  v_mfma_f32_16x16x32_bf16 v[36:39], v[184:187], v[180:183], v[36:39]
  s_waitcnt lgkmcnt(9)
  v_mfma_f32_16x16x32_bf16 v[40:43], v[184:187], v[188:191], v[40:43]
  ds_read_b64 v[216:217], v16 offset:2624
  v_mfma_f32_16x16x32_bf16 v[32:35], v[184:187], v[172:175], v[32:35]
  ds_read_b64 v[218:219], v16 offset:2632
  v_mfma_f32_16x16x32_bf16 v[36:39], v[168:171], v[188:191], v[36:39]
  s_waitcnt lgkmcnt(9)
  v_mfma_f32_16x16x32_bf16 v[40:43], v[192:195], v[180:183], v[40:43]
  ds_read_b64 v[220:221], v16 offset:128
  v_mfma_f32_16x16x32_bf16 v[44:47], v[192:195], v[188:191], v[44:47]
  ds_read_b64 v[222:223], v16 offset:136
  v_mfma_f32_16x16x32_bf16 v[36:39], v[192:195], v[172:175], v[36:39]
  ds_read_b128 v[224:227], v17 offset:3712
  s_waitcnt lgkmcnt(11)
  v_mfma_f32_16x16x32_bf16 v[40:43], v[168:171], v[196:199], v[40:43]
  ds_read_b128 v[228:231], v17 offset:576
  v_mfma_f32_16x16x32_bf16 v[44:47], v[184:187], v[196:199], v[44:47]
  ds_read_b128 v[232:235], v17 offset:3200
  v_mfma_f32_16x16x32_bf16 v[48:51], v[192:195], v[196:199], v[48:51]
  ds_read_b64 v[236:237], v16 offset:3136
  s_waitcnt lgkmcnt(12)
  v_mfma_f32_16x16x32_bf16 v[40:43], v[200:203], v[172:175], v[40:43]
  ds_read_b64 v[238:239], v16 offset:3144
  v_mfma_f32_16x16x32_bf16 v[44:47], v[200:203], v[180:183], v[44:47]
  ds_read_b64 v[240:241], v16 offset:640
  v_mfma_f32_16x16x32_bf16 v[48:51], v[200:203], v[188:191], v[48:51]
  ds_read_b64 v[242:243], v16 offset:648
  v_mfma_f32_16x16x32_bf16 v[52:55], v[200:203], v[196:199], v[52:55]
  s_waitcnt lgkmcnt(14)
  v_mfma_f32_16x16x32_bf16 v[44:47], v[168:171], v[204:207], v[44:47]
  ds_read_b128 v[124:127], v17 offset:64
  v_mfma_f32_16x16x32_bf16 v[48:51], v[184:187], v[204:207], v[48:51]
  v_mfma_f32_16x16x32_bf16 v[52:55], v[192:195], v[204:207], v[52:55]
  v_mfma_f32_16x16x32_bf16 v[56:59], v[200:203], v[204:207], v[56:59]
  s_waitcnt lgkmcnt(13)
  v_mfma_f32_16x16x32_bf16 v[44:47], v[208:211], v[172:175], v[44:47]
  ds_read_b128 v[132:135], v17 offset:2688
  v_mfma_f32_16x16x32_bf16 v[48:51], v[208:211], v[180:183], v[48:51]
  ds_read_b64 v[116:117], v16 offset:3648
  v_mfma_f32_16x16x32_bf16 v[52:55], v[208:211], v[188:191], v[52:55]
  v_mfma_f32_16x16x32_bf16 v[56:59], v[208:211], v[196:199], v[56:59]
  s_waitcnt lgkmcnt(14)
  v_mfma_f32_16x16x32_bf16 v[48:51], v[168:171], v[212:215], v[48:51]
  ds_read_b64 v[118:119], v16 offset:3656
  v_mfma_f32_16x16x32_bf16 v[52:55], v[184:187], v[212:215], v[52:55]
  v_mfma_f32_16x16x32_bf16 v[56:59], v[192:195], v[212:215], v[56:59]
  s_waitcnt lgkmcnt(13)
  v_mfma_f32_16x16x32_bf16 v[48:51], v[216:219], v[172:175], v[48:51]
  ds_read_b64 v[140:141], v16 offset:1152
  v_mfma_f32_16x16x32_bf16 v[52:55], v[216:219], v[180:183], v[52:55]
  ds_read_b64 v[142:143], v16 offset:1160
  v_mfma_f32_16x16x32_bf16 v[56:59], v[216:219], v[188:191], v[56:59]
  s_waitcnt lgkmcnt(12)
  v_mfma_f32_16x16x32_bf16 v[28:31], v[220:223], v[224:227], v[28:31]
  ds_read_b128 v[112:115], v17 offset:2176
  s_waitcnt lgkmcnt(12)
  v_mfma_f32_16x16x32_bf16 v[52:55], v[168:171], v[228:231], v[52:55]
  ds_read_b64 v[108:109], v16 offset:1664
  v_mfma_f32_16x16x32_bf16 v[56:59], v[184:187], v[228:231], v[56:59]
  ds_read_b64 v[110:111], v16 offset:1672
  s_waitcnt lgkmcnt(13)
  v_mfma_f32_16x16x32_bf16 v[32:35], v[220:223], v[232:235], v[32:35]
  ds_read_b128 v[120:123], v17 offset:1664
  s_waitcnt lgkmcnt(12)
  v_mfma_f32_16x16x32_bf16 v[52:55], v[236:239], v[172:175], v[52:55]
  ds_read_b64 v[148:149], v16 offset:2176
  v_mfma_f32_16x16x32_bf16 v[56:59], v[236:239], v[180:183], v[56:59]
  ds_read_b64 v[150:151], v16 offset:2184
  s_waitcnt lgkmcnt(12)
  v_mfma_f32_16x16x32_bf16 v[32:35], v[240:243], v[224:227], v[32:35]
  ds_read_b128 v[100:103], v17 offset:1152
  v_mfma_f32_16x16x32_bf16 v[36:39], v[240:243], v[232:235], v[36:39]
  s_waitcnt lgkmcnt(12)
  v_mfma_f32_16x16x32_bf16 v[56:59], v[168:171], v[124:127], v[56:59]
  s_waitcnt lgkmcnt(11)
  v_mfma_f32_16x16x32_bf16 v[40:43], v[240:243], v[132:135], v[40:43]
  ds_read_b64 v[128:129], v16 offset:2688
  v_mfma_f32_16x16x32_bf16 v[36:39], v[220:223], v[132:135], v[36:39]
  ds_read_b64 v[130:131], v16 offset:2696
  s_waitcnt lgkmcnt(11)
  v_mfma_f32_16x16x32_bf16 v[56:59], v[116:119], v[172:175], v[56:59]
  s_waitcnt lgkmcnt(9)
  v_mfma_f32_16x16x32_bf16 v[40:43], v[140:143], v[232:235], v[40:43]
  ds_read_b64 v[136:137], v16 offset:192
  v_mfma_f32_16x16x32_bf16 v[36:39], v[140:143], v[224:227], v[36:39]
  ds_read_b64 v[138:139], v16 offset:200
  v_mfma_f32_16x16x32_bf16 v[44:47], v[140:143], v[132:135], v[44:47]
  ds_read_b128 v[104:107], v17 offset:3776
  s_waitcnt lgkmcnt(11)
  v_mfma_f32_16x16x32_bf16 v[40:43], v[220:223], v[112:115], v[40:43]
  ds_read_b128 v[144:147], v17 offset:640
  v_mfma_f32_16x16x32_bf16 v[48:51], v[140:143], v[112:115], v[48:51]
  ds_read_b128 v[156:159], v17 offset:3264
  v_mfma_f32_16x16x32_bf16 v[44:47], v[240:243], v[112:115], v[44:47]
  ds_read_b64 v[160:161], v16 offset:3200
  s_waitcnt lgkmcnt(12)
  v_mfma_f32_16x16x32_bf16 v[40:43], v[108:111], v[224:227], v[40:43]
  ds_read_b64 v[162:163], v16 offset:3208
  v_mfma_f32_16x16x32_bf16 v[48:51], v[108:111], v[132:135], v[48:51]
  ds_read_b64 v[164:165], v16 offset:704
  v_mfma_f32_16x16x32_bf16 v[44:47], v[108:111], v[232:235], v[44:47]
  ds_read_b64 v[166:167], v16 offset:712
  v_mfma_f32_16x16x32_bf16 v[52:55], v[108:111], v[112:115], v[52:55]
  s_waitcnt lgkmcnt(14)
  v_mfma_f32_16x16x32_bf16 v[48:51], v[240:243], v[120:123], v[48:51]
  ds_read_b128 v[176:179], v17 offset:128
  v_mfma_f32_16x16x32_bf16 v[44:47], v[220:223], v[120:123], v[44:47]
  v_mfma_f32_16x16x32_bf16 v[52:55], v[140:143], v[120:123], v[52:55]
  v_mfma_f32_16x16x32_bf16 v[56:59], v[108:111], v[120:123], v[56:59]
  s_waitcnt lgkmcnt(13)
  v_mfma_f32_16x16x32_bf16 v[44:47], v[148:151], v[224:227], v[44:47]
  ds_read_b128 v[152:155], v17 offset:2752
  v_mfma_f32_16x16x32_bf16 v[48:51], v[148:151], v[232:235], v[48:51]
  ds_read_b64 v[200:201], v16 offset:3712
  v_mfma_f32_16x16x32_bf16 v[52:55], v[148:151], v[132:135], v[52:55]
  v_mfma_f32_16x16x32_bf16 v[56:59], v[148:151], v[112:115], v[56:59]
  s_waitcnt lgkmcnt(14)
  v_mfma_f32_16x16x32_bf16 v[48:51], v[220:223], v[100:103], v[48:51]
  ds_read_b64 v[202:203], v16 offset:3720
  v_mfma_f32_16x16x32_bf16 v[52:55], v[240:243], v[100:103], v[52:55]
  v_mfma_f32_16x16x32_bf16 v[56:59], v[140:143], v[100:103], v[56:59]
  s_waitcnt lgkmcnt(13)
  v_mfma_f32_16x16x32_bf16 v[48:51], v[128:131], v[224:227], v[48:51]
  ds_read_b64 v[204:205], v16 offset:1216
  v_mfma_f32_16x16x32_bf16 v[52:55], v[128:131], v[232:235], v[52:55]
  ds_read_b64 v[206:207], v16 offset:1224
  v_mfma_f32_16x16x32_bf16 v[56:59], v[128:131], v[132:135], v[56:59]
  s_waitcnt lgkmcnt(12)
  v_mfma_f32_16x16x32_bf16 v[28:31], v[136:139], v[104:107], v[28:31]
  ds_read_b128 v[208:211], v17 offset:2240
  s_waitcnt lgkmcnt(12)
  v_mfma_f32_16x16x32_bf16 v[52:55], v[220:223], v[144:147], v[52:55]
  ds_read_b64 v[196:197], v16 offset:1728
  v_mfma_f32_16x16x32_bf16 v[56:59], v[240:243], v[144:147], v[56:59]
  ds_read_b64 v[198:199], v16 offset:1736
  s_waitcnt lgkmcnt(13)
  v_mfma_f32_16x16x32_bf16 v[32:35], v[136:139], v[156:159], v[32:35]
  ds_read_b128 v[192:195], v17 offset:1728
  s_waitcnt lgkmcnt(12)
  v_mfma_f32_16x16x32_bf16 v[52:55], v[160:163], v[224:227], v[52:55]
  ds_read_b64 v[212:213], v16 offset:2240
  v_mfma_f32_16x16x32_bf16 v[56:59], v[160:163], v[232:235], v[56:59]
  ds_read_b64 v[214:215], v16 offset:2248
  s_waitcnt lgkmcnt(12)
  v_mfma_f32_16x16x32_bf16 v[32:35], v[164:167], v[104:107], v[32:35]
  ds_read_b128 v[216:219], v17 offset:1216
  v_mfma_f32_16x16x32_bf16 v[36:39], v[164:167], v[156:159], v[36:39]
  s_waitcnt lgkmcnt(12)
  v_mfma_f32_16x16x32_bf16 v[56:59], v[220:223], v[176:179], v[56:59]
  s_waitcnt lgkmcnt(11)
  v_mfma_f32_16x16x32_bf16 v[40:43], v[164:167], v[152:155], v[40:43]
  ds_read_b64 v[188:189], v16 offset:2752
  v_mfma_f32_16x16x32_bf16 v[36:39], v[136:139], v[152:155], v[36:39]
  ds_read_b64 v[190:191], v16 offset:2760
  s_waitcnt lgkmcnt(11)
  v_mfma_f32_16x16x32_bf16 v[56:59], v[200:203], v[224:227], v[56:59]
  s_waitcnt lgkmcnt(9)
  v_mfma_f32_16x16x32_bf16 v[40:43], v[204:207], v[156:159], v[40:43]
  ds_read_b64 v[184:185], v16 offset:256
  v_mfma_f32_16x16x32_bf16 v[36:39], v[204:207], v[104:107], v[36:39]
  ds_read_b64 v[186:187], v16 offset:264
  v_mfma_f32_16x16x32_bf16 v[44:47], v[204:207], v[152:155], v[44:47]
  ds_read_b128 v[228:231], v17 offset:3840
  s_waitcnt lgkmcnt(11)
  v_mfma_f32_16x16x32_bf16 v[40:43], v[136:139], v[208:211], v[40:43]
  ds_read_b128 v[236:239], v17 offset:704
  v_mfma_f32_16x16x32_bf16 v[48:51], v[204:207], v[208:211], v[48:51]
  ds_read_b128 v[180:183], v17 offset:3328
  v_mfma_f32_16x16x32_bf16 v[44:47], v[164:167], v[208:211], v[44:47]
  ds_read_b64 v[168:169], v16 offset:3264
  s_waitcnt lgkmcnt(12)
  v_mfma_f32_16x16x32_bf16 v[40:43], v[196:199], v[104:107], v[40:43]
  ds_read_b64 v[170:171], v16 offset:3272
  v_mfma_f32_16x16x32_bf16 v[48:51], v[196:199], v[152:155], v[48:51]
  ds_read_b64 v[124:125], v16 offset:768
  v_mfma_f32_16x16x32_bf16 v[44:47], v[196:199], v[156:159], v[44:47]
  ds_read_b64 v[126:127], v16 offset:776
  v_mfma_f32_16x16x32_bf16 v[52:55], v[196:199], v[208:211], v[52:55]
  s_waitcnt lgkmcnt(14)
  v_mfma_f32_16x16x32_bf16 v[48:51], v[164:167], v[192:195], v[48:51]
  ds_read_b128 v[116:119], v17 offset:192
  v_mfma_f32_16x16x32_bf16 v[44:47], v[136:139], v[192:195], v[44:47]
  v_mfma_f32_16x16x32_bf16 v[52:55], v[204:207], v[192:195], v[52:55]
  v_mfma_f32_16x16x32_bf16 v[56:59], v[196:199], v[192:195], v[56:59]
  s_waitcnt lgkmcnt(13)
  v_mfma_f32_16x16x32_bf16 v[44:47], v[212:215], v[104:107], v[44:47]
  ds_read_b128 v[172:175], v17 offset:2816
  v_mfma_f32_16x16x32_bf16 v[48:51], v[212:215], v[156:159], v[48:51]
  ds_read_b64 v[108:109], v16 offset:3776
  v_mfma_f32_16x16x32_bf16 v[52:55], v[212:215], v[152:155], v[52:55]
  v_mfma_f32_16x16x32_bf16 v[56:59], v[212:215], v[208:211], v[56:59]
  s_waitcnt lgkmcnt(14)
  v_mfma_f32_16x16x32_bf16 v[48:51], v[136:139], v[216:219], v[48:51]
  ds_read_b64 v[110:111], v16 offset:3784
  v_mfma_f32_16x16x32_bf16 v[52:55], v[164:167], v[216:219], v[52:55]
  v_mfma_f32_16x16x32_bf16 v[56:59], v[204:207], v[216:219], v[56:59]
  s_waitcnt lgkmcnt(13)
  v_mfma_f32_16x16x32_bf16 v[48:51], v[188:191], v[104:107], v[48:51]
  ds_read_b64 v[120:121], v16 offset:1280
  v_mfma_f32_16x16x32_bf16 v[52:55], v[188:191], v[156:159], v[52:55]
  ds_read_b64 v[122:123], v16 offset:1288
  v_mfma_f32_16x16x32_bf16 v[56:59], v[188:191], v[152:155], v[56:59]
  s_waitcnt lgkmcnt(12)
  v_mfma_f32_16x16x32_bf16 v[28:31], v[184:187], v[228:231], v[28:31]
  ds_read_b128 v[148:151], v17 offset:2304
  s_waitcnt lgkmcnt(12)
  v_mfma_f32_16x16x32_bf16 v[52:55], v[136:139], v[236:239], v[52:55]
  ds_read_b64 v[112:113], v16 offset:1792
  v_mfma_f32_16x16x32_bf16 v[56:59], v[164:167], v[236:239], v[56:59]
  ds_read_b64 v[114:115], v16 offset:1800
  s_waitcnt lgkmcnt(13)
  v_mfma_f32_16x16x32_bf16 v[32:35], v[184:187], v[180:183], v[32:35]
  ds_read_b128 v[140:143], v17 offset:1792
  s_waitcnt lgkmcnt(12)
  v_mfma_f32_16x16x32_bf16 v[52:55], v[168:171], v[104:107], v[52:55]
  ds_read_b64 v[100:101], v16 offset:2304
  v_mfma_f32_16x16x32_bf16 v[56:59], v[168:171], v[156:159], v[56:59]
  ds_read_b64 v[102:103], v16 offset:2312
  s_waitcnt lgkmcnt(12)
  v_mfma_f32_16x16x32_bf16 v[32:35], v[124:127], v[228:231], v[32:35]
  ds_read_b128 v[128:131], v17 offset:1280
  v_mfma_f32_16x16x32_bf16 v[36:39], v[124:127], v[180:183], v[36:39]
  s_waitcnt lgkmcnt(12)
  v_mfma_f32_16x16x32_bf16 v[56:59], v[136:139], v[116:119], v[56:59]
  s_waitcnt lgkmcnt(11)
  v_mfma_f32_16x16x32_bf16 v[40:43], v[124:127], v[172:175], v[40:43]
  ds_read_b64 v[132:133], v16 offset:2816
  v_mfma_f32_16x16x32_bf16 v[36:39], v[184:187], v[172:175], v[36:39]
  ds_read_b64 v[134:135], v16 offset:2824
  s_waitcnt lgkmcnt(11)
  v_mfma_f32_16x16x32_bf16 v[56:59], v[108:111], v[104:107], v[56:59]
  s_waitcnt lgkmcnt(9)
  v_mfma_f32_16x16x32_bf16 v[40:43], v[120:123], v[180:183], v[40:43]
  ds_read_b64 v[240:241], v16 offset:320
  v_mfma_f32_16x16x32_bf16 v[36:39], v[120:123], v[228:231], v[36:39]
  ds_read_b64 v[242:243], v16 offset:328
  v_mfma_f32_16x16x32_bf16 v[44:47], v[120:123], v[172:175], v[44:47]
  ds_read_b128 v[144:147], v17 offset:3904
  s_waitcnt lgkmcnt(11)
  v_mfma_f32_16x16x32_bf16 v[40:43], v[184:187], v[148:151], v[40:43]
  ds_read_b128 v[160:163], v17 offset:768
  v_mfma_f32_16x16x32_bf16 v[48:51], v[120:123], v[148:151], v[48:51]
  ds_read_b128 v[232:235], v17 offset:3392
  v_mfma_f32_16x16x32_bf16 v[44:47], v[124:127], v[148:151], v[44:47]
  ds_read_b64 v[220:221], v16 offset:3328
  s_waitcnt lgkmcnt(12)
  v_mfma_f32_16x16x32_bf16 v[40:43], v[112:115], v[228:231], v[40:43]
  ds_read_b64 v[222:223], v16 offset:3336
  v_mfma_f32_16x16x32_bf16 v[48:51], v[112:115], v[172:175], v[48:51]
  ds_read_b64 v[176:177], v16 offset:832
  v_mfma_f32_16x16x32_bf16 v[44:47], v[112:115], v[180:183], v[44:47]
  ds_read_b64 v[178:179], v16 offset:840
  v_mfma_f32_16x16x32_bf16 v[52:55], v[112:115], v[148:151], v[52:55]
  s_waitcnt lgkmcnt(14)
  v_mfma_f32_16x16x32_bf16 v[48:51], v[124:127], v[140:143], v[48:51]
  ds_read_b128 v[200:203], v17 offset:256
  v_mfma_f32_16x16x32_bf16 v[44:47], v[184:187], v[140:143], v[44:47]
  v_mfma_f32_16x16x32_bf16 v[52:55], v[120:123], v[140:143], v[52:55]
  v_mfma_f32_16x16x32_bf16 v[56:59], v[112:115], v[140:143], v[56:59]
  s_waitcnt lgkmcnt(13)
  v_mfma_f32_16x16x32_bf16 v[44:47], v[100:103], v[228:231], v[44:47]
  ds_read_b128 v[224:227], v17 offset:2880
  v_mfma_f32_16x16x32_bf16 v[48:51], v[100:103], v[180:183], v[48:51]
  ds_read_b64 v[196:197], v16 offset:3840
  v_mfma_f32_16x16x32_bf16 v[52:55], v[100:103], v[172:175], v[52:55]
  v_mfma_f32_16x16x32_bf16 v[56:59], v[100:103], v[148:151], v[56:59]
  s_waitcnt lgkmcnt(14)
  v_mfma_f32_16x16x32_bf16 v[48:51], v[184:187], v[128:131], v[48:51]
  ds_read_b64 v[198:199], v16 offset:3848
  v_mfma_f32_16x16x32_bf16 v[52:55], v[124:127], v[128:131], v[52:55]
  v_mfma_f32_16x16x32_bf16 v[56:59], v[120:123], v[128:131], v[56:59]
  s_waitcnt lgkmcnt(13)
  v_mfma_f32_16x16x32_bf16 v[48:51], v[132:135], v[228:231], v[48:51]
  ds_read_b64 v[192:193], v16 offset:1344
  v_mfma_f32_16x16x32_bf16 v[52:55], v[132:135], v[180:183], v[52:55]
  ds_read_b64 v[194:195], v16 offset:1352
  v_mfma_f32_16x16x32_bf16 v[56:59], v[132:135], v[172:175], v[56:59]
  s_waitcnt lgkmcnt(12)
  v_mfma_f32_16x16x32_bf16 v[28:31], v[240:243], v[144:147], v[28:31]
  ds_read_b128 v[212:215], v17 offset:2368
  s_waitcnt lgkmcnt(12)
  v_mfma_f32_16x16x32_bf16 v[52:55], v[184:187], v[160:163], v[52:55]
  ds_read_b64 v[208:209], v16 offset:1856
  v_mfma_f32_16x16x32_bf16 v[56:59], v[124:127], v[160:163], v[56:59]
  ds_read_b64 v[210:211], v16 offset:1864
  s_waitcnt lgkmcnt(13)
  v_mfma_f32_16x16x32_bf16 v[32:35], v[240:243], v[232:235], v[32:35]
  ds_read_b128 v[204:207], v17 offset:1856
  s_waitcnt lgkmcnt(12)
  v_mfma_f32_16x16x32_bf16 v[52:55], v[220:223], v[228:231], v[52:55]
  ds_read_b64 v[216:217], v16 offset:2368
  v_mfma_f32_16x16x32_bf16 v[56:59], v[220:223], v[180:183], v[56:59]
  ds_read_b64 v[218:219], v16 offset:2376
  s_waitcnt lgkmcnt(12)
  v_mfma_f32_16x16x32_bf16 v[32:35], v[176:179], v[144:147], v[32:35]
  ds_read_b128 v[188:191], v17 offset:1344
  v_mfma_f32_16x16x32_bf16 v[36:39], v[176:179], v[232:235], v[36:39]
  s_waitcnt lgkmcnt(12)
  v_mfma_f32_16x16x32_bf16 v[56:59], v[184:187], v[200:203], v[56:59]
  s_waitcnt lgkmcnt(11)
  v_mfma_f32_16x16x32_bf16 v[40:43], v[176:179], v[224:227], v[40:43]
  ds_read_b64 v[152:153], v16 offset:2880
  v_mfma_f32_16x16x32_bf16 v[36:39], v[240:243], v[224:227], v[36:39]
  ds_read_b64 v[154:155], v16 offset:2888
  s_waitcnt lgkmcnt(11)
  v_mfma_f32_16x16x32_bf16 v[56:59], v[196:199], v[228:231], v[56:59]
  s_waitcnt lgkmcnt(9)
  v_mfma_f32_16x16x32_bf16 v[40:43], v[192:195], v[232:235], v[40:43]
  ds_read_b64 v[164:165], v16 offset:384
  v_mfma_f32_16x16x32_bf16 v[36:39], v[192:195], v[144:147], v[36:39]
  ds_read_b64 v[166:167], v16 offset:392
  v_mfma_f32_16x16x32_bf16 v[44:47], v[192:195], v[224:227], v[44:47]
  ds_read_b128 v[236:239], v17 offset:3968
  s_waitcnt lgkmcnt(11)
  v_mfma_f32_16x16x32_bf16 v[40:43], v[240:243], v[212:215], v[40:43]
  ds_read_b128 v[168:171], v17 offset:832
  v_mfma_f32_16x16x32_bf16 v[48:51], v[192:195], v[212:215], v[48:51]
  ds_read_b128 v[156:159], v17 offset:3456
  v_mfma_f32_16x16x32_bf16 v[44:47], v[176:179], v[212:215], v[44:47]
  ds_read_b64 v[136:137], v16 offset:3392
  s_waitcnt lgkmcnt(12)
  v_mfma_f32_16x16x32_bf16 v[40:43], v[208:211], v[144:147], v[40:43]
  ds_read_b64 v[138:139], v16 offset:3400
  v_mfma_f32_16x16x32_bf16 v[48:51], v[208:211], v[224:227], v[48:51]
  ds_read_b64 v[116:117], v16 offset:896
  v_mfma_f32_16x16x32_bf16 v[44:47], v[208:211], v[232:235], v[44:47]
  ds_read_b64 v[118:119], v16 offset:904
  v_mfma_f32_16x16x32_bf16 v[52:55], v[208:211], v[212:215], v[52:55]
  s_waitcnt lgkmcnt(14)
  v_mfma_f32_16x16x32_bf16 v[48:51], v[176:179], v[204:207], v[48:51]
  ds_read_b128 v[108:111], v17 offset:320
  v_mfma_f32_16x16x32_bf16 v[44:47], v[240:243], v[204:207], v[44:47]
  v_mfma_f32_16x16x32_bf16 v[52:55], v[192:195], v[204:207], v[52:55]
  v_mfma_f32_16x16x32_bf16 v[56:59], v[208:211], v[204:207], v[56:59]
  s_waitcnt lgkmcnt(13)
  v_mfma_f32_16x16x32_bf16 v[44:47], v[216:219], v[144:147], v[44:47]
  ds_read_b128 v[104:107], v17 offset:2944
  v_mfma_f32_16x16x32_bf16 v[48:51], v[216:219], v[232:235], v[48:51]
  ds_read_b64 v[112:113], v16 offset:3904
  v_mfma_f32_16x16x32_bf16 v[52:55], v[216:219], v[224:227], v[52:55]
  v_mfma_f32_16x16x32_bf16 v[56:59], v[216:219], v[212:215], v[56:59]
  s_waitcnt lgkmcnt(14)
  v_mfma_f32_16x16x32_bf16 v[48:51], v[240:243], v[188:191], v[48:51]
  ds_read_b64 v[114:115], v16 offset:3912
  v_mfma_f32_16x16x32_bf16 v[52:55], v[176:179], v[188:191], v[52:55]
  v_mfma_f32_16x16x32_bf16 v[56:59], v[192:195], v[188:191], v[56:59]
  s_waitcnt lgkmcnt(13)
  v_mfma_f32_16x16x32_bf16 v[48:51], v[152:155], v[144:147], v[48:51]
  ds_read_b64 v[140:141], v16 offset:1408
  v_mfma_f32_16x16x32_bf16 v[52:55], v[152:155], v[232:235], v[52:55]
  ds_read_b64 v[142:143], v16 offset:1416
  v_mfma_f32_16x16x32_bf16 v[56:59], v[152:155], v[224:227], v[56:59]
  s_waitcnt lgkmcnt(12)
  v_mfma_f32_16x16x32_bf16 v[28:31], v[164:167], v[236:239], v[28:31]
  ds_read_b128 v[100:103], v17 offset:2432
  s_waitcnt lgkmcnt(12)
  v_mfma_f32_16x16x32_bf16 v[52:55], v[240:243], v[168:171], v[52:55]
  ds_read_b64 v[148:149], v16 offset:1920
  v_mfma_f32_16x16x32_bf16 v[56:59], v[176:179], v[168:171], v[56:59]
  ds_read_b64 v[150:151], v16 offset:1928
  s_waitcnt lgkmcnt(13)
  v_mfma_f32_16x16x32_bf16 v[32:35], v[164:167], v[156:159], v[32:35]
  ds_read_b128 v[120:123], v17 offset:1920
  s_waitcnt lgkmcnt(12)
  v_mfma_f32_16x16x32_bf16 v[52:55], v[136:139], v[144:147], v[52:55]
  ds_read_b64 v[128:129], v16 offset:2432
  v_mfma_f32_16x16x32_bf16 v[56:59], v[136:139], v[232:235], v[56:59]
  ds_read_b64 v[130:131], v16 offset:2440
  s_waitcnt lgkmcnt(12)
  v_mfma_f32_16x16x32_bf16 v[32:35], v[116:119], v[236:239], v[32:35]
  ds_read_b128 v[132:135], v17 offset:1408
  v_mfma_f32_16x16x32_bf16 v[36:39], v[116:119], v[156:159], v[36:39]
  s_waitcnt lgkmcnt(12)
  v_mfma_f32_16x16x32_bf16 v[56:59], v[240:243], v[108:111], v[56:59]
  s_waitcnt lgkmcnt(11)
  v_mfma_f32_16x16x32_bf16 v[40:43], v[116:119], v[104:107], v[40:43]
  ds_read_b64 v[172:173], v16 offset:2944
  v_mfma_f32_16x16x32_bf16 v[36:39], v[164:167], v[104:107], v[36:39]
  ds_read_b64 v[174:175], v16 offset:2952
  s_waitcnt lgkmcnt(11)
  v_mfma_f32_16x16x32_bf16 v[56:59], v[112:115], v[144:147], v[56:59]
  s_waitcnt lgkmcnt(9)
  v_mfma_f32_16x16x32_bf16 v[40:43], v[140:143], v[156:159], v[40:43]
  ds_read_b64 v[124:125], v16 offset:448
  v_mfma_f32_16x16x32_bf16 v[36:39], v[140:143], v[236:239], v[36:39]
  ds_read_b64 v[126:127], v16 offset:456
  v_mfma_f32_16x16x32_bf16 v[44:47], v[140:143], v[104:107], v[44:47]
  ds_read_b128 v[160:163], v17 offset:4032
  s_waitcnt lgkmcnt(11)
  v_mfma_f32_16x16x32_bf16 v[40:43], v[164:167], v[100:103], v[40:43]
  ds_read_b128 v[220:223], v17 offset:896
  v_mfma_f32_16x16x32_bf16 v[48:51], v[140:143], v[100:103], v[48:51]
  ds_read_b128 v[180:183], v17 offset:3520
  v_mfma_f32_16x16x32_bf16 v[44:47], v[116:119], v[100:103], v[44:47]
  ds_read_b64 v[184:185], v16 offset:3456
  s_waitcnt lgkmcnt(12)
  v_mfma_f32_16x16x32_bf16 v[40:43], v[148:151], v[236:239], v[40:43]
  ds_read_b64 v[186:187], v16 offset:3464
  v_mfma_f32_16x16x32_bf16 v[48:51], v[148:151], v[104:107], v[48:51]
  ds_read_b64 v[200:201], v16 offset:960
  v_mfma_f32_16x16x32_bf16 v[44:47], v[148:151], v[156:159], v[44:47]
  ds_read_b64 v[202:203], v16 offset:968
  v_mfma_f32_16x16x32_bf16 v[52:55], v[148:151], v[100:103], v[52:55]
  s_waitcnt lgkmcnt(14)
  v_mfma_f32_16x16x32_bf16 v[48:51], v[116:119], v[120:123], v[48:51]
  ds_read_b128 v[196:199], v17 offset:384
  v_mfma_f32_16x16x32_bf16 v[44:47], v[164:167], v[120:123], v[44:47]
  v_mfma_f32_16x16x32_bf16 v[52:55], v[140:143], v[120:123], v[52:55]
  v_mfma_f32_16x16x32_bf16 v[56:59], v[148:151], v[120:123], v[56:59]
  s_waitcnt lgkmcnt(13)
  v_mfma_f32_16x16x32_bf16 v[44:47], v[128:131], v[236:239], v[44:47]
  ds_read_b128 v[228:231], v17 offset:3008
  v_mfma_f32_16x16x32_bf16 v[48:51], v[128:131], v[156:159], v[48:51]
  ds_read_b64 v[208:209], v16 offset:3968
  v_mfma_f32_16x16x32_bf16 v[52:55], v[128:131], v[104:107], v[52:55]
  v_mfma_f32_16x16x32_bf16 v[56:59], v[128:131], v[100:103], v[56:59]
  s_waitcnt lgkmcnt(14)
  v_mfma_f32_16x16x32_bf16 v[48:51], v[164:167], v[132:135], v[48:51]
  ds_read_b64 v[210:211], v16 offset:3976
  v_mfma_f32_16x16x32_bf16 v[52:55], v[116:119], v[132:135], v[52:55]
  v_mfma_f32_16x16x32_bf16 v[56:59], v[140:143], v[132:135], v[56:59]
  s_waitcnt lgkmcnt(13)
  v_mfma_f32_16x16x32_bf16 v[48:51], v[172:175], v[236:239], v[48:51]
  ds_read_b64 v[204:205], v16 offset:1472
  v_mfma_f32_16x16x32_bf16 v[52:55], v[172:175], v[156:159], v[52:55]
  ds_read_b64 v[206:207], v16 offset:1480
  v_mfma_f32_16x16x32_bf16 v[56:59], v[172:175], v[104:107], v[56:59]
  s_waitcnt lgkmcnt(12)
  v_mfma_f32_16x16x32_bf16 v[28:31], v[124:127], v[160:163], v[28:31]
  ds_read_b128 v[216:219], v17 offset:2496
  s_waitcnt lgkmcnt(12)
  v_mfma_f32_16x16x32_bf16 v[52:55], v[164:167], v[220:223], v[52:55]
  ds_read_b64 v[212:213], v16 offset:1984
  v_mfma_f32_16x16x32_bf16 v[56:59], v[116:119], v[220:223], v[56:59]
  ds_read_b64 v[214:215], v16 offset:1992
  s_waitcnt lgkmcnt(13)
  v_mfma_f32_16x16x32_bf16 v[32:35], v[124:127], v[180:183], v[32:35]
  ds_read_b128 v[192:195], v17 offset:1984
  s_waitcnt lgkmcnt(12)
  v_mfma_f32_16x16x32_bf16 v[52:55], v[184:187], v[236:239], v[52:55]
  ds_read_b64 v[188:189], v16 offset:2496
  v_mfma_f32_16x16x32_bf16 v[56:59], v[184:187], v[156:159], v[56:59]
  ds_read_b64 v[190:191], v16 offset:2504
  s_waitcnt lgkmcnt(12)
  v_mfma_f32_16x16x32_bf16 v[32:35], v[200:203], v[160:163], v[32:35]
  ds_read_b128 v[152:155], v17 offset:1472
  v_mfma_f32_16x16x32_bf16 v[36:39], v[200:203], v[180:183], v[36:39]
  s_waitcnt lgkmcnt(12)
  v_mfma_f32_16x16x32_bf16 v[56:59], v[164:167], v[196:199], v[56:59]
  s_waitcnt lgkmcnt(11)
  v_mfma_f32_16x16x32_bf16 v[40:43], v[200:203], v[228:231], v[40:43]
  ds_read_b64 v[224:225], v16 offset:3008
  v_mfma_f32_16x16x32_bf16 v[36:39], v[124:127], v[228:231], v[36:39]
  ds_read_b64 v[226:227], v16 offset:3016
  s_waitcnt lgkmcnt(11)
  v_mfma_f32_16x16x32_bf16 v[56:59], v[208:211], v[236:239], v[56:59]
  s_waitcnt lgkmcnt(9)
  v_mfma_f32_16x16x32_bf16 v[40:43], v[204:207], v[180:183], v[40:43]
  ds_read_b128 v[176:179], v17 offset:960
  v_mfma_f32_16x16x32_bf16 v[36:39], v[204:207], v[160:163], v[36:39]
  v_mfma_f32_16x16x32_bf16 v[44:47], v[204:207], v[228:231], v[44:47]
  ds_read_b64 v[168:169], v16 offset:3520
  s_waitcnt lgkmcnt(10)
  v_mfma_f32_16x16x32_bf16 v[40:43], v[124:127], v[216:219], v[40:43]
  ds_read_b64 v[170:171], v16 offset:3528
  v_mfma_f32_16x16x32_bf16 v[48:51], v[204:207], v[216:219], v[48:51]
  ds_read_b128 v[136:139], v17 offset:448
  v_mfma_f32_16x16x32_bf16 v[44:47], v[200:203], v[216:219], v[44:47]
  ds_read_b64 v[232:233], v16 offset:4032
  s_waitcnt lgkmcnt(11)
  v_mfma_f32_16x16x32_bf16 v[40:43], v[212:215], v[160:163], v[40:43]
  ds_read_b64 v[234:235], v16 offset:4040
  v_mfma_f32_16x16x32_bf16 v[48:51], v[212:215], v[228:231], v[48:51]
  v_mfma_f32_16x16x32_bf16 v[44:47], v[212:215], v[180:183], v[44:47]
  v_mfma_f32_16x16x32_bf16 v[52:55], v[212:215], v[216:219], v[52:55]
  s_waitcnt lgkmcnt(11)
  v_mfma_f32_16x16x32_bf16 v[48:51], v[200:203], v[192:195], v[48:51]
  v_mfma_f32_16x16x32_bf16 v[44:47], v[124:127], v[192:195], v[44:47]
  v_mfma_f32_16x16x32_bf16 v[52:55], v[204:207], v[192:195], v[52:55]
  v_mfma_f32_16x16x32_bf16 v[56:59], v[212:215], v[192:195], v[56:59]
  s_waitcnt lgkmcnt(9)
  v_mfma_f32_16x16x32_bf16 v[44:47], v[188:191], v[160:163], v[44:47]
  v_mfma_f32_16x16x32_bf16 v[48:51], v[188:191], v[180:183], v[48:51]
  v_mfma_f32_16x16x32_bf16 v[52:55], v[188:191], v[228:231], v[52:55]
  v_mfma_f32_16x16x32_bf16 v[56:59], v[188:191], v[216:219], v[56:59]
  s_waitcnt lgkmcnt(8)
  v_mfma_f32_16x16x32_bf16 v[48:51], v[124:127], v[152:155], v[48:51]
  v_mfma_f32_16x16x32_bf16 v[52:55], v[200:203], v[152:155], v[52:55]
  v_mfma_f32_16x16x32_bf16 v[56:59], v[204:207], v[152:155], v[56:59]
  s_waitcnt lgkmcnt(6)
  v_mfma_f32_16x16x32_bf16 v[48:51], v[224:227], v[160:163], v[48:51]
  v_mfma_f32_16x16x32_bf16 v[52:55], v[224:227], v[180:183], v[52:55]
  v_mfma_f32_16x16x32_bf16 v[56:59], v[224:227], v[228:231], v[56:59]
  s_waitcnt lgkmcnt(5)
  v_mfma_f32_16x16x32_bf16 v[52:55], v[124:127], v[176:179], v[52:55]
  v_mfma_f32_16x16x32_bf16 v[56:59], v[200:203], v[176:179], v[56:59]
  s_waitcnt lgkmcnt(3)
  v_mfma_f32_16x16x32_bf16 v[52:55], v[168:171], v[160:163], v[52:55]
  v_mfma_f32_16x16x32_bf16 v[56:59], v[168:171], v[180:183], v[56:59]
  s_waitcnt lgkmcnt(2)
  v_mfma_f32_16x16x32_bf16 v[56:59], v[124:127], v[136:139], v[56:59]
  s_waitcnt lgkmcnt(0)
  v_mfma_f32_16x16x32_bf16 v[56:59], v[232:235], v[160:163], v[56:59]
  v_cvt_pk_bf16_f32 v28, v28, v29
  v_cvt_pk_bf16_f32 v29, v30, v31
  ds_write_b64 v96, v[28:29] offset:0
  v_cvt_pk_bf16_f32 v32, v32, v33
  v_cvt_pk_bf16_f32 v33, v34, v35
  ds_write_b64 v96, v[32:33] offset:512
  v_cvt_pk_bf16_f32 v36, v36, v37
  v_cvt_pk_bf16_f32 v37, v38, v39
  ds_write_b64 v96, v[36:37] offset:1024
  v_cvt_pk_bf16_f32 v40, v40, v41
  v_cvt_pk_bf16_f32 v41, v42, v43
  ds_write_b64 v96, v[40:41] offset:1536
  v_cvt_pk_bf16_f32 v44, v44, v45
  v_cvt_pk_bf16_f32 v45, v46, v47
  ds_write_b64 v96, v[44:45] offset:2048
  v_cvt_pk_bf16_f32 v48, v48, v49
  v_cvt_pk_bf16_f32 v49, v50, v51
  ds_write_b64 v96, v[48:49] offset:2560
  v_cvt_pk_bf16_f32 v52, v52, v53
  v_cvt_pk_bf16_f32 v53, v54, v55
  ds_write_b64 v96, v[52:53] offset:3072
  v_cvt_pk_bf16_f32 v56, v56, v57
  v_cvt_pk_bf16_f32 v57, v58, v59
  ds_write_b64 v96, v[56:57] offset:3584
  v_mov_b32 v11, 1
  ds_write_b32 v21, v11
  s_mov_b32 s37, 0x100000
fr_ep:
  ds_read_b32 v10, v22
  s_waitcnt lgkmcnt(0)
  v_cmp_ne_u32 vcc, 1, v10
  s_cbranch_vccz fr_epd
  s_sub_u32 s37, s37, 1
  s_cbranch_scc0 fr_ep
fr_epd:
  ds_read_b64_tr_b16 v[64:65], v97 offset:0
  ds_read_b64_tr_b16 v[66:67], v97 offset:128
  ds_read_b64_tr_b16 v[68:69], v97 offset:256
  ds_read_b64_tr_b16 v[70:71], v97 offset:384
  ds_read_b64_tr_b16 v[72:73], v97 offset:512
  ds_read_b64_tr_b16 v[74:75], v97 offset:640
  ds_read_b64_tr_b16 v[76:77], v97 offset:768
  ds_read_b64_tr_b16 v[78:79], v97 offset:896
  s_add_u32 s24, s32, 0
  s_waitcnt lgkmcnt(7)
  buffer_store_dwordx2 v[64:65], v98, s[8:11], s24 offen sc1
  s_add_u32 s25, s32, 73728
  s_waitcnt lgkmcnt(6)
  buffer_store_dwordx2 v[66:67], v98, s[8:11], s25 offen sc1
  s_add_u32 s24, s32, 147456
  s_waitcnt lgkmcnt(5)
  buffer_store_dwordx2 v[68:69], v98, s[8:11], s24 offen sc1
  s_add_u32 s25, s32, 221184
  s_waitcnt lgkmcnt(4)
  buffer_store_dwordx2 v[70:71], v98, s[8:11], s25 offen sc1
  s_add_u32 s24, s32, 294912
  s_waitcnt lgkmcnt(3)
  buffer_store_dwordx2 v[72:73], v98, s[8:11], s24 offen sc1
  s_add_u32 s25, s32, 368640
  s_waitcnt lgkmcnt(2)
  buffer_store_dwordx2 v[74:75], v98, s[8:11], s25 offen sc1
  s_add_u32 s24, s32, 442368
  s_waitcnt lgkmcnt(1)
  buffer_store_dwordx2 v[76:77], v98, s[8:11], s24 offen sc1
  s_add_u32 s25, s32, 516096
  s_waitcnt lgkmcnt(0)
  buffer_store_dwordx2 v[78:79], v98, s[8:11], s25 offen sc1
  s_mov_b32 s39, 0
  s_branch per_entry
.p2align 6
fr_rl:
  s_cmp_ge_u32 s2, 256
  s_cbranch_scc1 fr_end
  s_load_dwordx4 s[44:47], s[0:1], 88
  s_memrealtime s[40:41]
  s_waitcnt lgkmcnt(0)
  s_load_dwordx4 s[12:15], s[0:1], 56
  s_load_dwordx2 s[20:21], s[0:1], 72
  s_mov_b32 s8, s46
  s_mov_b32 s9, s47
  s_mov_b32 s46, 256
  s_mov_b32 s47, 131072
  s_cmp_lg_u32 s2, 144
  s_cbranch_scc1 fr_nl
  s_mov_b32 s46, 256
  s_mov_b32 s47, 131072
  s_or_b32 s41, s41, 1073741824
  s_or_b32 s40, s40, 1
  v_mov_b32 v2, s40
  v_mov_b32 v3, s41
  v_mov_b32 v4, 0
  v_cmp_eq_u32 vcc, 0, v0
  s_nop 1
  s_and_saveexec_b64 s[42:43], vcc
  s_cbranch_execz fr_nl2
  buffer_store_dwordx2 v[2:3], v4, s[44:47], 0 offen sc1
fr_nl2:
  s_mov_b64 exec, -1
fr_nl:
  v_lshrrev_b32 v1, 6, v0
  s_nop 0
  v_readfirstlane_b32 s3, v1
  s_sub_u32 s4, s2, 144
  s_lshr_b32 s4, s4, 3
  s_mov_b32 s10, 268435456
  s_mov_b32 s11, 131072
  s_sub_u32 s36, s2, 144
  s_lshl_b32 s36, s36, 13
  s_add_u32 s36, s36, 69206016
  v_lshlrev_b32 v8, 4, v0
  s_sub_u32 s6, 7, s3
  s_mul_i32 s6, s6, 14
  v_mov_b32 v4, 0
  s_add_u32 s6, s6, s4
  s_mul_i32 s5, s3, 9216
  v_and_b32 v217, 63, v0
  v_lshlrev_b32 v216, 4, v217
  v_lshrrev_b32 v218, 3, v217
  v_and_b32 v219, 7, v217
  v_lshrrev_b32 v220, 4, v217
  v_bfe_u32 v221, v217, 2, 2
  v_lshl_add_u32 v220, v220, 3, v221
  v_and_b32 v221, 3, v217
  v_mul_u32_u24 v207, 9216, v218
  v_lshl_add_u32 v207, v219, 4, v207
  v_mul_u32_u24 v209, 264, v218
  v_lshl_add_u32 v209, v219, 5, v209
  v_add_u32 v209, s5, v209
  v_mul_u32_u24 v210, 264, v220
  v_lshl_add_u32 v210, v221, 5, v210
  v_add_u32 v210, s5, v210
  v_add_u32 v213, 2112, v209
  v_add_u32 v214, 4224, v209
  v_add_u32 v215, 6336, v209
  s_and_b32 s24, s2, 7
  s_mul_i32 s24, s24, 9
  s_add_u32 s27, s6, 0
  s_mul_i32 s25, s27, 7282
  s_lshr_b32 s25, s25, 16
  s_mul_i32 s26, s25, 9
  s_sub_u32 s26, s27, s26
  s_add_u32 s26, s26, s24
  s_mul_i32 s48, s25, 294912
  s_lshl_b32 s27, s26, 7
  s_add_u32 s48, s48, s27
  s_mul_i32 s27, s26, 36
  s_add_u32 s27, s27, s25
  s_lshl_b32 s27, s27, 12
  s_add_u32 s49, s27, 12582912
  s_add_u32 s27, s6, 112
  s_mul_i32 s25, s27, 7282
  s_lshr_b32 s25, s25, 16
  s_mul_i32 s26, s25, 9
  s_sub_u32 s26, s27, s26
  s_add_u32 s26, s26, s24
  s_mul_i32 s50, s25, 294912
  s_lshl_b32 s27, s26, 7
  s_add_u32 s50, s50, s27
  s_mul_i32 s27, s26, 36
  s_add_u32 s27, s27, s25
  s_lshl_b32 s27, s27, 12
  s_add_u32 s51, s27, 12582912
  s_waitcnt lgkmcnt(0)
  s_mov_b32 s16, s14
  s_mov_b32 s17, s15
  s_mov_b32 s18, 5308416
  s_mov_b32 s19, 131072
  s_mov_b32 s14, 5308416
  s_mov_b32 s15, 131072
  s_mov_b32 s22, 5308416
  s_mov_b32 s23, 131072
  buffer_load_dwordx4 v[236:239], v8, s[8:11], s36 offen sc1
  s_waitcnt vmcnt(0)
  s_cmp_ge_u32 s6, 50
  s_cbranch_scc1 fr_r_v1
  s_add_u32 s28, s48, 0
  buffer_load_dwordx4 v[16:19], v207, s[12:15], s28 offen nt
  buffer_load_dwordx4 v[32:35], v207, s[16:19], s28 offen nt
  s_add_u32 s29, s48, 73728
  buffer_load_dwordx4 v[20:23], v207, s[12:15], s29 offen nt
  buffer_load_dwordx4 v[36:39], v207, s[16:19], s29 offen nt
  s_add_u32 s28, s48, 147456
  buffer_load_dwordx4 v[24:27], v207, s[12:15], s28 offen nt
  buffer_load_dwordx4 v[40:43], v207, s[16:19], s28 offen nt
  s_add_u32 s29, s48, 221184
  buffer_load_dwordx4 v[28:31], v207, s[12:15], s29 offen nt
  buffer_load_dwordx4 v[44:47], v207, s[16:19], s29 offen nt
  s_add_u32 s28, s50, 0
  buffer_load_dwordx4 v[48:51], v207, s[12:15], s28 offen nt
  buffer_load_dwordx4 v[64:67], v207, s[16:19], s28 offen nt
  s_add_u32 s29, s50, 73728
  buffer_load_dwordx4 v[52:55], v207, s[12:15], s29 offen nt
  buffer_load_dwordx4 v[68:71], v207, s[16:19], s29 offen nt
  s_add_u32 s28, s50, 147456
  buffer_load_dwordx4 v[56:59], v207, s[12:15], s28 offen nt
  buffer_load_dwordx4 v[72:75], v207, s[16:19], s28 offen nt
  s_add_u32 s29, s50, 221184
  buffer_load_dwordx4 v[60:63], v207, s[12:15], s29 offen nt
  buffer_load_dwordx4 v[76:79], v207, s[16:19], s29 offen nt
  s_load_dwordx2 s[32:33], s[0:1], 0
  s_and_b32 s24, s2, 240
  s_and_b32 s25, s2, 7
  s_lshl_b32 s25, s25, 1
  s_add_u32 s24, s24, s25
  s_bfe_u32 s25, s2, 65539
  s_add_u32 s24, s24, s25
  s_mul_i32 s24, s24, 9216
  s_and_b32 s25, s3, 3
  s_mul_i32 s25, s25, 2304
  s_add_u32 s24, s24, s25
  v_add_u32 v220, s24, v216
  s_mov_b32 s34, 2359296
  s_mov_b32 s35, 131072
  s_waitcnt lgkmcnt(0)
  buffer_load_dwordx4 v[224:227], v220, s[32:35], 0 offen offset:0
  buffer_load_dwordx4 v[228:231], v220, s[32:35], 0 offen offset:1024
  buffer_load_dwordx4 v[232:235], v220, s[32:35], 0 offen offset:1280
  s_cmp_lg_u32 s3, 0
  s_cbranch_scc1 fr_r_m0a
  buffer_load_dwordx2 v[2:3], v4, s[44:47], 0 offen sc1
fr_r_m0a:
  s_waitcnt vmcnt(17)
  ds_write2_b32 v209, v16, v32 offset0:0 offset1:1
  ds_write2_b32 v209, v17, v33 offset0:2 offset1:3
  ds_write2_b32 v209, v18, v34 offset0:4 offset1:5
  ds_write2_b32 v209, v19, v35 offset0:6 offset1:7
  s_waitcnt vmcnt(15)
  ds_write2_b32 v213, v20, v36 offset0:0 offset1:1
  ds_write2_b32 v213, v21, v37 offset0:2 offset1:3
  ds_write2_b32 v213, v22, v38 offset0:4 offset1:5
  ds_write2_b32 v213, v23, v39 offset0:6 offset1:7
  s_waitcnt vmcnt(13)
  ds_write2_b32 v214, v24, v40 offset0:0 offset1:1
  ds_write2_b32 v214, v25, v41 offset0:2 offset1:3
  ds_write2_b32 v214, v26, v42 offset0:4 offset1:5
  ds_write2_b32 v214, v27, v43 offset0:6 offset1:7
  s_waitcnt vmcnt(11)
  ds_write2_b32 v215, v28, v44 offset0:0 offset1:1
  ds_write2_b32 v215, v29, v45 offset0:2 offset1:3
  ds_write2_b32 v215, v30, v46 offset0:4 offset1:5
  ds_write2_b32 v215, v31, v47 offset0:6 offset1:7
  ds_read_b64_tr_b16 v[80:81], v210 offset:0
  ds_read_b64_tr_b16 v[82:83], v210 offset:1056
  ds_read_b64_tr_b16 v[84:85], v210 offset:8
  ds_read_b64_tr_b16 v[86:87], v210 offset:1064
  ds_read_b64_tr_b16 v[88:89], v210 offset:16
  ds_read_b64_tr_b16 v[90:91], v210 offset:1072
  ds_read_b64_tr_b16 v[92:93], v210 offset:24
  ds_read_b64_tr_b16 v[94:95], v210 offset:1080
  ds_read_b64_tr_b16 v[96:97], v210 offset:128
  ds_read_b64_tr_b16 v[98:99], v210 offset:1184
  ds_read_b64_tr_b16 v[100:101], v210 offset:136
  ds_read_b64_tr_b16 v[102:103], v210 offset:1192
  ds_read_b64_tr_b16 v[104:105], v210 offset:144
  ds_read_b64_tr_b16 v[106:107], v210 offset:1200
  ds_read_b64_tr_b16 v[108:109], v210 offset:152
  ds_read_b64_tr_b16 v[110:111], v210 offset:1208
  s_add_u32 s30, s49, 73728
  s_waitcnt lgkmcnt(14)
  buffer_store_dwordx4 v[80:83], v216, s[8:11], s49 offen offset:0 sc1
  s_waitcnt lgkmcnt(12)
  buffer_store_dwordx4 v[84:87], v216, s[8:11], s49 offen offset:1024 sc1
  s_waitcnt lgkmcnt(10)
  buffer_store_dwordx4 v[88:91], v216, s[8:11], s49 offen offset:2048 sc1
  s_waitcnt lgkmcnt(8)
  buffer_store_dwordx4 v[92:95], v216, s[8:11], s49 offen offset:3072 sc1
  s_waitcnt lgkmcnt(6)
  buffer_store_dwordx4 v[96:99], v216, s[8:11], s30 offen offset:0 sc1
  s_waitcnt lgkmcnt(4)
  buffer_store_dwordx4 v[100:103], v216, s[8:11], s30 offen offset:1024 sc1
  s_waitcnt lgkmcnt(2)
  buffer_store_dwordx4 v[104:107], v216, s[8:11], s30 offen offset:2048 sc1
  s_waitcnt lgkmcnt(0)
  buffer_store_dwordx4 v[108:111], v216, s[8:11], s30 offen offset:3072 sc1
  s_cmp_lg_u32 s3, 0
  s_cbranch_scc1 fr_r_m0c
  s_waitcnt vmcnt(8)
  s_mov_b32 s43, 0x40000
fr_r_m0l:
  v_cmp_eq_u32 vcc, 0, v2
  s_cbranch_vccz fr_r_m0b
  buffer_load_dwordx2 v[2:3], v4, s[44:47], 0 offen sc1
  s_waitcnt vmcnt(0)
  s_sub_u32 s43, s43, 1
  s_cbranch_scc0 fr_r_m0l
fr_r_m0b:
  v_mov_b32 v5, 161828
  ds_write_b32 v5, v4
  ds_write_b64 v5, v[2:3] offset:4
  s_waitcnt lgkmcnt(0)
fr_r_m0c:
  s_barrier
  s_waitcnt vmcnt(17)
  ds_write2_b32 v209, v48, v64 offset0:0 offset1:1
  ds_write2_b32 v209, v49, v65 offset0:2 offset1:3
  ds_write2_b32 v209, v50, v66 offset0:4 offset1:5
  ds_write2_b32 v209, v51, v67 offset0:6 offset1:7
  s_waitcnt vmcnt(15)
  ds_write2_b32 v213, v52, v68 offset0:0 offset1:1
  ds_write2_b32 v213, v53, v69 offset0:2 offset1:3
  ds_write2_b32 v213, v54, v70 offset0:4 offset1:5
  ds_write2_b32 v213, v55, v71 offset0:6 offset1:7
  s_waitcnt vmcnt(13)
  ds_write2_b32 v214, v56, v72 offset0:0 offset1:1
  ds_write2_b32 v214, v57, v73 offset0:2 offset1:3
  ds_write2_b32 v214, v58, v74 offset0:4 offset1:5
  ds_write2_b32 v214, v59, v75 offset0:6 offset1:7
  s_waitcnt vmcnt(11)
  ds_write2_b32 v215, v60, v76 offset0:0 offset1:1
  ds_write2_b32 v215, v61, v77 offset0:2 offset1:3
  ds_write2_b32 v215, v62, v78 offset0:4 offset1:5
  ds_write2_b32 v215, v63, v79 offset0:6 offset1:7
  ds_read_b64_tr_b16 v[112:113], v210 offset:0
  ds_read_b64_tr_b16 v[114:115], v210 offset:1056
  ds_read_b64_tr_b16 v[116:117], v210 offset:8
  ds_read_b64_tr_b16 v[118:119], v210 offset:1064
  ds_read_b64_tr_b16 v[120:121], v210 offset:16
  ds_read_b64_tr_b16 v[122:123], v210 offset:1072
  ds_read_b64_tr_b16 v[124:125], v210 offset:24
  ds_read_b64_tr_b16 v[126:127], v210 offset:1080
  ds_read_b64_tr_b16 v[128:129], v210 offset:128
  ds_read_b64_tr_b16 v[130:131], v210 offset:1184
  ds_read_b64_tr_b16 v[132:133], v210 offset:136
  ds_read_b64_tr_b16 v[134:135], v210 offset:1192
  ds_read_b64_tr_b16 v[136:137], v210 offset:144
  ds_read_b64_tr_b16 v[138:139], v210 offset:1200
  ds_read_b64_tr_b16 v[140:141], v210 offset:152
  ds_read_b64_tr_b16 v[142:143], v210 offset:1208
  s_add_u32 s30, s51, 73728
  s_waitcnt lgkmcnt(14)
  buffer_store_dwordx4 v[112:115], v216, s[8:11], s51 offen offset:0 sc1
  s_waitcnt lgkmcnt(12)
  buffer_store_dwordx4 v[116:119], v216, s[8:11], s51 offen offset:1024 sc1
  s_waitcnt lgkmcnt(10)
  buffer_store_dwordx4 v[120:123], v216, s[8:11], s51 offen offset:2048 sc1
  s_waitcnt lgkmcnt(8)
  buffer_store_dwordx4 v[124:127], v216, s[8:11], s51 offen offset:3072 sc1
  s_waitcnt lgkmcnt(6)
  buffer_store_dwordx4 v[128:131], v216, s[8:11], s30 offen offset:0 sc1
  s_waitcnt lgkmcnt(4)
  buffer_store_dwordx4 v[132:135], v216, s[8:11], s30 offen offset:1024 sc1
  s_waitcnt lgkmcnt(2)
  buffer_store_dwordx4 v[136:139], v216, s[8:11], s30 offen offset:2048 sc1
  s_waitcnt lgkmcnt(0)
  buffer_store_dwordx4 v[140:143], v216, s[8:11], s30 offen offset:3072 sc1
  s_waitcnt vmcnt(16)
  s_mov_b32 s39, 0
  s_branch per_entry
fr_r_v1:
  s_add_u32 s28, s48, 0
  buffer_load_dwordx4 v[16:19], v207, s[12:15], s28 offen nt
  buffer_load_dwordx4 v[32:35], v207, s[16:19], s28 offen nt
  s_add_u32 s29, s48, 73728
  buffer_load_dwordx4 v[20:23], v207, s[12:15], s29 offen nt
  buffer_load_dwordx4 v[36:39], v207, s[16:19], s29 offen nt
  s_add_u32 s28, s48, 147456
  buffer_load_dwordx4 v[24:27], v207, s[12:15], s28 offen nt
  buffer_load_dwordx4 v[40:43], v207, s[16:19], s28 offen nt
  s_add_u32 s29, s48, 221184
  buffer_load_dwordx4 v[28:31], v207, s[12:15], s29 offen nt
  buffer_load_dwordx4 v[44:47], v207, s[16:19], s29 offen nt
  s_load_dwordx2 s[32:33], s[0:1], 0
  s_and_b32 s24, s2, 240
  s_and_b32 s25, s2, 7
  s_lshl_b32 s25, s25, 1
  s_add_u32 s24, s24, s25
  s_bfe_u32 s25, s2, 65539
  s_add_u32 s24, s24, s25
  s_mul_i32 s24, s24, 9216
  s_and_b32 s25, s3, 3
  s_mul_i32 s25, s25, 2304
  s_add_u32 s24, s24, s25
  v_add_u32 v220, s24, v216
  s_mov_b32 s34, 2359296
  s_mov_b32 s35, 131072
  s_waitcnt lgkmcnt(0)
  buffer_load_dwordx4 v[224:227], v220, s[32:35], 0 offen offset:0
  buffer_load_dwordx4 v[228:231], v220, s[32:35], 0 offen offset:1024
  buffer_load_dwordx4 v[232:235], v220, s[32:35], 0 offen offset:1280
  s_cmp_lg_u32 s3, 0
  s_cbranch_scc1 fr_r_m1a
  buffer_load_dwordx2 v[2:3], v4, s[44:47], 0 offen sc1
fr_r_m1a:
  s_waitcnt vmcnt(9)
  ds_write2_b32 v209, v16, v32 offset0:0 offset1:1
  ds_write2_b32 v209, v17, v33 offset0:2 offset1:3
  ds_write2_b32 v209, v18, v34 offset0:4 offset1:5
  ds_write2_b32 v209, v19, v35 offset0:6 offset1:7
  s_waitcnt vmcnt(7)
  ds_write2_b32 v213, v20, v36 offset0:0 offset1:1
  ds_write2_b32 v213, v21, v37 offset0:2 offset1:3
  ds_write2_b32 v213, v22, v38 offset0:4 offset1:5
  ds_write2_b32 v213, v23, v39 offset0:6 offset1:7
  s_waitcnt vmcnt(5)
  ds_write2_b32 v214, v24, v40 offset0:0 offset1:1
  ds_write2_b32 v214, v25, v41 offset0:2 offset1:3
  ds_write2_b32 v214, v26, v42 offset0:4 offset1:5
  ds_write2_b32 v214, v27, v43 offset0:6 offset1:7
  s_waitcnt vmcnt(3)
  ds_write2_b32 v215, v28, v44 offset0:0 offset1:1
  ds_write2_b32 v215, v29, v45 offset0:2 offset1:3
  ds_write2_b32 v215, v30, v46 offset0:4 offset1:5
  ds_write2_b32 v215, v31, v47 offset0:6 offset1:7
  ds_read_b64_tr_b16 v[80:81], v210 offset:0
  ds_read_b64_tr_b16 v[82:83], v210 offset:1056
  ds_read_b64_tr_b16 v[84:85], v210 offset:8
  ds_read_b64_tr_b16 v[86:87], v210 offset:1064
  ds_read_b64_tr_b16 v[88:89], v210 offset:16
  ds_read_b64_tr_b16 v[90:91], v210 offset:1072
  ds_read_b64_tr_b16 v[92:93], v210 offset:24
  ds_read_b64_tr_b16 v[94:95], v210 offset:1080
  ds_read_b64_tr_b16 v[96:97], v210 offset:128
  ds_read_b64_tr_b16 v[98:99], v210 offset:1184
  ds_read_b64_tr_b16 v[100:101], v210 offset:136
  ds_read_b64_tr_b16 v[102:103], v210 offset:1192
  ds_read_b64_tr_b16 v[104:105], v210 offset:144
  ds_read_b64_tr_b16 v[106:107], v210 offset:1200
  ds_read_b64_tr_b16 v[108:109], v210 offset:152
  ds_read_b64_tr_b16 v[110:111], v210 offset:1208
  s_add_u32 s30, s49, 73728
  s_waitcnt lgkmcnt(14)
  buffer_store_dwordx4 v[80:83], v216, s[8:11], s49 offen offset:0 sc1
  s_waitcnt lgkmcnt(12)
  buffer_store_dwordx4 v[84:87], v216, s[8:11], s49 offen offset:1024 sc1
  s_waitcnt lgkmcnt(10)
  buffer_store_dwordx4 v[88:91], v216, s[8:11], s49 offen offset:2048 sc1
  s_waitcnt lgkmcnt(8)
  buffer_store_dwordx4 v[92:95], v216, s[8:11], s49 offen offset:3072 sc1
  s_waitcnt lgkmcnt(6)
  buffer_store_dwordx4 v[96:99], v216, s[8:11], s30 offen offset:0 sc1
  s_waitcnt lgkmcnt(4)
  buffer_store_dwordx4 v[100:103], v216, s[8:11], s30 offen offset:1024 sc1
  s_waitcnt lgkmcnt(2)
  buffer_store_dwordx4 v[104:107], v216, s[8:11], s30 offen offset:2048 sc1
  s_waitcnt lgkmcnt(0)
  buffer_store_dwordx4 v[108:111], v216, s[8:11], s30 offen offset:3072 sc1
  s_cmp_lg_u32 s3, 0
  s_cbranch_scc1 fr_r_m1c
  s_waitcnt vmcnt(8)
  s_mov_b32 s43, 0x40000
fr_r_m1l:
  v_cmp_eq_u32 vcc, 0, v2
  s_cbranch_vccz fr_r_m1b
  buffer_load_dwordx2 v[2:3], v4, s[44:47], 0 offen sc1
  s_waitcnt vmcnt(0)
  s_sub_u32 s43, s43, 1
  s_cbranch_scc0 fr_r_m1l
fr_r_m1b:
  v_mov_b32 v5, 161828
  ds_write_b32 v5, v4
  ds_write_b64 v5, v[2:3] offset:4
  s_waitcnt lgkmcnt(0)
fr_r_m1c:
  s_barrier
  s_waitcnt vmcnt(8)
  s_mov_b32 s39, 0
  s_branch per_entry
fr_end:
  s_waitcnt vmcnt(0) lgkmcnt(0)
  s_endpgm
per_entry:
  s_setprio 0
  s_load_dwordx2 s[48:49], s[0:1], 0
  v_mov_b32 v7, 161832
  ds_read_b64 v[8:9], v7
  v_mbcnt_lo_u32_b32 v0, -1, 0
  v_mbcnt_hi_u32_b32 v0, -1, v0
  s_lshl_b32 s6, s3, 6
  v_add_u32 v0, s6, v0
  v_lshrrev_b32 v4, 6, v0
  v_and_b32 v5, 63, v0
  v_lshlrev_b32 v228, 4, v0
  v_lshlrev_b32 v6, 2, v0
  v_lshlrev_b32 v0, 4, v5
  v_and_b32 v90, 3, v5
  v_bfe_u32 v91, v5, 2, 2
  v_lshrrev_b32 v92, 4, v5
  v_and_b32 v93, 1, v92
  v_lshrrev_b32 v94, 1, v92
  s_mov_b32 s10, 268435456
  s_mov_b32 s11, 131072
  s_and_b32 s4, s2, 7
  s_bfe_u32 s12, s2, 65539
  s_lshr_b32 s5, s2, 4
  s_lshl_b32 s46, s12, 3
  s_add_u32 s46, s46, s3
  s_lshl_b32 s42, s2, 3
  s_add_u32 s42, s42, s3
  s_mul_i32 s42, s42, 3072
  s_add_u32 s42, s42, 71303168
  v_and_b32 v192, 36, v5
  v_lshrrev_b32 v193, 1, v5
  v_and_b32 v193, 12, v193
  v_or_b32 v193, v193, v90
  v_lshlrev_b32 v193, 4, v193
  v_lshl_add_u32 v229, v192, 26, v193
  v_and_b32 v192, 15, v5
  v_lshlrev_b32 v98, 4, v192
  v_lshl_add_u32 v98, v94, 8, v98
  v_mul_u32_u24 v192, 576, v93
  v_add_u32 v98, v98, v192
  v_lshrrev_b32 v192, 1, v91
  v_mul_u32_u24 v192, 576, v192
  v_lshl_add_u32 v192, v90, 4, v192
  v_lshl_add_u32 v192, v93, 3, v192
  v_add_u32 v192, 512, v192
  v_and_b32 v193, 36, v5
  v_lshl_add_u32 v99, v193, 24, v192
  s_mov_b32 s50, 2359296
  s_mov_b32 s51, 131072
  s_lshl_b32 s47, s5, 3
  s_add_u32 s47, s47, s4
  s_lshl_b32 s52, s47, 4
  s_add_u32 s52, s52, s46
  s_mul_i32 s52, s52, 1152
  v_xor_b32 v192, v90, v92
  v_lshlrev_b32 v192, 4, v192
  v_lshrrev_b32 v193, 2, v5
  v_lshl_add_u32 v220, v193, 7, v192
  s_mul_i32 s47, s47, 18432
  s_lshl_b32 s7, s12, 6
  s_add_u32 s47, s47, s7
  s_add_u32 s47, s47, 2359296
  s_lshl_b32 s7, s3, 11
  s_add_u32 s6, s47, s7
  s_add_u32 s47, s47, 16384
  s_lshl_b32 s7, s3, 10
  s_waitcnt lgkmcnt(0)
  v_readfirstlane_b32 s96, v8
  v_readfirstlane_b32 s97, v9
  buffer_load_dwordx4 v[136:139], v98, s[48:51], s52 offen
  buffer_load_dwordx2 v[140:141], v99, s[48:51], s52 offen
  s_mov_b32 s13, s6
  s_mov_b32 s14, s7
  v_mov_b32 v7, 0
  v_add_u32 v251, 147456, v6
  ds_write_b32 v251, v7
  s_mov_b32 s57, 0
  s_mov_b32 s53, 69206016
  s_lshl_b32 s43, s2, 7
  s_add_u32 s43, s43, 69271552
  s_lshl_b32 s44, s5, 11
  s_add_u32 s44, s44, 69271552
  s_mul_i32 s45, s5, 147456
  s_lshl_b32 s7, s4, 10
  s_add_u32 s45, s45, s7
  s_lshl_b32 s7, s12, 7
  s_add_u32 s45, s45, s7
  s_lshl_b32 s7, s3, 14
  s_add_u32 s45, s45, s7
  s_add_u32 s45, s45, 9437184
  v_lshrrev_b32 v192, 3, v5
  v_and_b32 v193, 7, v5
  v_xor_b32 v193, v193, v192
  v_lshlrev_b32 v216, 4, v193
  v_and_b32 v193, 3, v192
  v_lshl_add_u32 v216, v193, 8, v216
  v_lshl_add_u32 v216, v94, 13, v216
  s_lshl_b32 s7, s3, 10
  s_add_u32 s7, s7, 16384
  v_add_u32 v217, s7, v0
  v_and_b32 v192, 15, v5
  v_lshl_add_u32 v192, v94, 4, v192
  v_mad_u32_u24 v192, v93, 36, v192
  v_and_b32 v193, 7, v192
  v_xor_b32 v193, s3, v193
  v_lshlrev_b32 v193, 4, v193
  v_lshl_add_u32 v218, v192, 7, v193
  v_add_u32 v218, 16384, v218
  v_lshrrev_b32 v192, 1, v91
  v_mad_u32_u24 v192, v192, 36, v90
  v_and_b32 v193, 7, v192
  v_xor_b32 v193, s3, v193
  v_lshlrev_b32 v193, 4, v193
  v_lshl_add_u32 v219, v192, 7, v193
  v_lshl_add_u32 v219, v93, 3, v219
  v_add_u32 v219, 20480, v219
  s_lshr_b32 s6, s3, 1
  s_and_b32 s7, s3, 1
  s_lshl_b32 s7, s7, 3
  s_add_u32 s7, s7, 0
  v_lshl_add_u32 v192, v90, 1, v93
  v_lshl_add_u32 v193, v91, 3, v192
  v_lshl_add_u32 v193, v94, 5, v193
  v_bfe_u32 v222, v193, 2, 2
  v_xor_b32 v222, s6, v222
  v_lshlrev_b32 v222, 4, v222
  v_lshl_add_u32 v221, v193, 6, v222
  v_add_u32 v221, s7, v221
  v_xor_b32 v222, 32, v221
  v_lshrrev_b32 v193, 1, v91
  v_mad_u32_u24 v193, v193, 36, v90
  v_lshl_add_u32 v193, v193, 1, v93
  v_bfe_u32 v223, v193, 2, 2
  v_xor_b32 v223, s6, v223
  v_lshlrev_b32 v223, 4, v223
  v_lshl_add_u32 v223, v193, 6, v223
  v_add_u32 v223, s7, v223
  v_mov_b32 v142, 0
  v_mov_b32 v143, 0
  s_and_b32 s6, s3, 4
  s_add_u32 s7, s6, 161824
  v_mov_b32 v8, s7
  v_mov_b32 v9, 1
  v_mov_b32 v10, s96
  v_mov_b32 v11, 0
  s_lshl_b32 s6, s6, 13
  s_lshl_b32 s7, s2, 7
  s_add_u32 s6, s6, s7
  s_add_u32 s6, s6, 70123520
  s_lshl_b32 s6, s2, 7
  s_add_u32 s6, s6, 7077888
  v_mul_u32_u24 v11, 18432, v5
  s_cmp_ge_u32 s3, 4
  s_mov_b32 s30, 1048576
  s_cselect_b32 s30, s30, 196623
  s_cmp_ge_u32 s2, 144
  s_cselect_b32 s30, 458753, s30
  s_cselect_b32 s7, 63078400, 0
  s_add_u32 s6, s6, s7
  s_cmp_ge_u32 s2, 144
  s_cselect_b32 s7, 4, 0
  s_add_u32 s7, s7, 161824
  v_mov_b32 v8, s7
  s_waitcnt lgkmcnt(0)
  s_waitcnt vmcnt(2)
  s_bfe_u32 s7, s30, 0x10014
  s_cbranch_scc1 per_entry_g1
  s_mov_b64 exec, 1
  ds_add_rtn_u32 v8, v8, v9
  s_lshr_b32 s7, s30, 16
  s_waitcnt lgkmcnt(0)
  v_and_b32 v8, 0xff, v8
  v_cmp_eq_u32 vcc, s7, v8
  s_cbranch_vccz per_entry_g0
  s_and_b32 exec_lo, s30, 0xffff
  buffer_store_dword v10, v11, s[8:11], s6 offen sc1
per_entry_g0:
  s_mov_b64 exec, -1
per_entry_g1:
  s_waitcnt vmcnt(1)
  v_permlane16_swap_b32 v136, v138
  v_permlane16_swap_b32 v137, v139
  v_lshlrev_b32 v168, 16, v136
  v_and_b32 v169, 4294901760, v136
  v_lshlrev_b32 v170, 16, v137
  v_and_b32 v171, 4294901760, v137
  v_lshlrev_b32 v172, 16, v138
  v_and_b32 v173, 4294901760, v138
  v_lshlrev_b32 v174, 16, v139
  v_and_b32 v175, 4294901760, v139
  s_waitcnt vmcnt(0)
  v_lshlrev_b32 v176, 16, v140
  v_and_b32 v177, 4294901760, v140
  v_lshlrev_b32 v178, 16, v141
  v_and_b32 v179, 4294901760, v141
  v_pk_add_f32 v[192:193], v[168:169], v[170:171]
  v_pk_mul_f32 v[196:197], v[168:169], v[168:169]
  v_pk_add_f32 v[194:195], v[172:173], v[174:175]
  v_pk_mul_f32 v[198:199], v[170:171], v[170:171]
  v_pk_add_f32 v[192:193], v[192:193], v[176:177]
  v_pk_fma_f32 v[196:197], v[172:173], v[172:173], v[196:197]
  v_pk_add_f32 v[194:195], v[194:195], v[178:179]
  v_pk_fma_f32 v[198:199], v[174:175], v[174:175], v[198:199]
  v_pk_fma_f32 v[196:197], v[176:177], v[176:177], v[196:197]
  v_pk_fma_f32 v[198:199], v[178:179], v[178:179], v[198:199]
  v_pk_add_f32 v[192:193], v[192:193], v[194:195]
  v_pk_add_f32 v[196:197], v[196:197], v[198:199]
  v_add_f32 v202, v192, v193
  v_add_f32 v200, v196, v197
  s_nop 0
  v_add_f32_dpp v202, v202, v202 quad_perm:[1,0,3,2] row_mask:0xf bank_mask:0xf
  v_add_f32_dpp v200, v200, v200 quad_perm:[1,0,3,2] row_mask:0xf bank_mask:0xf
  s_nop 0
  v_add_f32_dpp v202, v202, v202 quad_perm:[2,3,0,1] row_mask:0xf bank_mask:0xf
  v_add_f32_dpp v200, v200, v200 quad_perm:[2,3,0,1] row_mask:0xf bank_mask:0xf
  s_nop 0
  v_add_f32_dpp v202, v202, v202 row_half_mirror row_mask:0xf bank_mask:0xf
  v_add_f32_dpp v200, v200, v200 row_half_mirror row_mask:0xf bank_mask:0xf
  s_nop 0
  v_add_f32_dpp v202, v202, v202 row_mirror row_mask:0xf bank_mask:0xf
  v_add_f32_dpp v200, v200, v200 row_mirror row_mask:0xf bank_mask:0xf
  v_mov_b32 v192, v202
  v_mov_b32 v193, v200
  s_nop 0
  v_permlane16_swap_b32 v192, v202
  v_permlane16_swap_b32 v193, v200
  v_add_f32 v202, v202, v192
  v_add_f32 v200, v200, v193
  v_mov_b32 v192, v202
  v_mov_b32 v193, v200
  s_nop 0
  v_permlane32_swap_b32 v192, v202
  v_permlane32_swap_b32 v193, v200
  v_add_f32 v202, v202, v192
  v_add_f32 v200, v200, v193
  v_mul_f32 v202, 0xbae38e39, v202
  v_mul_f32 v200, 0x3ae38e39, v200
  v_fma_f32 v200, -v202, v202, v200
  v_cvt_pk_bf16_f32 v202, v202, v202
  v_max_f32 v200, 0, v200
  v_lshlrev_b32 v202, 16, v202
  v_cvt_pk_bf16_f32 v200, v200, v200
  v_lshlrev_b32 v200, 16, v200
  v_add_f32 v200, 0x3727c5ac, v200
  v_cvt_pk_bf16_f32 v200, v200, v200
  v_lshlrev_b32 v200, 16, v200
  v_sqrt_f32 v200, v200
  s_nop 0
  v_cvt_pk_bf16_f32 v200, v200, v200
  v_lshlrev_b32 v200, 16, v200
  v_rcp_f32 v200, v200
  s_nop 0
  v_mul_f32 v202, v202, v200
  s_cmp_lt_u32 s3, 4
  s_cbranch_scc1 per_entry_yp
  s_cmp_eq_u32 s39, 0
  s_cbranch_scc1 per_entry_yn
  v_mov_b32 v224, 161824
  s_mov_b32 s31, 0x40000
per_entry_wt:
  ds_read_b32 v225, v224
  s_waitcnt lgkmcnt(0)
  v_cmp_gt_u32 vcc, 1028, v225
  s_cbranch_vccz per_entry_wu
  s_sleep 2
  s_sub_u32 s31, s31, 1
  s_cbranch_scc0 per_entry_wt
per_entry_wu:
  s_add_u32 s6, s37, 36864
  buffer_store_dwordx4 v[16:19], v0, s[8:11], s37 offen offset:0 sc1
  buffer_store_dwordx4 v[20:23], v0, s[8:11], s37 offen offset:1024 sc1
  buffer_store_dwordx4 v[24:27], v0, s[8:11], s37 offen offset:2048 sc1
  buffer_store_dwordx4 v[28:31], v0, s[8:11], s37 offen offset:3072 sc1
  buffer_store_dwordx4 v[32:35], v0, s[8:11], s6 offen offset:0 sc1
  buffer_store_dwordx4 v[36:39], v0, s[8:11], s6 offen offset:1024 sc1
  buffer_store_dwordx4 v[40:43], v0, s[8:11], s6 offen offset:2048 sc1
  buffer_store_dwordx4 v[44:47], v0, s[8:11], s6 offen offset:3072 sc1
  s_cmp_eq_u32 s39, 1
  s_cbranch_scc1 per_entry_yn
  s_add_u32 s6, s38, 36864
  buffer_store_dwordx4 v[48:51], v0, s[8:11], s38 offen offset:0 sc1
  buffer_store_dwordx4 v[52:55], v0, s[8:11], s38 offen offset:1024 sc1
  buffer_store_dwordx4 v[56:59], v0, s[8:11], s38 offen offset:2048 sc1
  buffer_store_dwordx4 v[60:63], v0, s[8:11], s38 offen offset:3072 sc1
  buffer_store_dwordx4 v[64:67], v0, s[8:11], s6 offen offset:0 sc1
  buffer_store_dwordx4 v[68:71], v0, s[8:11], s6 offen offset:1024 sc1
  buffer_store_dwordx4 v[72:75], v0, s[8:11], s6 offen offset:2048 sc1
  buffer_store_dwordx4 v[76:79], v0, s[8:11], s6 offen offset:3072 sc1
  s_branch per_entry_yn
per_entry_yp:
  v_mov_b32 v227, 161824
  v_mul_u32_u24 v228, 128, v5
  s_cmp_eq_u32 s3, 0
  s_cbranch_scc1 per_entry_yq
  s_waitcnt vmcnt(0)
  s_mov_b64 exec, 4
  ds_add_u32 v227, v228
  s_mov_b64 exec, -1
  s_branch per_entry_yn
per_entry_yq:
  s_cmp_lg_u32 s3, 0
  s_cbranch_scc1 per_entry_yn
  v_mul_u32_u24 v228, 128, v5
  s_and_b32 s15, s2, 3
  s_mul_i32 s15, s15, 18432
  s_add_u32 s15, s15, 7077888
  s_add_u32 s16, s15, 8192
  s_add_u32 s17, s15, 16384
  s_mov_b64 s[18:19], -1
  s_mov_b64 s[20:21], -1
  s_mov_b64 s[22:23], 0xffff
  s_mov_b32 s31, 0x20000
per_entry_yl:
  s_mov_b64 exec, s[18:19]
  s_cbranch_execz per_entry_ys0
  buffer_load_dword v224, v228, s[8:11], s15 offen sc1
per_entry_ys0:
  s_mov_b64 exec, s[20:21]
  s_cbranch_execz per_entry_ys1
  buffer_load_dword v225, v228, s[8:11], s16 offen sc1
per_entry_ys1:
  s_mov_b64 exec, s[22:23]
  s_cbranch_execz per_entry_ys2
  buffer_load_dword v226, v228, s[8:11], s17 offen sc1
per_entry_ys2:
  s_waitcnt vmcnt(0)
  s_cmp_lg_u32 s31, 0x20000
  s_cbranch_scc1 per_entry_yr
  s_mov_b64 exec, 4
  ds_add_u32 v227, v228
  s_mov_b64 exec, -1
per_entry_yr:
  s_mov_b64 exec, s[18:19]
  v_cmp_ne_u32 s[18:19], s96, v224
  s_mov_b64 exec, s[20:21]
  v_cmp_ne_u32 s[20:21], s96, v225
  s_mov_b64 exec, s[22:23]
  v_cmp_ne_u32 s[22:23], s96, v226
  s_mov_b64 exec, -1
  s_nop 1
  s_or_b64 vcc, s[18:19], s[20:21]
  s_or_b64 vcc, vcc, s[22:23]
  s_cbranch_scc0 per_entry_yn
  s_sleep 2
  s_sub_u32 s31, s31, 1
  s_cbranch_scc0 per_entry_yl
per_entry_yn:
  s_barrier
  s_cmp_ge_u32 s3, 4
  s_cbranch_scc1 per_entry_y9
  s_cmp_lg_u32 s3, 0
  s_cbranch_scc1 per_entry_y8
  s_mov_b32 m0, 8192
  s_nop 0
  buffer_load_dwordx4 v220, s[8:11], s47 offen sc1 lds
per_entry_y8:
  s_add_u32 m0, s14, 0
  s_add_u32 s6, s13, 8192
  buffer_load_dwordx4 v220, s[8:11], s13 offen sc1 lds
  s_add_u32 m0, s14, 4096
  s_nop 0
  buffer_load_dwordx4 v220, s[8:11], s6 offen sc1 lds
  s_waitcnt vmcnt(0)
per_entry_y9:
  s_barrier
  ds_read_b64 v[144:145], v221
  ds_read_b64 v[146:147], v222 offset:4608
  s_mov_b64 exec, 252645135
  ds_read_b64 v[142:143], v223 offset:4096
  s_mov_b64 exec, -1
  v_pk_fma_f32 v[156:157], v[168:169], v[200:201], v[202:203] op_sel_hi:[1,0,0]
  v_pk_fma_f32 v[158:159], v[170:171], v[200:201], v[202:203] op_sel_hi:[1,0,0]
  v_pk_fma_f32 v[160:161], v[172:173], v[200:201], v[202:203] op_sel_hi:[1,0,0]
  v_pk_fma_f32 v[162:163], v[174:175], v[200:201], v[202:203] op_sel_hi:[1,0,0]
  v_pk_fma_f32 v[164:165], v[176:177], v[200:201], v[202:203] op_sel_hi:[1,0,0]
  v_pk_fma_f32 v[166:167], v[178:179], v[200:201], v[202:203] op_sel_hi:[1,0,0]
  s_waitcnt lgkmcnt(2)
  v_lshlrev_b32 v180, 16, v144
  v_and_b32 v181, 4294901760, v144
  v_lshlrev_b32 v182, 16, v145
  v_and_b32 v183, 4294901760, v145
  s_waitcnt lgkmcnt(1)
  v_lshlrev_b32 v184, 16, v146
  v_and_b32 v185, 4294901760, v146
  v_lshlrev_b32 v186, 16, v147
  v_and_b32 v187, 4294901760, v147
  s_waitcnt lgkmcnt(0)
  v_lshlrev_b32 v188, 16, v142
  v_and_b32 v189, 4294901760, v142
  v_lshlrev_b32 v190, 16, v143
  v_and_b32 v191, 4294901760, v143
  v_pk_fma_f32 v[168:169], v[156:157], v[180:181], v[168:169]
  v_pk_fma_f32 v[170:171], v[158:159], v[182:183], v[170:171]
  v_pk_fma_f32 v[172:173], v[160:161], v[184:185], v[172:173]
  v_pk_fma_f32 v[174:175], v[162:163], v[186:187], v[174:175]
  v_pk_fma_f32 v[176:177], v[164:165], v[188:189], v[176:177]
  v_pk_fma_f32 v[178:179], v[166:167], v[190:191], v[178:179]
  v_cvt_pk_bf16_f32 v136, v168, v169
  v_cvt_pk_bf16_f32 v137, v170, v171
  v_cvt_pk_bf16_f32 v138, v172, v173
  v_cvt_pk_bf16_f32 v139, v174, v175
  v_cvt_pk_bf16_f32 v140, v176, v177
  v_cvt_pk_bf16_f32 v141, v178, v179
  buffer_store_dwordx4 v[144:147], v0, s[8:11], s42 offen offset:2048 sc1
  v_pk_add_f32 v[192:193], v[168:169], v[170:171]
  v_pk_mul_f32 v[196:197], v[168:169], v[168:169]
  v_pk_add_f32 v[194:195], v[172:173], v[174:175]
  v_pk_mul_f32 v[198:199], v[170:171], v[170:171]
  v_pk_add_f32 v[192:193], v[192:193], v[176:177]
  v_pk_fma_f32 v[196:197], v[172:173], v[172:173], v[196:197]
  v_pk_add_f32 v[194:195], v[194:195], v[178:179]
  v_pk_fma_f32 v[198:199], v[174:175], v[174:175], v[198:199]
  v_pk_fma_f32 v[196:197], v[176:177], v[176:177], v[196:197]
  v_pk_fma_f32 v[198:199], v[178:179], v[178:179], v[198:199]
  v_pk_add_f32 v[192:193], v[192:193], v[194:195]
  v_pk_add_f32 v[196:197], v[196:197], v[198:199]
  v_add_f32 v202, v192, v193
  v_add_f32 v200, v196, v197
  s_nop 0
  v_add_f32_dpp v202, v202, v202 quad_perm:[1,0,3,2] row_mask:0xf bank_mask:0xf
  v_add_f32_dpp v200, v200, v200 quad_perm:[1,0,3,2] row_mask:0xf bank_mask:0xf
  s_nop 0
  v_add_f32_dpp v202, v202, v202 quad_perm:[2,3,0,1] row_mask:0xf bank_mask:0xf
  v_add_f32_dpp v200, v200, v200 quad_perm:[2,3,0,1] row_mask:0xf bank_mask:0xf
  s_nop 0
  v_add_f32_dpp v202, v202, v202 row_half_mirror row_mask:0xf bank_mask:0xf
  v_add_f32_dpp v200, v200, v200 row_half_mirror row_mask:0xf bank_mask:0xf
  s_nop 0
  v_add_f32_dpp v202, v202, v202 row_mirror row_mask:0xf bank_mask:0xf
  v_add_f32_dpp v200, v200, v200 row_mirror row_mask:0xf bank_mask:0xf
  v_mov_b32 v192, v202
  v_mov_b32 v193, v200
  s_nop 0
  v_permlane16_swap_b32 v192, v202
  v_permlane16_swap_b32 v193, v200
  v_add_f32 v202, v202, v192
  v_add_f32 v200, v200, v193
  v_mov_b32 v192, v202
  v_mov_b32 v193, v200
  s_nop 0
  v_permlane32_swap_b32 v192, v202
  v_permlane32_swap_b32 v193, v200
  v_add_f32 v202, v202, v192
  v_add_f32 v200, v200, v193
  v_mul_f32 v202, 0xbae38e39, v202
  v_mul_f32 v200, 0x3ae38e39, v200
  v_fma_f32 v200, -v202, v202, v200
  v_cvt_pk_bf16_f32 v202, v202, v202
  v_max_f32 v200, 0, v200
  v_lshlrev_b32 v202, 16, v202
  v_cvt_pk_bf16_f32 v200, v200, v200
  v_lshlrev_b32 v200, 16, v200
  v_add_f32 v200, 0x3727c5ac, v200
  v_cvt_pk_bf16_f32 v200, v200, v200
  v_lshlrev_b32 v200, 16, v200
  v_sqrt_f32 v200, v200
  s_nop 0
  v_cvt_pk_bf16_f32 v200, v200, v200
  v_lshlrev_b32 v200, 16, v200
  v_rcp_f32 v200, v200
  s_nop 0
  v_mul_f32 v200, 0x3eeff558, v200
  v_mul_f32 v202, v202, v200
  v_pk_fma_f32 v[156:157], v[168:169], v[200:201], v[202:203] op_sel_hi:[1,0,0]
  v_pk_fma_f32 v[158:159], v[170:171], v[200:201], v[202:203] op_sel_hi:[1,0,0]
  v_pk_fma_f32 v[160:161], v[172:173], v[200:201], v[202:203] op_sel_hi:[1,0,0]
  v_pk_fma_f32 v[162:163], v[174:175], v[200:201], v[202:203] op_sel_hi:[1,0,0]
  v_pk_fma_f32 v[164:165], v[176:177], v[200:201], v[202:203] op_sel_hi:[1,0,0]
  v_pk_fma_f32 v[166:167], v[178:179], v[200:201], v[202:203] op_sel_hi:[1,0,0]
  v_cvt_pk_bf16_f32 v208, v156, v157
  v_cvt_pk_bf16_f32 v209, v158, v159
  v_cvt_pk_bf16_f32 v210, v160, v161
  v_cvt_pk_bf16_f32 v211, v162, v163
  v_cvt_pk_bf16_f32 v212, v164, v165
  v_cvt_pk_bf16_f32 v213, v166, v167
  v_permlane16_swap_b32 v208, v210
  v_permlane16_swap_b32 v209, v211
  s_mov_b64 exec, 252645135
  ds_write_b64 v219, v[212:213]
  s_mov_b64 exec, -1
  ds_write_b128 v218, v[208:211]
  s_waitcnt lgkmcnt(0)
  s_branch per_pub
per_seam:
  s_setprio 0
  s_mov_b32 s59, s57
  s_sub_u32 s7, s53, 69206016
  s_lshl_b32 s7, s7, 1
  s_lshl_b32 s6, s5, 14
  s_add_u32 s7, s7, s6
  s_add_u32 s7, s7, 69468160
  s_lshl_b32 s47, s4, 11
  s_add_u32 s47, s47, s7
  s_and_b32 s23, s2, 15
  s_lshl_b32 s23, s23, 7
  s_add_u32 s23, s23, s7
  s_lshl_b32 s13, s5, 6
  s_add_u32 s13, s13, s4
  s_mul_i32 s13, s13, 18432
  s_add_u32 s13, s13, 29360128
  s_lshl_b32 s7, s46, 5
  s_add_u32 s41, s13, s7
  s_add_u32 s40, s41, s7
  s_add_u32 s41, s41, 8192
  s_and_b32 s27, s3, 3
  s_lshl_b32 s22, s27, 2
  s_lshl_b32 s22, 1, s22
  s_cmp_eq_u32 s27, 0
  s_cselect_b32 s20, -1, 0
  s_mov_b32 s21, 0
  v_lshrrev_b32 v5, 4, v0
  v_and_b32 v90, 3, v5
  v_bfe_u32 v91, v5, 2, 2
  v_lshrrev_b32 v92, 4, v5
  v_and_b32 v93, 1, v92
  v_lshrrev_b32 v94, 1, v92
  v_and_b32 v192, 36, v5
  v_lshrrev_b32 v193, 1, v5
  v_and_b32 v193, 12, v193
  v_or_b32 v193, v193, v90
  v_lshlrev_b32 v193, 4, v193
  v_lshl_add_u32 v229, v192, 26, v193
  v_and_b32 v232, 15, v5
  v_lshlrev_b32 v232, 7, v232
  v_lshl_add_u32 v232, v93, 2, v232
  v_mov_b32 v230, 0
  v_mov_b32 v234, 161800
  v_mov_b32 v249, s96
  v_mov_b32 v235, 1
  v_mul_u32_u24 v96, 147456, v92
  v_lshl_add_u32 v96, v91, 10, v96
  v_lshl_add_u32 v96, v90, 4, v96
  v_and_b32 v192, 1, v91
  v_lshl_add_u32 v193, v192, 2, v92
  v_mul_u32_u24 v97, 147456, v193
  v_mul_u32_u24 v192, 3, v192
  v_xor_b32 v192, v192, v90
  v_lshl_add_u32 v97, v192, 3, v97
  v_lshrrev_b32 v192, 1, v91
  v_mul_u32_u24 v192, 9216, v192
  v_add_u32 v97, v97, v192
  v_lshlrev_b32 v231, 11, v5
  v_mov_b32 v250, 161792
  v_mov_b32 v248, 31
  s_cmp_ge_u32 s3, 4
  s_cbranch_scc0 per_s_aa
  s_waitcnt vmcnt(0)
  ds_write_b32 v251, v248
  s_branch per_s_nf
per_s_aa:
  s_mov_b64 exec, 1
  s_waitcnt vmcnt(0)
  ds_add_rtn_u32 v250, v250, v235
  s_waitcnt lgkmcnt(0)
  v_cmp_eq_u32 vcc, 3, v250
  s_mov_b64 exec, 0xff
  s_cbranch_vccz per_s_ab
  buffer_store_dword v249, v231, s[8:11], s23 offen sc1
per_s_ab:
  s_mov_b64 exec, -1
per_s_nf:
  s_cmp_eq_u32 s20, 0
  s_cbranch_scc1 per_s_p0
  s_mov_b64 exec, s[20:21]
  buffer_load_dword v230, v232, s[8:11], s47 offen sc1
  s_mov_b64 exec, -1
per_s_p0:

  buffer_load_dwordx4 v[136:139], v0, s[8:11], s42 offen sc1
  buffer_load_dwordx4 v[140:143], v229, s[8:11], s42 offen offset:1024 sc1
  v_and_b32 v193, 15, v5
  v_and_b32 v192, 1, v5
  v_lshlrev_b32 v192, 4, v192
  v_mov_b32 v194, 16256
  v_lshlrev_b32 v194, v192, v194
  v_lshrrev_b32 v193, 1, v193
  v_cmp_eq_u32_e64 s[28:29], 0, v193
  v_cmp_eq_u32_e64 s[32:33], 1, v193
  s_nop 0
  v_cndmask_b32_e64 v148, 0, v194, s[28:29]
  v_cmp_eq_u32_e64 s[28:29], 2, v193
  v_cndmask_b32_e64 v149, 0, v194, s[32:33]
  v_cmp_eq_u32_e64 s[32:33], 3, v193
  v_cndmask_b32_e64 v150, 0, v194, s[28:29]
  v_cmp_eq_u32_e64 s[28:29], 4, v193
  v_cndmask_b32_e64 v151, 0, v194, s[32:33]
  v_cmp_eq_u32_e64 s[32:33], 5, v193
  v_cndmask_b32_e64 v152, 0, v194, s[28:29]
  v_cmp_eq_u32_e64 s[28:29], 6, v193
  v_cndmask_b32_e64 v153, 0, v194, s[32:33]
  v_cmp_eq_u32_e64 s[32:33], 7, v193
  v_cndmask_b32_e64 v154, 0, v194, s[28:29]
  s_nop 0
  v_cndmask_b32_e64 v155, 0, v194, s[32:33]
  s_mul_i32 s6, s27, 3072
  s_add_u32 s6, s6, 149504
  v_add_u32 v233, s6, v0
  v_mov_b32 v204, 0
  v_mov_b32 v180, 0
  v_mov_b32 v205, 0
  v_mov_b32 v181, 0
  v_mov_b32 v206, 0
  v_mov_b32 v182, 0
  v_mov_b32 v207, 0
  v_mov_b32 v183, 0
  v_mov_b32 v202, 0x4091afa4
  s_cmp_lg_u32 s59, 0
  s_cbranch_scc1 per_s_f1
  buffer_load_dwordx4 v[144:147], v0, s[8:11], s42 offen offset:2048 sc1
  s_mov_b32 s57, 100663296
  s_mov_b32 s53, 69337088
  s_lshl_b32 s43, s2, 7
  s_add_u32 s43, s43, 69402624
  s_lshl_b32 s44, s5, 11
  s_add_u32 s44, s44, 69402624
  s_mul_i32 s45, s5, 147456
  s_lshl_b32 s7, s4, 10
  s_add_u32 s45, s45, s7
  s_lshl_b32 s7, s12, 7
  s_add_u32 s45, s45, s7
  s_lshl_b32 s7, s3, 14
  s_add_u32 s45, s45, s7
  s_add_u32 s45, s45, 9437184
  v_lshrrev_b32 v192, 3, v5
  v_and_b32 v193, 7, v5
  v_xor_b32 v193, v193, v192
  v_lshlrev_b32 v216, 4, v193
  v_and_b32 v193, 3, v192
  v_lshl_add_u32 v216, v193, 8, v216
  v_lshl_add_u32 v216, v94, 13, v216
  s_lshl_b32 s7, s3, 10
  s_add_u32 s7, s7, 16384
  v_add_u32 v217, s7, v0
  v_and_b32 v192, 15, v5
  v_lshl_add_u32 v192, v94, 4, v192
  v_mad_u32_u24 v192, v93, 36, v192
  v_and_b32 v193, 7, v192
  v_xor_b32 v193, s3, v193
  v_lshlrev_b32 v193, 4, v193
  v_lshl_add_u32 v218, v192, 7, v193
  v_add_u32 v218, 16384, v218
  v_lshrrev_b32 v192, 1, v91
  v_mad_u32_u24 v192, v192, 36, v90
  v_and_b32 v193, 7, v192
  v_xor_b32 v193, s3, v193
  v_lshlrev_b32 v193, 4, v193
  v_lshl_add_u32 v219, v192, 7, v193
  v_lshl_add_u32 v219, v93, 3, v219
  v_add_u32 v219, 20480, v219
  s_branch per_s_f2
per_s_f1:
  s_load_dwordx2 s[48:49], s[0:1], 80
  v_and_b32 v192, 15, v5
  v_lshlrev_b32 v98, 4, v192
  v_lshl_add_u32 v98, v94, 8, v98
  v_mul_u32_u24 v192, 576, v93
  v_add_u32 v98, v98, v192
  v_lshrrev_b32 v192, 1, v91
  v_mul_u32_u24 v192, 576, v192
  v_lshl_add_u32 v192, v90, 4, v192
  v_lshl_add_u32 v192, v93, 3, v192
  v_add_u32 v192, 512, v192
  v_and_b32 v193, 36, v5
  v_lshl_add_u32 v99, v193, 24, v192
  s_mov_b32 s50, 2359296
  s_mov_b32 s51, 131072
  s_waitcnt lgkmcnt(0)
per_s_f2:
  s_cmp_ge_u32 s3, 4
  s_cbranch_scc1 per_s_B0
  s_cmp_lg_u32 s3, 1
  s_cbranch_scc1 per_s_Pe
  s_mov_b32 s24, 24
  s_mov_b32 s31, 0x40000
  v_mov_b32 v248, 4
per_s_Pl:
  ds_read_b32 v250, v254 offset:1024
  s_waitcnt lgkmcnt(0)
per_s_Pc:
  v_cmp_gt_u32 vcc, s24, v250
  s_cbranch_vccnz per_s_Pw
  s_mov_b64 exec, 1
  buffer_store_dword v249, v248, s[8:11], s23 offen sc1
  s_mov_b64 exec, -1
  s_add_u32 s23, s23, 2048
  s_add_u32 s24, s24, 1
  s_cmp_le_u32 s24, 31
  s_cbranch_scc1 per_s_Pc
  s_branch per_s_Pd
per_s_Pw:
  s_sleep 1
  s_sub_u32 s31, s31, 1
  s_cbranch_scc0 per_s_Pl
per_s_Pd:
  s_mov_b64 exec, 1
  ds_or_b32 v234, v248
  s_mov_b64 exec, -1
per_s_Pe:
  s_mov_b32 s56, 34954
  s_mov_b32 s31, 0x20000
per_s_Al:
  s_cmp_eq_u32 s20, 0
  s_cbranch_scc1 per_s_Ar
  s_waitcnt vmcnt(0)
  v_cmp_eq_u32 vcc, s96, v230
  s_nop 1
  s_andn2_b32 s20, s20, vcc_lo
  s_lshr_b32 s54, vcc_lo, 1
  s_and_b32 s54, s54, vcc_lo
  s_lshr_b32 s55, s54, 2
  s_and_b32 s54, s54, s55
  s_and_b32 s54, s54, 0x11111111
  s_lshl_b32 s54, s54, 3
  v_mov_b32 v248, s54
  s_mov_b64 exec, 1
  ds_or_rtn_b32 v250, v234, v248
  s_mov_b64 exec, -1
  s_waitcnt lgkmcnt(0)
  v_readfirstlane_b32 s58, v250
  s_nop 1
  s_or_b32 s58, s58, s54
  s_branch per_s_Ag
per_s_Ar:
  ds_read_b32 v250, v234
  s_waitcnt lgkmcnt(0)
  v_readfirstlane_b32 s58, v250
  s_nop 1
per_s_Ag:
  s_and_b32 s25, s58, s56
  s_cbranch_scc0 per_s_A3
  s_andn2_b32 s56, s56, s25
  s_bitcmp1_b32 s25, 3
  s_cbranch_scc0 per_s_A0
  s_add_u32 s6, s40, 0
  buffer_load_dwordx4 v[100:103], v96, s[8:11], s6 offen sc1
  buffer_load_dwordx4 v[40:43], v96, s[8:11], s6 offen offset:256 sc1
per_s_A0:
  s_bitcmp1_b32 s25, 11
  s_cbranch_scc0 per_s_A1
  s_add_u32 s6, s40, 9216
  buffer_load_dwordx4 v[116:119], v96, s[8:11], s6 offen sc1
  buffer_load_dwordx4 v[56:59], v96, s[8:11], s6 offen offset:256 sc1
per_s_A1:
  s_bitcmp1_b32 s25, 7
  s_cbranch_scc0 per_s_A2
  s_add_u32 s6, s40, 589824
  buffer_load_dwordx4 v[104:107], v96, s[8:11], s6 offen sc1
  buffer_load_dwordx4 v[44:47], v96, s[8:11], s6 offen offset:256 sc1
per_s_A2:
  s_bitcmp1_b32 s25, 15
  s_cbranch_scc0 per_s_A3
  s_add_u32 s6, s40, 599040
  buffer_load_dwordx4 v[120:123], v96, s[8:11], s6 offen sc1
  buffer_load_dwordx4 v[60:63], v96, s[8:11], s6 offen offset:256 sc1
per_s_A3:
  s_cmp_eq_u32 s56, 2
  s_cbranch_scc1 per_s_Ad
  s_sleep 2
  s_cmp_eq_u32 s20, 0
  s_cbranch_scc1 per_s_Ap
  s_mov_b64 exec, s[20:21]
  buffer_load_dword v230, v232, s[8:11], s47 offen sc1
  s_mov_b64 exec, -1
per_s_Ap:
  s_sub_u32 s31, s31, 1
  s_cbranch_scc0 per_s_Al
per_s_Ad:
  buffer_load_dwordx2 v[132:133], v97, s[8:11], s41 offen offset:0 sc1
  buffer_load_dwordx2 v[72:73], v97, s[8:11], s41 offen offset:128 sc1
  buffer_load_dwordx2 v[134:135], v97, s[8:11], s41 offen offset:512 sc1
  buffer_load_dwordx2 v[74:75], v97, s[8:11], s41 offen offset:640 sc1
  s_mov_b32 s20, 0
  s_waitcnt vmcnt(0)
  v_mfma_f32_16x16x32_bf16 v[84:87], v[148:151], v[72:75], 0
  v_mfma_f32_16x16x32_bf16 v[76:79], v[148:151], v[40:43], 0
  v_mfma_f32_16x16x32_bf16 v[80:83], v[148:151], v[56:59], 0
  v_mfma_f32_16x16x32_bf16 v[76:79], v[148:151], v[44:47], v[76:79]
  v_mfma_f32_16x16x32_bf16 v[80:83], v[148:151], v[60:63], v[80:83]
  v_mfma_f32_16x16x32_bf16 v[164:167], v[148:151], v[132:135], 0
  v_mfma_f32_16x16x32_bf16 v[156:159], v[148:151], v[100:103], 0
  v_mfma_f32_16x16x32_bf16 v[160:163], v[148:151], v[116:119], 0
  v_mfma_f32_16x16x32_bf16 v[156:159], v[148:151], v[104:107], v[156:159]
  v_mfma_f32_16x16x32_bf16 v[160:163], v[148:151], v[120:123], v[160:163]
  v_add_f32_dpp v180, v84, v84 row_half_mirror row_mask:0x3 bank_mask:0x5
  v_add_f32_dpp v181, v85, v85 row_half_mirror row_mask:0x3 bank_mask:0x5
  v_add_f32_dpp v182, v86, v86 row_half_mirror row_mask:0x3 bank_mask:0x5
  v_add_f32_dpp v183, v87, v87 row_half_mirror row_mask:0x3 bank_mask:0x5
  ds_write_b128 v233, v[76:79]
  ds_write_b128 v233, v[80:83] offset:1024
  ds_write_b128 v233, v[180:183] offset:2048
  v_mov_b32 v248, s22
  s_mov_b64 exec, 1
  ds_or_b32 v234, v248
  s_mov_b64 exec, -1
  v_add_f32_dpp v204, v164, v164 row_half_mirror row_mask:0x3 bank_mask:0x5
  v_add_f32_dpp v205, v165, v165 row_half_mirror row_mask:0x3 bank_mask:0x5
  v_add_f32_dpp v206, v166, v166 row_half_mirror row_mask:0x3 bank_mask:0x5
  v_add_f32_dpp v207, v167, v167 row_half_mirror row_mask:0x3 bank_mask:0x5
  s_mov_b32 s56, 2290614272
  s_branch per_s_B1
per_s_B0:
  s_or_b32 s56, s22, 2290614272
per_s_B1:
  s_mov_b32 s31, 0x20000
per_s_Bl:
  s_cmp_eq_u32 s20, 0
  s_cbranch_scc1 per_s_Br
  s_waitcnt vmcnt(0)
  v_cmp_eq_u32 vcc, s96, v230
  s_nop 1
  s_andn2_b32 s20, s20, vcc_lo
  s_lshr_b32 s54, vcc_lo, 1
  s_and_b32 s54, s54, vcc_lo
  s_lshr_b32 s55, s54, 2
  s_and_b32 s54, s54, s55
  s_and_b32 s54, s54, 0x11111111
  s_lshl_b32 s54, s54, 3
  v_mov_b32 v248, s54
  s_mov_b64 exec, 1
  ds_or_rtn_b32 v250, v234, v248
  s_mov_b64 exec, -1
  s_waitcnt lgkmcnt(0)
  v_readfirstlane_b32 s58, v250
  s_nop 1
  s_or_b32 s58, s58, s54
  s_cmp_eq_u32 s20, 0
  s_cbranch_scc1 per_s_Bg
  s_sleep 1
  s_cmp_eq_u32 s20, 0
  s_cbranch_scc1 per_s_Bp
  s_mov_b64 exec, s[20:21]
  buffer_load_dword v230, v232, s[8:11], s47 offen sc1
  s_mov_b64 exec, -1
per_s_Bp:
  s_branch per_s_Bn
per_s_Br:
  ds_read_b32 v250, v234
  s_waitcnt lgkmcnt(0)
  v_readfirstlane_b32 s58, v250
  s_nop 1
per_s_Bg:
  s_and_b32 s25, s58, s56
  s_cbranch_scc0 per_s_Bs
  s_bitcmp1_b32 s25, 19
  s_cbranch_scc0 per_s_Bu0
  s_add_u32 s6, s40, 4096
  buffer_load_dwordx4 v[108:111], v96, s[8:11], s6 offen sc1
per_s_Bu0:
  s_bitcmp1_b32 s25, 27
  s_cbranch_scc0 per_s_Bu1
  s_add_u32 s6, s40, 13312
  buffer_load_dwordx4 v[124:127], v96, s[8:11], s6 offen sc1
per_s_Bu1:
  s_bitcmp1_b32 s25, 23
  s_cbranch_scc0 per_s_Bu2
  s_add_u32 s6, s40, 593920
  buffer_load_dwordx4 v[112:115], v96, s[8:11], s6 offen sc1
per_s_Bu2:
  s_bitcmp1_b32 s25, 31
  s_cbranch_scc0 per_s_Bu3
  s_add_u32 s6, s40, 603136
  buffer_load_dwordx4 v[128:131], v96, s[8:11], s6 offen sc1
per_s_Bu3:
  s_and_b32 s6, s25, 0xffff
  s_cbranch_scc0 per_s_Bh
  ds_read_b128 v[156:159], v233
  ds_read_b128 v[160:163], v233 offset:1024
  ds_read_b128 v[204:207], v233 offset:2048
per_s_Bh:
  s_andn2_b32 s56, s56, s25
  s_cbranch_scc0 per_s_Bd
per_s_Bs:
  s_sleep 1
per_s_Bn:
  s_sub_u32 s31, s31, 1
  s_cbranch_scc0 per_s_Bl
per_s_Bd:
  s_waitcnt vmcnt(4)
  v_lshlrev_b32 v168, 16, v136
  v_and_b32 v169, 4294901760, v136
  v_lshlrev_b32 v170, 16, v137
  v_and_b32 v171, 4294901760, v137
  v_lshlrev_b32 v172, 16, v138
  v_and_b32 v173, 4294901760, v138
  v_lshlrev_b32 v174, 16, v139
  v_and_b32 v175, 4294901760, v139
  v_lshlrev_b32 v176, 16, v140
  v_and_b32 v177, 4294901760, v140
  v_lshlrev_b32 v178, 16, v141
  v_and_b32 v179, 4294901760, v141
  v_lshlrev_b32 v180, 16, v144
  v_and_b32 v181, 4294901760, v144
  v_lshlrev_b32 v182, 16, v145
  v_and_b32 v183, 4294901760, v145
  v_lshlrev_b32 v184, 16, v146
  v_and_b32 v185, 4294901760, v146
  v_lshlrev_b32 v186, 16, v147
  v_and_b32 v187, 4294901760, v147
  v_lshlrev_b32 v188, 16, v142
  v_and_b32 v189, 4294901760, v142
  v_lshlrev_b32 v190, 16, v143
  v_and_b32 v191, 4294901760, v143
  s_waitcnt lgkmcnt(0)
  v_pk_fma_f32 v[176:177], v[204:205], v[202:203], v[176:177] op_sel_hi:[1,0,1]
  v_pk_fma_f32 v[178:179], v[206:207], v[202:203], v[178:179] op_sel_hi:[1,0,1]
  s_waitcnt vmcnt(0)
  v_mfma_f32_16x16x32_bf16 v[156:159], v[152:155], v[108:111], v[156:159]
  v_mfma_f32_16x16x32_bf16 v[160:163], v[152:155], v[124:127], v[160:163]
  v_mfma_f32_16x16x32_bf16 v[156:159], v[152:155], v[112:115], v[156:159]
  v_mfma_f32_16x16x32_bf16 v[160:163], v[152:155], v[128:131], v[160:163]
  s_nop 6
  v_pk_fma_f32 v[168:169], v[156:157], v[202:203], v[168:169] op_sel_hi:[1,0,1]
  v_pk_fma_f32 v[170:171], v[158:159], v[202:203], v[170:171] op_sel_hi:[1,0,1]
  v_pk_fma_f32 v[172:173], v[160:161], v[202:203], v[172:173] op_sel_hi:[1,0,1]
  v_pk_fma_f32 v[174:175], v[162:163], v[202:203], v[174:175] op_sel_hi:[1,0,1]
  s_cmp_lg_u32 s59, 0
  s_cbranch_scc0 per_ln1
  v_cvt_pk_bf16_f32 v136, v168, v169
  v_cvt_pk_bf16_f32 v137, v170, v171
  v_cvt_pk_bf16_f32 v138, v172, v173
  v_cvt_pk_bf16_f32 v139, v174, v175
  v_cvt_pk_bf16_f32 v140, v176, v177
  v_cvt_pk_bf16_f32 v141, v178, v179
  v_permlane16_swap_b32 v136, v138
  v_permlane16_swap_b32 v137, v139
  buffer_store_dwordx4 v[136:139], v98, s[48:51], s52 offen
  buffer_store_dwordx2 v[140:141], v99, s[48:51], s52 offen
  s_waitcnt vmcnt(0)
  s_endpgm
per_ln1:
  v_pk_add_f32 v[192:193], v[168:169], v[170:171]
  v_pk_mul_f32 v[196:197], v[168:169], v[168:169]
  v_pk_add_f32 v[194:195], v[172:173], v[174:175]
  v_pk_mul_f32 v[198:199], v[170:171], v[170:171]
  v_pk_add_f32 v[192:193], v[192:193], v[176:177]
  v_pk_fma_f32 v[196:197], v[172:173], v[172:173], v[196:197]
  v_pk_add_f32 v[194:195], v[194:195], v[178:179]
  v_pk_fma_f32 v[198:199], v[174:175], v[174:175], v[198:199]
  v_pk_fma_f32 v[196:197], v[176:177], v[176:177], v[196:197]
  v_pk_fma_f32 v[198:199], v[178:179], v[178:179], v[198:199]
  v_pk_add_f32 v[192:193], v[192:193], v[194:195]
  v_pk_add_f32 v[196:197], v[196:197], v[198:199]
  v_add_f32 v202, v192, v193
  v_add_f32 v200, v196, v197
  s_nop 0
  v_add_f32_dpp v202, v202, v202 quad_perm:[1,0,3,2] row_mask:0xf bank_mask:0xf
  v_add_f32_dpp v200, v200, v200 quad_perm:[1,0,3,2] row_mask:0xf bank_mask:0xf
  s_nop 0
  v_add_f32_dpp v202, v202, v202 quad_perm:[2,3,0,1] row_mask:0xf bank_mask:0xf
  v_add_f32_dpp v200, v200, v200 quad_perm:[2,3,0,1] row_mask:0xf bank_mask:0xf
  s_nop 0
  v_add_f32_dpp v202, v202, v202 row_half_mirror row_mask:0xf bank_mask:0xf
  v_add_f32_dpp v200, v200, v200 row_half_mirror row_mask:0xf bank_mask:0xf
  s_nop 0
  v_add_f32_dpp v202, v202, v202 row_mirror row_mask:0xf bank_mask:0xf
  v_add_f32_dpp v200, v200, v200 row_mirror row_mask:0xf bank_mask:0xf
  v_mov_b32 v192, v202
  v_mov_b32 v193, v200
  s_nop 0
  v_permlane16_swap_b32 v192, v202
  v_permlane16_swap_b32 v193, v200
  v_add_f32 v202, v202, v192
  v_add_f32 v200, v200, v193
  v_mov_b32 v192, v202
  v_mov_b32 v193, v200
  s_nop 0
  v_permlane32_swap_b32 v192, v202
  v_permlane32_swap_b32 v193, v200
  v_add_f32 v202, v202, v192
  v_add_f32 v200, v200, v193
  v_mul_f32 v202, 0xbae38e39, v202
  v_mul_f32 v200, 0x3ae38e39, v200
  v_fma_f32 v200, -v202, v202, v200
  v_cvt_pk_bf16_f32 v202, v202, v202
  v_max_f32 v200, 0, v200
  v_lshlrev_b32 v202, 16, v202
  v_cvt_pk_bf16_f32 v200, v200, v200
  v_lshlrev_b32 v200, 16, v200
  v_add_f32 v200, 0x3727c5ac, v200
  v_cvt_pk_bf16_f32 v200, v200, v200
  v_lshlrev_b32 v200, 16, v200
  v_sqrt_f32 v200, v200
  s_nop 0
  v_cvt_pk_bf16_f32 v200, v200, v200
  v_lshlrev_b32 v200, 16, v200
  v_rcp_f32 v200, v200
  s_nop 0
  v_mul_f32 v202, v202, v200
  v_pk_fma_f32 v[156:157], v[168:169], v[200:201], v[202:203] op_sel_hi:[1,0,0]
  v_pk_fma_f32 v[158:159], v[170:171], v[200:201], v[202:203] op_sel_hi:[1,0,0]
  v_pk_fma_f32 v[160:161], v[172:173], v[200:201], v[202:203] op_sel_hi:[1,0,0]
  v_pk_fma_f32 v[162:163], v[174:175], v[200:201], v[202:203] op_sel_hi:[1,0,0]
  v_pk_fma_f32 v[164:165], v[176:177], v[200:201], v[202:203] op_sel_hi:[1,0,0]
  v_pk_fma_f32 v[166:167], v[178:179], v[200:201], v[202:203] op_sel_hi:[1,0,0]
  v_pk_fma_f32 v[168:169], v[156:157], v[180:181], v[168:169]
  v_pk_fma_f32 v[170:171], v[158:159], v[182:183], v[170:171]
  v_pk_fma_f32 v[172:173], v[160:161], v[184:185], v[172:173]
  v_pk_fma_f32 v[174:175], v[162:163], v[186:187], v[174:175]
  v_pk_fma_f32 v[176:177], v[164:165], v[188:189], v[176:177]
  v_pk_fma_f32 v[178:179], v[166:167], v[190:191], v[178:179]
  v_cvt_pk_bf16_f32 v136, v168, v169
  v_cvt_pk_bf16_f32 v137, v170, v171
  v_cvt_pk_bf16_f32 v138, v172, v173
  v_cvt_pk_bf16_f32 v139, v174, v175
  v_cvt_pk_bf16_f32 v140, v176, v177
  v_cvt_pk_bf16_f32 v141, v178, v179
  v_pk_add_f32 v[192:193], v[168:169], v[170:171]
  v_pk_mul_f32 v[196:197], v[168:169], v[168:169]
  v_pk_add_f32 v[194:195], v[172:173], v[174:175]
  v_pk_mul_f32 v[198:199], v[170:171], v[170:171]
  v_pk_add_f32 v[192:193], v[192:193], v[176:177]
  v_pk_fma_f32 v[196:197], v[172:173], v[172:173], v[196:197]
  v_pk_add_f32 v[194:195], v[194:195], v[178:179]
  v_pk_fma_f32 v[198:199], v[174:175], v[174:175], v[198:199]
  v_pk_fma_f32 v[196:197], v[176:177], v[176:177], v[196:197]
  v_pk_fma_f32 v[198:199], v[178:179], v[178:179], v[198:199]
  v_pk_add_f32 v[192:193], v[192:193], v[194:195]
  v_pk_add_f32 v[196:197], v[196:197], v[198:199]
  v_add_f32 v202, v192, v193
  v_add_f32 v200, v196, v197
  s_nop 0
  v_add_f32_dpp v202, v202, v202 quad_perm:[1,0,3,2] row_mask:0xf bank_mask:0xf
  v_add_f32_dpp v200, v200, v200 quad_perm:[1,0,3,2] row_mask:0xf bank_mask:0xf
  s_nop 0
  v_add_f32_dpp v202, v202, v202 quad_perm:[2,3,0,1] row_mask:0xf bank_mask:0xf
  v_add_f32_dpp v200, v200, v200 quad_perm:[2,3,0,1] row_mask:0xf bank_mask:0xf
  s_nop 0
  v_add_f32_dpp v202, v202, v202 row_half_mirror row_mask:0xf bank_mask:0xf
  v_add_f32_dpp v200, v200, v200 row_half_mirror row_mask:0xf bank_mask:0xf
  s_nop 0
  v_add_f32_dpp v202, v202, v202 row_mirror row_mask:0xf bank_mask:0xf
  v_add_f32_dpp v200, v200, v200 row_mirror row_mask:0xf bank_mask:0xf
  v_mov_b32 v192, v202
  v_mov_b32 v193, v200
  s_nop 0
  v_permlane16_swap_b32 v192, v202
  v_permlane16_swap_b32 v193, v200
  v_add_f32 v202, v202, v192
  v_add_f32 v200, v200, v193
  v_mov_b32 v192, v202
  v_mov_b32 v193, v200
  s_nop 0
  v_permlane32_swap_b32 v192, v202
  v_permlane32_swap_b32 v193, v200
  v_add_f32 v202, v202, v192
  v_add_f32 v200, v200, v193
  v_mul_f32 v202, 0xbae38e39, v202
  v_mul_f32 v200, 0x3ae38e39, v200
  v_fma_f32 v200, -v202, v202, v200
  v_cvt_pk_bf16_f32 v202, v202, v202
  v_max_f32 v200, 0, v200
  v_lshlrev_b32 v202, 16, v202
  v_cvt_pk_bf16_f32 v200, v200, v200
  v_lshlrev_b32 v200, 16, v200
  v_add_f32 v200, 0x3727c5ac, v200
  v_cvt_pk_bf16_f32 v200, v200, v200
  v_lshlrev_b32 v200, 16, v200
  v_sqrt_f32 v200, v200
  s_nop 0
  v_cvt_pk_bf16_f32 v200, v200, v200
  v_lshlrev_b32 v200, 16, v200
  v_rcp_f32 v200, v200
  s_nop 0
  v_mul_f32 v200, 0x3eeff558, v200
  v_mul_f32 v202, v202, v200
  v_pk_fma_f32 v[156:157], v[168:169], v[200:201], v[202:203] op_sel_hi:[1,0,0]
  v_pk_fma_f32 v[158:159], v[170:171], v[200:201], v[202:203] op_sel_hi:[1,0,0]
  v_pk_fma_f32 v[160:161], v[172:173], v[200:201], v[202:203] op_sel_hi:[1,0,0]
  v_pk_fma_f32 v[162:163], v[174:175], v[200:201], v[202:203] op_sel_hi:[1,0,0]
  v_pk_fma_f32 v[164:165], v[176:177], v[200:201], v[202:203] op_sel_hi:[1,0,0]
  v_pk_fma_f32 v[166:167], v[178:179], v[200:201], v[202:203] op_sel_hi:[1,0,0]
  v_cvt_pk_bf16_f32 v208, v156, v157
  v_cvt_pk_bf16_f32 v209, v158, v159
  v_cvt_pk_bf16_f32 v210, v160, v161
  v_cvt_pk_bf16_f32 v211, v162, v163
  v_cvt_pk_bf16_f32 v212, v164, v165
  v_cvt_pk_bf16_f32 v213, v166, v167
  v_permlane16_swap_b32 v208, v210
  v_permlane16_swap_b32 v209, v211
  s_mov_b64 exec, 252645135
  ds_write_b64 v219, v[212:213]
  s_mov_b64 exec, -1
  ds_write_b128 v218, v[208:211]
  s_waitcnt lgkmcnt(0)
per_pub:
  s_barrier
  v_mov_b32 v7, 0
  ds_write_b32 v251, v7
  v_mov_b32 v8, 0
  v_mov_b32 v9, 0
  v_mov_b32 v10, 0
  v_mov_b32 v11, 0
  v_mov_b32 v6, 161792
  ds_write_b128 v6, v[8:11]
  v_lshlrev_b32 v248, 6, v0
  v_add_u32 v248, 0x8000, v248
  s_lshl_b32 s15, s4, 7
  s_add_u32 s15, s15, 70123520
  s_cmp_lg_u32 s3, 5
  s_cbranch_scc1 per_wn
  s_cmp_lg_u32 s57, 0
  s_cbranch_scc1 per_wn
  s_mov_b64 exec, 4294705152
  buffer_load_dword v249, v248, s[8:11], s15 offen sc1
  s_mov_b64 exec, -1
per_wn:
  ds_read_b128 v[208:211], v217
  s_cmp_lg_u32 s3, 0
  s_cbranch_scc1 per_n8
  ds_read_b128 v[212:215], v217 offset:8192
  s_add_u32 s6, s45, 131072
  s_waitcnt lgkmcnt(0)
  buffer_store_dwordx4 v[212:215], v216, s[8:11], s6 offen sc1
per_n8:
  s_waitcnt lgkmcnt(0)
  buffer_store_dwordx4 v[208:211], v216, s[8:11], s45 offen sc1
  s_barrier
  buffer_store_dwordx4 v[136:139], v0, s[8:11], s42 offen sc1
  buffer_store_dwordx4 v[140:143], v229, s[8:11], s42 offen offset:1024 sc1
  s_waitcnt vmcnt(2)
  s_cmp_lg_u32 s3, 5
  s_cbranch_scc1 per_wm
  s_cmp_lg_u32 s57, 0
  s_cbranch_scc1 per_wm
  s_mov_b64 exec, 4294705152
  s_mov_b32 s31, 0x20000
per_wl:
  v_cmp_ne_u32 vcc, s96, v249
  s_cbranch_vccz per_we
  buffer_load_dword v249, v248, s[8:11], s15 offen sc1
  s_waitcnt vmcnt(0)
  s_sub_u32 s31, s31, 1
  s_cbranch_scc0 per_wl
per_we:
  s_mov_b64 exec, -1
per_wm:
  s_barrier
  s_cmp_lg_u32 s3, 0
  s_cbranch_scc1 per_nf
  v_mov_b32 v248, 0
  v_mov_b32 v249, s96
  s_mov_b64 exec, 1
  buffer_store_dword v249, v248, s[8:11], s43 offen sc1
  s_mov_b64 exec, -1
per_nf:
  s_cmp_lg_u32 s3, 1
  s_cbranch_scc1 per_nd
  s_cmp_lg_u32 s57, 0
  s_cbranch_scc1 per_nd
  s_cmp_ge_u32 s2, 144
  s_cbranch_scc1 per_nd
  v_mov_b32 v248, 0
  v_mov_b32 v249, s96
  s_lshl_b32 s6, s2, 7
  s_add_u32 s6, s6, 70156288
  s_mov_b64 exec, 1
  buffer_store_dword v249, v248, s[8:11], s6 offen sc1
  s_mov_b64 exec, -1
per_nd:
  v_add_u32 v1, 65536, v0
  v_add_u32 v2, 131072, v0
  v_and_b32 v6, 15, v5
  v_lshrrev_b32 v7, 4, v5
  v_lshl_add_u32 v6, v6, 2, v7
  v_lshlrev_b32 v3, 4, v6
  v_lshlrev_b32 v255, 3, v6
  s_lshl_b32 s13, s4, 1
  s_add_u32 s13, s13, s12
  s_xor_b32 s14, s13, 1
  s_mul_i32 s6, s13, 9
  s_add_u32 s7, s6, s3
  s_mul_i32 s20, s7, 73728
  s_add_u32 s20, s20, 12582912
  s_add_u32 s7, s6, 8
  s_mul_i32 s21, s7, 73728
  s_lshl_b32 s7, s3, 10
  s_add_u32 s21, s21, s7
  s_add_u32 s21, s21, 12582912
  s_and_b32 s19, s3, 3
  s_lshl_b32 s25, s19, 11
  s_lshl_b32 s18, s19, 13
  s_mul_i32 s24, s5, 147456
  s_add_u32 s24, s24, s25
  s_add_u32 s24, s24, 9437184
  s_mul_i32 s15, s12, 18432
  s_add_u32 s15, s15, 23199744
  s_lshl_b32 s16, s3, 11
  s_and_b32 s17, s3, 1
  s_lshl_b32 s17, s17, 10
  s_add_u32 s17, s17, 16384
  s_mul_i32 s7, s13, 331776
  s_add_u32 s7, s7, s15
  s_add_u32 s22, s7, s16
  s_add_u32 s23, s7, s17
  s_mul_i32 s7, s14, 331776
  s_add_u32 s7, s7, s15
  s_add_u32 s32, s7, s16
  s_add_u32 s33, s7, s17
  s_lshl_b32 s7, s5, 3
  s_add_u32 s7, s7, s4
  s_mul_i32 s7, s7, 147456
  s_mul_i32 s15, s12, 9216
  s_add_u32 s7, s7, s15
  s_add_u32 s7, s7, 29360128
  s_lshl_b32 s15, s3, 10
  s_add_u32 s26, s7, s15
  s_and_b32 s15, s3, 1
  s_lshl_b32 s15, s15, 9
  s_add_u32 s27, s7, s15
  s_add_u32 s27, s27, 8192
  s_cmp_ge_u32 s3, 4
  s_cselect_b32 s17, 40960, 0
  s_cselect_b32 s16, 81920, 0
  s_add_u32 s17, s17, s18
  s_add_u32 s16, s16, s18
  v_add_u32 v252, s16, v0
  s_lshl_b32 s7, s5, 4
  s_add_u32 s15, s7, s13
  s_lshl_b32 s38, s15, 8
  s_add_u32 s38, s38, s53
  s_lshl_b32 s16, s3, 5
  s_add_u32 s38, s38, s16
  s_mul_i32 s15, s15, 73728
  s_add_u32 s15, s15, 50331648
  s_add_u32 s34, s15, s17
  s_add_u32 s36, s15, s25
  s_add_u32 s36, s36, 32768
  s_add_u32 s15, s7, s14
  s_lshl_b32 s39, s15, 8
  s_add_u32 s39, s39, s53
  s_lshl_b32 s16, s19, 5
  s_add_u32 s39, s39, s16
  s_mul_i32 s15, s15, 73728
  s_add_u32 s15, s15, 50331648
  s_add_u32 s35, s15, s18
  s_add_u32 s37, s15, s25
  s_add_u32 s37, s37, 32768
  s_lshl_b32 s7, s3, 2
  s_add_u32 s7, s7, 32768
  v_add_u32 v253, s7, v0
  v_and_b32 v6, 3, v5
  v_lshlrev_b32 v6, 8, v6
  v_add_u32 v254, 147456, v6
  s_cmp_eq_u32 s3, 2
  s_cselect_b32 s7, 1, 0
  s_cmp_eq_u32 s3, 3
  s_cselect_b32 s7, 1, s7
  s_lshl_b32 s17, s7, 10
  s_mul_i32 s7, s7, 18432
  s_sub_u32 s16, s26, s7
  s_add_u32 s26, s26, s7
  s_add_u32 s27, s27, s7
  s_cmp_ge_u32 s3, 4
  s_cbranch_scc1 per_B
  s_add_u32 s29, s20, 0
  buffer_load_dwordx4 v[28:31], v0, s[8:11], s29 offen offset:0
  buffer_load_dwordx4 v[32:35], v0, s[8:11], s29 offen offset:1024
  buffer_load_dwordx4 v[36:39], v0, s[8:11], s29 offen offset:2048
  buffer_load_dwordx4 v[40:43], v0, s[8:11], s29 offen offset:3072
  s_add_u32 s28, s21, 0
  buffer_load_dwordx4 v[44:47], v0, s[8:11], s28 offen offset:0
  s_add_u32 s29, s20, 4096
  buffer_load_dwordx4 v[48:51], v0, s[8:11], s29 offen offset:0
  buffer_load_dwordx4 v[52:55], v0, s[8:11], s29 offen offset:1024
  buffer_load_dwordx4 v[56:59], v0, s[8:11], s29 offen offset:2048
  buffer_load_dwordx4 v[60:63], v0, s[8:11], s29 offen offset:3072
  s_add_u32 s28, s21, 4096
  buffer_load_dwordx4 v[64:67], v0, s[8:11], s28 offen offset:0
  s_setprio 3
  s_barrier
  s_add_u32 m0, s25, 0
  s_add_u32 s30, s24, 0
  buffer_load_dwordx4 v0, s[8:11], s30 offen sc1 lds
  buffer_load_dwordx4 v0, s[8:11], s30 offen offset:1024 sc1 lds
  s_setprio 2
  s_waitcnt vmcnt(0)
  v_mov_b32 v248, 1
  ds_write_b32 v251, v248
  ds_read_b32 v250, v254 offset:0
  s_waitcnt lgkmcnt(0)
  v_cmp_gt_u32 vcc, 1, v250
  s_cbranch_vccnz per_A_x0s
per_A_x0r:
  ds_read_b128 v[4:7], v0 offset:0
  ds_read_b128 v[8:11], v0 offset:1024
  ds_read_b128 v[12:15], v0 offset:2048
  ds_read_b128 v[16:19], v0 offset:3072
  ds_read_b128 v[20:23], v0 offset:4096
  ds_read_b128 v[24:27], v0 offset:5120
  s_waitcnt lgkmcnt(5)
  v_mfma_f32_16x16x32_bf16 v[88:91], v[28:31], v[4:7], 0
  v_mfma_f32_16x16x32_bf16 v[120:123], v[32:35], v[4:7], 0
  s_add_u32 s29, s20, 8192
  buffer_load_dwordx4 v[68:71], v0, s[8:11], s29 offen offset:0
  v_mfma_f32_16x16x32_bf16 v[152:155], v[36:39], v[4:7], 0
  buffer_load_dwordx4 v[72:75], v0, s[8:11], s29 offen offset:1024
  v_mfma_f32_16x16x32_bf16 v[184:187], v[40:43], v[4:7], 0
  buffer_load_dwordx4 v[76:79], v0, s[8:11], s29 offen offset:2048
  v_mfma_f32_16x16x32_bf16 v[216:219], v[44:47], v[4:7], 0
  s_waitcnt lgkmcnt(4)
  v_mfma_f32_16x16x32_bf16 v[92:95], v[28:31], v[8:11], 0
  ds_read_b128 v[4:7], v0 offset:6144
  v_mfma_f32_16x16x32_bf16 v[124:127], v[32:35], v[8:11], 0
  buffer_load_dwordx4 v[80:83], v0, s[8:11], s29 offen offset:3072
  v_mfma_f32_16x16x32_bf16 v[156:159], v[36:39], v[8:11], 0
  s_add_u32 s28, s21, 8192
  buffer_load_dwordx4 v[84:87], v0, s[8:11], s28 offen offset:0
  v_mfma_f32_16x16x32_bf16 v[188:191], v[40:43], v[8:11], 0
  v_mfma_f32_16x16x32_bf16 v[220:223], v[44:47], v[8:11], 0
  s_waitcnt lgkmcnt(4)
  v_mfma_f32_16x16x32_bf16 v[96:99], v[28:31], v[12:15], 0
  ds_read_b128 v[8:11], v0 offset:7168
  ds_read_b32 v250, v254 offset:1024
  v_mfma_f32_16x16x32_bf16 v[128:131], v[32:35], v[12:15], 0
  v_mfma_f32_16x16x32_bf16 v[160:163], v[36:39], v[12:15], 0
  v_mfma_f32_16x16x32_bf16 v[192:195], v[40:43], v[12:15], 0
  v_mfma_f32_16x16x32_bf16 v[224:227], v[44:47], v[12:15], 0
  s_waitcnt lgkmcnt(5)
  v_mfma_f32_16x16x32_bf16 v[100:103], v[28:31], v[16:19], 0
  s_waitcnt lgkmcnt(0)
  v_cmp_gt_u32 vcc, 2, v250
  s_cbranch_vccnz per_A_x1s
per_A_x1r:
  ds_read_b128 v[12:15], v0 offset:8192
  v_mfma_f32_16x16x32_bf16 v[132:135], v[32:35], v[16:19], 0
  v_mfma_f32_16x16x32_bf16 v[164:167], v[36:39], v[16:19], 0
  v_mfma_f32_16x16x32_bf16 v[196:199], v[40:43], v[16:19], 0
  v_mfma_f32_16x16x32_bf16 v[228:231], v[44:47], v[16:19], 0
  v_mfma_f32_16x16x32_bf16 v[104:107], v[28:31], v[20:23], 0
  ds_read_b128 v[16:19], v0 offset:9216
  v_mfma_f32_16x16x32_bf16 v[136:139], v[32:35], v[20:23], 0
  v_mfma_f32_16x16x32_bf16 v[168:171], v[36:39], v[20:23], 0
  v_mfma_f32_16x16x32_bf16 v[200:203], v[40:43], v[20:23], 0
  v_mfma_f32_16x16x32_bf16 v[232:235], v[44:47], v[20:23], 0
  v_mfma_f32_16x16x32_bf16 v[108:111], v[28:31], v[24:27], 0
  ds_read_b128 v[20:23], v0 offset:10240
  v_mfma_f32_16x16x32_bf16 v[140:143], v[32:35], v[24:27], 0
  v_mfma_f32_16x16x32_bf16 v[172:175], v[36:39], v[24:27], 0
  v_mfma_f32_16x16x32_bf16 v[204:207], v[40:43], v[24:27], 0
  v_mfma_f32_16x16x32_bf16 v[236:239], v[44:47], v[24:27], 0
  v_mfma_f32_16x16x32_bf16 v[112:115], v[28:31], v[4:7], 0
  ds_read_b128 v[24:27], v0 offset:11264
  v_mfma_f32_16x16x32_bf16 v[144:147], v[32:35], v[4:7], 0
  v_mfma_f32_16x16x32_bf16 v[176:179], v[36:39], v[4:7], 0
  v_mfma_f32_16x16x32_bf16 v[208:211], v[40:43], v[4:7], 0
  v_mfma_f32_16x16x32_bf16 v[240:243], v[44:47], v[4:7], 0
  v_mfma_f32_16x16x32_bf16 v[116:119], v[28:31], v[8:11], 0
  ds_read_b128 v[4:7], v0 offset:12288
  v_mfma_f32_16x16x32_bf16 v[148:151], v[32:35], v[8:11], 0
  s_add_u32 s29, s20, 12288
  buffer_load_dwordx4 v[28:31], v0, s[8:11], s29 offen offset:0
  v_mfma_f32_16x16x32_bf16 v[180:183], v[36:39], v[8:11], 0
  v_mfma_f32_16x16x32_bf16 v[212:215], v[40:43], v[8:11], 0
  v_mfma_f32_16x16x32_bf16 v[244:247], v[44:47], v[8:11], 0
  s_waitcnt lgkmcnt(4)
  v_mfma_f32_16x16x32_bf16 v[88:91], v[48:51], v[12:15], v[88:91]
  ds_read_b128 v[8:11], v0 offset:13312
  v_mfma_f32_16x16x32_bf16 v[120:123], v[52:55], v[12:15], v[120:123]
  buffer_load_dwordx4 v[32:35], v0, s[8:11], s29 offen offset:1024
  v_mfma_f32_16x16x32_bf16 v[152:155], v[56:59], v[12:15], v[152:155]
  v_mfma_f32_16x16x32_bf16 v[184:187], v[60:63], v[12:15], v[184:187]
  v_mfma_f32_16x16x32_bf16 v[216:219], v[64:67], v[12:15], v[216:219]
  s_waitcnt lgkmcnt(4)
  v_mfma_f32_16x16x32_bf16 v[92:95], v[48:51], v[16:19], v[92:95]
  ds_read_b128 v[12:15], v0 offset:14336
  v_mfma_f32_16x16x32_bf16 v[124:127], v[52:55], v[16:19], v[124:127]
  buffer_load_dwordx4 v[36:39], v0, s[8:11], s29 offen offset:2048
  v_mfma_f32_16x16x32_bf16 v[156:159], v[56:59], v[16:19], v[156:159]
  v_mfma_f32_16x16x32_bf16 v[188:191], v[60:63], v[16:19], v[188:191]
  v_mfma_f32_16x16x32_bf16 v[220:223], v[64:67], v[16:19], v[220:223]
  s_waitcnt lgkmcnt(4)
  v_mfma_f32_16x16x32_bf16 v[96:99], v[48:51], v[20:23], v[96:99]
  ds_read_b128 v[16:19], v0 offset:15360
  ds_read_b32 v250, v254 offset:1024
  v_mfma_f32_16x16x32_bf16 v[128:131], v[52:55], v[20:23], v[128:131]
  buffer_load_dwordx4 v[40:43], v0, s[8:11], s29 offen offset:3072
  v_mfma_f32_16x16x32_bf16 v[160:163], v[56:59], v[20:23], v[160:163]
  v_mfma_f32_16x16x32_bf16 v[192:195], v[60:63], v[20:23], v[192:195]
  v_mfma_f32_16x16x32_bf16 v[224:227], v[64:67], v[20:23], v[224:227]
  s_waitcnt lgkmcnt(5)
  v_mfma_f32_16x16x32_bf16 v[100:103], v[48:51], v[24:27], v[100:103]
  s_waitcnt lgkmcnt(0)
  v_cmp_gt_u32 vcc, 3, v250
  s_cbranch_vccnz per_A_x2s
per_A_x2r:
  ds_read_b128 v[20:23], v0 offset:16384
  v_mfma_f32_16x16x32_bf16 v[132:135], v[52:55], v[24:27], v[132:135]
  s_add_u32 s28, s21, 12288
  buffer_load_dwordx4 v[44:47], v0, s[8:11], s28 offen offset:0
  v_mfma_f32_16x16x32_bf16 v[164:167], v[56:59], v[24:27], v[164:167]
  v_mfma_f32_16x16x32_bf16 v[196:199], v[60:63], v[24:27], v[196:199]
  v_mfma_f32_16x16x32_bf16 v[228:231], v[64:67], v[24:27], v[228:231]
  v_mfma_f32_16x16x32_bf16 v[104:107], v[48:51], v[4:7], v[104:107]
  ds_read_b128 v[24:27], v0 offset:17408
  v_mfma_f32_16x16x32_bf16 v[136:139], v[52:55], v[4:7], v[136:139]
  v_mfma_f32_16x16x32_bf16 v[168:171], v[56:59], v[4:7], v[168:171]
  v_mfma_f32_16x16x32_bf16 v[200:203], v[60:63], v[4:7], v[200:203]
  v_mfma_f32_16x16x32_bf16 v[232:235], v[64:67], v[4:7], v[232:235]
  v_mfma_f32_16x16x32_bf16 v[108:111], v[48:51], v[8:11], v[108:111]
  ds_read_b128 v[4:7], v0 offset:18432
  v_mfma_f32_16x16x32_bf16 v[140:143], v[52:55], v[8:11], v[140:143]
  v_mfma_f32_16x16x32_bf16 v[172:175], v[56:59], v[8:11], v[172:175]
  v_mfma_f32_16x16x32_bf16 v[204:207], v[60:63], v[8:11], v[204:207]
  v_mfma_f32_16x16x32_bf16 v[236:239], v[64:67], v[8:11], v[236:239]
  v_mfma_f32_16x16x32_bf16 v[112:115], v[48:51], v[12:15], v[112:115]
  ds_read_b128 v[8:11], v0 offset:19456
  v_mfma_f32_16x16x32_bf16 v[144:147], v[52:55], v[12:15], v[144:147]
  v_mfma_f32_16x16x32_bf16 v[176:179], v[56:59], v[12:15], v[176:179]
  v_mfma_f32_16x16x32_bf16 v[208:211], v[60:63], v[12:15], v[208:211]
  v_mfma_f32_16x16x32_bf16 v[240:243], v[64:67], v[12:15], v[240:243]
  v_mfma_f32_16x16x32_bf16 v[116:119], v[48:51], v[16:19], v[116:119]
  ds_read_b128 v[12:15], v0 offset:20480
  v_mfma_f32_16x16x32_bf16 v[148:151], v[52:55], v[16:19], v[148:151]
  s_add_u32 s29, s20, 16384
  buffer_load_dwordx4 v[48:51], v0, s[8:11], s29 offen offset:0
  v_mfma_f32_16x16x32_bf16 v[180:183], v[56:59], v[16:19], v[180:183]
  v_mfma_f32_16x16x32_bf16 v[212:215], v[60:63], v[16:19], v[212:215]
  v_mfma_f32_16x16x32_bf16 v[244:247], v[64:67], v[16:19], v[244:247]
  s_waitcnt vmcnt(6) lgkmcnt(4)
  v_mfma_f32_16x16x32_bf16 v[88:91], v[68:71], v[20:23], v[88:91]
  ds_read_b128 v[16:19], v0 offset:21504
  v_mfma_f32_16x16x32_bf16 v[120:123], v[72:75], v[20:23], v[120:123]
  buffer_load_dwordx4 v[52:55], v0, s[8:11], s29 offen offset:1024
  v_mfma_f32_16x16x32_bf16 v[152:155], v[76:79], v[20:23], v[152:155]
  v_mfma_f32_16x16x32_bf16 v[184:187], v[80:83], v[20:23], v[184:187]
  v_mfma_f32_16x16x32_bf16 v[216:219], v[84:87], v[20:23], v[216:219]
  s_waitcnt lgkmcnt(4)
  v_mfma_f32_16x16x32_bf16 v[92:95], v[68:71], v[24:27], v[92:95]
  ds_read_b128 v[20:23], v0 offset:22528
  v_mfma_f32_16x16x32_bf16 v[124:127], v[72:75], v[24:27], v[124:127]
  buffer_load_dwordx4 v[56:59], v0, s[8:11], s29 offen offset:2048
  v_mfma_f32_16x16x32_bf16 v[156:159], v[76:79], v[24:27], v[156:159]
  v_mfma_f32_16x16x32_bf16 v[188:191], v[80:83], v[24:27], v[188:191]
  v_mfma_f32_16x16x32_bf16 v[220:223], v[84:87], v[24:27], v[220:223]
  s_waitcnt lgkmcnt(4)
  v_mfma_f32_16x16x32_bf16 v[96:99], v[68:71], v[4:7], v[96:99]
  ds_read_b128 v[24:27], v0 offset:23552
  ds_read_b32 v250, v254 offset:1024
  v_mfma_f32_16x16x32_bf16 v[128:131], v[72:75], v[4:7], v[128:131]
  buffer_load_dwordx4 v[60:63], v0, s[8:11], s29 offen offset:3072
  v_mfma_f32_16x16x32_bf16 v[160:163], v[76:79], v[4:7], v[160:163]
  v_mfma_f32_16x16x32_bf16 v[192:195], v[80:83], v[4:7], v[192:195]
  v_mfma_f32_16x16x32_bf16 v[224:227], v[84:87], v[4:7], v[224:227]
  s_waitcnt lgkmcnt(5)
  v_mfma_f32_16x16x32_bf16 v[100:103], v[68:71], v[8:11], v[100:103]
  s_waitcnt lgkmcnt(0)
  v_cmp_gt_u32 vcc, 4, v250
  s_cbranch_vccnz per_A_x3s
per_A_x3r:
  ds_read_b128 v[4:7], v0 offset:24576
  v_mfma_f32_16x16x32_bf16 v[132:135], v[72:75], v[8:11], v[132:135]
  s_add_u32 s28, s21, 16384
  buffer_load_dwordx4 v[64:67], v0, s[8:11], s28 offen offset:0
  v_mfma_f32_16x16x32_bf16 v[164:167], v[76:79], v[8:11], v[164:167]
  v_mfma_f32_16x16x32_bf16 v[196:199], v[80:83], v[8:11], v[196:199]
  v_mfma_f32_16x16x32_bf16 v[228:231], v[84:87], v[8:11], v[228:231]
  v_mfma_f32_16x16x32_bf16 v[104:107], v[68:71], v[12:15], v[104:107]
  ds_read_b128 v[8:11], v0 offset:25600
  v_mfma_f32_16x16x32_bf16 v[136:139], v[72:75], v[12:15], v[136:139]
  v_mfma_f32_16x16x32_bf16 v[168:171], v[76:79], v[12:15], v[168:171]
  v_mfma_f32_16x16x32_bf16 v[200:203], v[80:83], v[12:15], v[200:203]
  v_mfma_f32_16x16x32_bf16 v[232:235], v[84:87], v[12:15], v[232:235]
  v_mfma_f32_16x16x32_bf16 v[108:111], v[68:71], v[16:19], v[108:111]
  ds_read_b128 v[12:15], v0 offset:26624
  v_mfma_f32_16x16x32_bf16 v[140:143], v[72:75], v[16:19], v[140:143]
  v_mfma_f32_16x16x32_bf16 v[172:175], v[76:79], v[16:19], v[172:175]
  v_mfma_f32_16x16x32_bf16 v[204:207], v[80:83], v[16:19], v[204:207]
  v_mfma_f32_16x16x32_bf16 v[236:239], v[84:87], v[16:19], v[236:239]
  v_mfma_f32_16x16x32_bf16 v[112:115], v[68:71], v[20:23], v[112:115]
  ds_read_b128 v[16:19], v0 offset:27648
  v_mfma_f32_16x16x32_bf16 v[144:147], v[72:75], v[20:23], v[144:147]
  v_mfma_f32_16x16x32_bf16 v[176:179], v[76:79], v[20:23], v[176:179]
  v_mfma_f32_16x16x32_bf16 v[208:211], v[80:83], v[20:23], v[208:211]
  v_mfma_f32_16x16x32_bf16 v[240:243], v[84:87], v[20:23], v[240:243]
  v_mfma_f32_16x16x32_bf16 v[116:119], v[68:71], v[24:27], v[116:119]
  ds_read_b128 v[20:23], v0 offset:28672
  v_mfma_f32_16x16x32_bf16 v[148:151], v[72:75], v[24:27], v[148:151]
  s_add_u32 s29, s20, 20480
  buffer_load_dwordx4 v[68:71], v0, s[8:11], s29 offen offset:0
  v_mfma_f32_16x16x32_bf16 v[180:183], v[76:79], v[24:27], v[180:183]
  v_mfma_f32_16x16x32_bf16 v[212:215], v[80:83], v[24:27], v[212:215]
  v_mfma_f32_16x16x32_bf16 v[244:247], v[84:87], v[24:27], v[244:247]
  s_waitcnt vmcnt(6) lgkmcnt(4)
  v_mfma_f32_16x16x32_bf16 v[88:91], v[28:31], v[4:7], v[88:91]
  ds_read_b128 v[24:27], v0 offset:29696
  v_mfma_f32_16x16x32_bf16 v[120:123], v[32:35], v[4:7], v[120:123]
  buffer_load_dwordx4 v[72:75], v0, s[8:11], s29 offen offset:1024
  v_mfma_f32_16x16x32_bf16 v[152:155], v[36:39], v[4:7], v[152:155]
  v_mfma_f32_16x16x32_bf16 v[184:187], v[40:43], v[4:7], v[184:187]
  v_mfma_f32_16x16x32_bf16 v[216:219], v[44:47], v[4:7], v[216:219]
  s_waitcnt lgkmcnt(4)
  v_mfma_f32_16x16x32_bf16 v[92:95], v[28:31], v[8:11], v[92:95]
  ds_read_b128 v[4:7], v0 offset:30720
  v_mfma_f32_16x16x32_bf16 v[124:127], v[32:35], v[8:11], v[124:127]
  buffer_load_dwordx4 v[76:79], v0, s[8:11], s29 offen offset:2048
  v_mfma_f32_16x16x32_bf16 v[156:159], v[36:39], v[8:11], v[156:159]
  v_mfma_f32_16x16x32_bf16 v[188:191], v[40:43], v[8:11], v[188:191]
  v_mfma_f32_16x16x32_bf16 v[220:223], v[44:47], v[8:11], v[220:223]
  s_waitcnt lgkmcnt(4)
  v_mfma_f32_16x16x32_bf16 v[96:99], v[28:31], v[12:15], v[96:99]
  ds_read_b128 v[8:11], v0 offset:31744
  ds_read_b32 v250, v254 offset:1024
  v_mfma_f32_16x16x32_bf16 v[128:131], v[32:35], v[12:15], v[128:131]
  buffer_load_dwordx4 v[80:83], v0, s[8:11], s29 offen offset:3072
  v_mfma_f32_16x16x32_bf16 v[160:163], v[36:39], v[12:15], v[160:163]
  v_mfma_f32_16x16x32_bf16 v[192:195], v[40:43], v[12:15], v[192:195]
  v_mfma_f32_16x16x32_bf16 v[224:227], v[44:47], v[12:15], v[224:227]
  s_waitcnt lgkmcnt(5)
  v_mfma_f32_16x16x32_bf16 v[100:103], v[28:31], v[16:19], v[100:103]
  s_waitcnt lgkmcnt(0)
  v_cmp_gt_u32 vcc, 5, v250
  s_cbranch_vccnz per_A_x4s
per_A_x4r:
  ds_read_b128 v[12:15], v0 offset:32768
  v_mfma_f32_16x16x32_bf16 v[132:135], v[32:35], v[16:19], v[132:135]
  s_add_u32 s28, s21, 20480
  buffer_load_dwordx4 v[84:87], v0, s[8:11], s28 offen offset:0
  v_mfma_f32_16x16x32_bf16 v[164:167], v[36:39], v[16:19], v[164:167]
  v_mfma_f32_16x16x32_bf16 v[196:199], v[40:43], v[16:19], v[196:199]
  v_mfma_f32_16x16x32_bf16 v[228:231], v[44:47], v[16:19], v[228:231]
  v_mfma_f32_16x16x32_bf16 v[104:107], v[28:31], v[20:23], v[104:107]
  ds_read_b128 v[16:19], v0 offset:33792
  v_mfma_f32_16x16x32_bf16 v[136:139], v[32:35], v[20:23], v[136:139]
  v_mfma_f32_16x16x32_bf16 v[168:171], v[36:39], v[20:23], v[168:171]
  v_mfma_f32_16x16x32_bf16 v[200:203], v[40:43], v[20:23], v[200:203]
  v_mfma_f32_16x16x32_bf16 v[232:235], v[44:47], v[20:23], v[232:235]
  v_mfma_f32_16x16x32_bf16 v[108:111], v[28:31], v[24:27], v[108:111]
  ds_read_b128 v[20:23], v0 offset:34816
  v_mfma_f32_16x16x32_bf16 v[140:143], v[32:35], v[24:27], v[140:143]
  v_mfma_f32_16x16x32_bf16 v[172:175], v[36:39], v[24:27], v[172:175]
  v_mfma_f32_16x16x32_bf16 v[204:207], v[40:43], v[24:27], v[204:207]
  v_mfma_f32_16x16x32_bf16 v[236:239], v[44:47], v[24:27], v[236:239]
  v_mfma_f32_16x16x32_bf16 v[112:115], v[28:31], v[4:7], v[112:115]
  ds_read_b128 v[24:27], v0 offset:35840
  v_mfma_f32_16x16x32_bf16 v[144:147], v[32:35], v[4:7], v[144:147]
  v_mfma_f32_16x16x32_bf16 v[176:179], v[36:39], v[4:7], v[176:179]
  v_mfma_f32_16x16x32_bf16 v[208:211], v[40:43], v[4:7], v[208:211]
  v_mfma_f32_16x16x32_bf16 v[240:243], v[44:47], v[4:7], v[240:243]
  v_mfma_f32_16x16x32_bf16 v[116:119], v[28:31], v[8:11], v[116:119]
  ds_read_b128 v[4:7], v0 offset:36864
  v_mfma_f32_16x16x32_bf16 v[148:151], v[32:35], v[8:11], v[148:151]
  s_add_u32 s29, s20, 24576
  buffer_load_dwordx4 v[28:31], v0, s[8:11], s29 offen offset:0
  v_mfma_f32_16x16x32_bf16 v[180:183], v[36:39], v[8:11], v[180:183]
  v_mfma_f32_16x16x32_bf16 v[212:215], v[40:43], v[8:11], v[212:215]
  v_mfma_f32_16x16x32_bf16 v[244:247], v[44:47], v[8:11], v[244:247]
  s_waitcnt vmcnt(6) lgkmcnt(4)
  v_mfma_f32_16x16x32_bf16 v[88:91], v[48:51], v[12:15], v[88:91]
  ds_read_b128 v[8:11], v0 offset:37888
  v_mfma_f32_16x16x32_bf16 v[120:123], v[52:55], v[12:15], v[120:123]
  buffer_load_dwordx4 v[32:35], v0, s[8:11], s29 offen offset:1024
  v_mfma_f32_16x16x32_bf16 v[152:155], v[56:59], v[12:15], v[152:155]
  v_mfma_f32_16x16x32_bf16 v[184:187], v[60:63], v[12:15], v[184:187]
  v_mfma_f32_16x16x32_bf16 v[216:219], v[64:67], v[12:15], v[216:219]
  s_waitcnt lgkmcnt(4)
  v_mfma_f32_16x16x32_bf16 v[92:95], v[48:51], v[16:19], v[92:95]
  ds_read_b128 v[12:15], v0 offset:38912
  v_mfma_f32_16x16x32_bf16 v[124:127], v[52:55], v[16:19], v[124:127]
  buffer_load_dwordx4 v[36:39], v0, s[8:11], s29 offen offset:2048
  v_mfma_f32_16x16x32_bf16 v[156:159], v[56:59], v[16:19], v[156:159]
  v_mfma_f32_16x16x32_bf16 v[188:191], v[60:63], v[16:19], v[188:191]
  v_mfma_f32_16x16x32_bf16 v[220:223], v[64:67], v[16:19], v[220:223]
  s_waitcnt lgkmcnt(4)
  v_mfma_f32_16x16x32_bf16 v[96:99], v[48:51], v[20:23], v[96:99]
  ds_read_b128 v[16:19], v0 offset:39936
  ds_read_b32 v250, v254 offset:1024
  v_mfma_f32_16x16x32_bf16 v[128:131], v[52:55], v[20:23], v[128:131]
  buffer_load_dwordx4 v[40:43], v0, s[8:11], s29 offen offset:3072
  v_mfma_f32_16x16x32_bf16 v[160:163], v[56:59], v[20:23], v[160:163]
  v_mfma_f32_16x16x32_bf16 v[192:195], v[60:63], v[20:23], v[192:195]
  v_mfma_f32_16x16x32_bf16 v[224:227], v[64:67], v[20:23], v[224:227]
  s_waitcnt lgkmcnt(5)
  v_mfma_f32_16x16x32_bf16 v[100:103], v[48:51], v[24:27], v[100:103]
  s_waitcnt lgkmcnt(0)
  v_cmp_gt_u32 vcc, 6, v250
  s_cbranch_vccnz per_A_x5s
per_A_x5r:
  ds_read_b128 v[20:23], v0 offset:40960
  v_mfma_f32_16x16x32_bf16 v[132:135], v[52:55], v[24:27], v[132:135]
  s_add_u32 s28, s21, 24576
  buffer_load_dwordx4 v[44:47], v0, s[8:11], s28 offen offset:0
  v_mfma_f32_16x16x32_bf16 v[164:167], v[56:59], v[24:27], v[164:167]
  v_mfma_f32_16x16x32_bf16 v[196:199], v[60:63], v[24:27], v[196:199]
  v_mfma_f32_16x16x32_bf16 v[228:231], v[64:67], v[24:27], v[228:231]
  v_mfma_f32_16x16x32_bf16 v[104:107], v[48:51], v[4:7], v[104:107]
  ds_read_b128 v[24:27], v0 offset:41984
  v_mfma_f32_16x16x32_bf16 v[136:139], v[52:55], v[4:7], v[136:139]
  v_mfma_f32_16x16x32_bf16 v[168:171], v[56:59], v[4:7], v[168:171]
  v_mfma_f32_16x16x32_bf16 v[200:203], v[60:63], v[4:7], v[200:203]
  v_mfma_f32_16x16x32_bf16 v[232:235], v[64:67], v[4:7], v[232:235]
  v_mfma_f32_16x16x32_bf16 v[108:111], v[48:51], v[8:11], v[108:111]
  ds_read_b128 v[4:7], v0 offset:43008
  v_mfma_f32_16x16x32_bf16 v[140:143], v[52:55], v[8:11], v[140:143]
  v_mfma_f32_16x16x32_bf16 v[172:175], v[56:59], v[8:11], v[172:175]
  v_mfma_f32_16x16x32_bf16 v[204:207], v[60:63], v[8:11], v[204:207]
  v_mfma_f32_16x16x32_bf16 v[236:239], v[64:67], v[8:11], v[236:239]
  v_mfma_f32_16x16x32_bf16 v[112:115], v[48:51], v[12:15], v[112:115]
  ds_read_b128 v[8:11], v0 offset:44032
  v_mfma_f32_16x16x32_bf16 v[144:147], v[52:55], v[12:15], v[144:147]
  v_mfma_f32_16x16x32_bf16 v[176:179], v[56:59], v[12:15], v[176:179]
  v_mfma_f32_16x16x32_bf16 v[208:211], v[60:63], v[12:15], v[208:211]
  v_mfma_f32_16x16x32_bf16 v[240:243], v[64:67], v[12:15], v[240:243]
  v_mfma_f32_16x16x32_bf16 v[116:119], v[48:51], v[16:19], v[116:119]
  ds_read_b128 v[12:15], v0 offset:45056
  v_mfma_f32_16x16x32_bf16 v[148:151], v[52:55], v[16:19], v[148:151]
  s_add_u32 s29, s20, 28672
  buffer_load_dwordx4 v[48:51], v0, s[8:11], s29 offen offset:0
  v_mfma_f32_16x16x32_bf16 v[180:183], v[56:59], v[16:19], v[180:183]
  v_mfma_f32_16x16x32_bf16 v[212:215], v[60:63], v[16:19], v[212:215]
  v_mfma_f32_16x16x32_bf16 v[244:247], v[64:67], v[16:19], v[244:247]
  s_waitcnt vmcnt(6) lgkmcnt(4)
  v_mfma_f32_16x16x32_bf16 v[88:91], v[68:71], v[20:23], v[88:91]
  ds_read_b128 v[16:19], v0 offset:46080
  v_mfma_f32_16x16x32_bf16 v[120:123], v[72:75], v[20:23], v[120:123]
  buffer_load_dwordx4 v[52:55], v0, s[8:11], s29 offen offset:1024
  v_mfma_f32_16x16x32_bf16 v[152:155], v[76:79], v[20:23], v[152:155]
  v_mfma_f32_16x16x32_bf16 v[184:187], v[80:83], v[20:23], v[184:187]
  v_mfma_f32_16x16x32_bf16 v[216:219], v[84:87], v[20:23], v[216:219]
  s_waitcnt lgkmcnt(4)
  v_mfma_f32_16x16x32_bf16 v[92:95], v[68:71], v[24:27], v[92:95]
  ds_read_b128 v[20:23], v0 offset:47104
  v_mfma_f32_16x16x32_bf16 v[124:127], v[72:75], v[24:27], v[124:127]
  buffer_load_dwordx4 v[56:59], v0, s[8:11], s29 offen offset:2048
  v_mfma_f32_16x16x32_bf16 v[156:159], v[76:79], v[24:27], v[156:159]
  v_mfma_f32_16x16x32_bf16 v[188:191], v[80:83], v[24:27], v[188:191]
  v_mfma_f32_16x16x32_bf16 v[220:223], v[84:87], v[24:27], v[220:223]
  s_waitcnt lgkmcnt(4)
  v_mfma_f32_16x16x32_bf16 v[96:99], v[68:71], v[4:7], v[96:99]
  ds_read_b128 v[24:27], v0 offset:48128
  ds_read_b32 v250, v254 offset:1024
  v_mfma_f32_16x16x32_bf16 v[128:131], v[72:75], v[4:7], v[128:131]
  buffer_load_dwordx4 v[60:63], v0, s[8:11], s29 offen offset:3072
  v_mfma_f32_16x16x32_bf16 v[160:163], v[76:79], v[4:7], v[160:163]
  v_mfma_f32_16x16x32_bf16 v[192:195], v[80:83], v[4:7], v[192:195]
  v_mfma_f32_16x16x32_bf16 v[224:227], v[84:87], v[4:7], v[224:227]
  s_waitcnt lgkmcnt(5)
  v_mfma_f32_16x16x32_bf16 v[100:103], v[68:71], v[8:11], v[100:103]
  s_waitcnt lgkmcnt(0)
  v_cmp_gt_u32 vcc, 7, v250
  s_cbranch_vccnz per_A_x6s
per_A_x6r:
  ds_read_b128 v[4:7], v0 offset:49152
  v_mfma_f32_16x16x32_bf16 v[132:135], v[72:75], v[8:11], v[132:135]
  s_add_u32 s28, s21, 28672
  buffer_load_dwordx4 v[64:67], v0, s[8:11], s28 offen offset:0
  v_mfma_f32_16x16x32_bf16 v[164:167], v[76:79], v[8:11], v[164:167]
  v_mfma_f32_16x16x32_bf16 v[196:199], v[80:83], v[8:11], v[196:199]
  v_mfma_f32_16x16x32_bf16 v[228:231], v[84:87], v[8:11], v[228:231]
  v_mfma_f32_16x16x32_bf16 v[104:107], v[68:71], v[12:15], v[104:107]
  ds_read_b128 v[8:11], v0 offset:50176
  v_mfma_f32_16x16x32_bf16 v[136:139], v[72:75], v[12:15], v[136:139]
  v_mfma_f32_16x16x32_bf16 v[168:171], v[76:79], v[12:15], v[168:171]
  v_mfma_f32_16x16x32_bf16 v[200:203], v[80:83], v[12:15], v[200:203]
  v_mfma_f32_16x16x32_bf16 v[232:235], v[84:87], v[12:15], v[232:235]
  v_mfma_f32_16x16x32_bf16 v[108:111], v[68:71], v[16:19], v[108:111]
  ds_read_b128 v[12:15], v0 offset:51200
  v_mfma_f32_16x16x32_bf16 v[140:143], v[72:75], v[16:19], v[140:143]
  v_mfma_f32_16x16x32_bf16 v[172:175], v[76:79], v[16:19], v[172:175]
  v_mfma_f32_16x16x32_bf16 v[204:207], v[80:83], v[16:19], v[204:207]
  v_mfma_f32_16x16x32_bf16 v[236:239], v[84:87], v[16:19], v[236:239]
  v_mfma_f32_16x16x32_bf16 v[112:115], v[68:71], v[20:23], v[112:115]
  ds_read_b128 v[16:19], v0 offset:52224
  v_mfma_f32_16x16x32_bf16 v[144:147], v[72:75], v[20:23], v[144:147]
  v_mfma_f32_16x16x32_bf16 v[176:179], v[76:79], v[20:23], v[176:179]
  v_mfma_f32_16x16x32_bf16 v[208:211], v[80:83], v[20:23], v[208:211]
  v_mfma_f32_16x16x32_bf16 v[240:243], v[84:87], v[20:23], v[240:243]
  v_mfma_f32_16x16x32_bf16 v[116:119], v[68:71], v[24:27], v[116:119]
  ds_read_b128 v[20:23], v0 offset:53248
  v_mfma_f32_16x16x32_bf16 v[148:151], v[72:75], v[24:27], v[148:151]
  s_add_u32 s29, s20, 32768
  buffer_load_dwordx4 v[68:71], v0, s[8:11], s29 offen offset:0
  v_mfma_f32_16x16x32_bf16 v[180:183], v[76:79], v[24:27], v[180:183]
  v_mfma_f32_16x16x32_bf16 v[212:215], v[80:83], v[24:27], v[212:215]
  v_mfma_f32_16x16x32_bf16 v[244:247], v[84:87], v[24:27], v[244:247]
  s_waitcnt vmcnt(6) lgkmcnt(4)
  v_mfma_f32_16x16x32_bf16 v[88:91], v[28:31], v[4:7], v[88:91]
  ds_read_b128 v[24:27], v0 offset:54272
  v_mfma_f32_16x16x32_bf16 v[120:123], v[32:35], v[4:7], v[120:123]
  buffer_load_dwordx4 v[72:75], v0, s[8:11], s29 offen offset:1024
  v_mfma_f32_16x16x32_bf16 v[152:155], v[36:39], v[4:7], v[152:155]
  v_mfma_f32_16x16x32_bf16 v[184:187], v[40:43], v[4:7], v[184:187]
  v_mfma_f32_16x16x32_bf16 v[216:219], v[44:47], v[4:7], v[216:219]
  s_waitcnt lgkmcnt(4)
  v_mfma_f32_16x16x32_bf16 v[92:95], v[28:31], v[8:11], v[92:95]
  ds_read_b128 v[4:7], v0 offset:55296
  v_mfma_f32_16x16x32_bf16 v[124:127], v[32:35], v[8:11], v[124:127]
  buffer_load_dwordx4 v[76:79], v0, s[8:11], s29 offen offset:2048
  v_mfma_f32_16x16x32_bf16 v[156:159], v[36:39], v[8:11], v[156:159]
  v_mfma_f32_16x16x32_bf16 v[188:191], v[40:43], v[8:11], v[188:191]
  v_mfma_f32_16x16x32_bf16 v[220:223], v[44:47], v[8:11], v[220:223]
  s_waitcnt lgkmcnt(4)
  v_mfma_f32_16x16x32_bf16 v[96:99], v[28:31], v[12:15], v[96:99]
  ds_read_b128 v[8:11], v0 offset:56320
  ds_read_b32 v250, v254 offset:1024
  v_mfma_f32_16x16x32_bf16 v[128:131], v[32:35], v[12:15], v[128:131]
  buffer_load_dwordx4 v[80:83], v0, s[8:11], s29 offen offset:3072
  v_mfma_f32_16x16x32_bf16 v[160:163], v[36:39], v[12:15], v[160:163]
  v_mfma_f32_16x16x32_bf16 v[192:195], v[40:43], v[12:15], v[192:195]
  v_mfma_f32_16x16x32_bf16 v[224:227], v[44:47], v[12:15], v[224:227]
  s_waitcnt lgkmcnt(5)
  v_mfma_f32_16x16x32_bf16 v[100:103], v[28:31], v[16:19], v[100:103]
  s_waitcnt lgkmcnt(0)
  v_cmp_gt_u32 vcc, 8, v250
  s_cbranch_vccnz per_A_x7s
per_A_x7r:
  ds_read_b128 v[12:15], v0 offset:57344
  v_mfma_f32_16x16x32_bf16 v[132:135], v[32:35], v[16:19], v[132:135]
  s_add_u32 s28, s21, 32768
  buffer_load_dwordx4 v[84:87], v0, s[8:11], s28 offen offset:0
  v_mfma_f32_16x16x32_bf16 v[164:167], v[36:39], v[16:19], v[164:167]
  v_mfma_f32_16x16x32_bf16 v[196:199], v[40:43], v[16:19], v[196:199]
  v_mfma_f32_16x16x32_bf16 v[228:231], v[44:47], v[16:19], v[228:231]
  v_mfma_f32_16x16x32_bf16 v[104:107], v[28:31], v[20:23], v[104:107]
  ds_read_b128 v[16:19], v0 offset:58368
  v_mfma_f32_16x16x32_bf16 v[136:139], v[32:35], v[20:23], v[136:139]
  v_mfma_f32_16x16x32_bf16 v[168:171], v[36:39], v[20:23], v[168:171]
  v_mfma_f32_16x16x32_bf16 v[200:203], v[40:43], v[20:23], v[200:203]
  v_mfma_f32_16x16x32_bf16 v[232:235], v[44:47], v[20:23], v[232:235]
  v_mfma_f32_16x16x32_bf16 v[108:111], v[28:31], v[24:27], v[108:111]
  ds_read_b128 v[20:23], v0 offset:59392
  v_mfma_f32_16x16x32_bf16 v[140:143], v[32:35], v[24:27], v[140:143]
  v_mfma_f32_16x16x32_bf16 v[172:175], v[36:39], v[24:27], v[172:175]
  v_mfma_f32_16x16x32_bf16 v[204:207], v[40:43], v[24:27], v[204:207]
  v_mfma_f32_16x16x32_bf16 v[236:239], v[44:47], v[24:27], v[236:239]
  v_mfma_f32_16x16x32_bf16 v[112:115], v[28:31], v[4:7], v[112:115]
  ds_read_b128 v[24:27], v0 offset:60416
  v_mfma_f32_16x16x32_bf16 v[144:147], v[32:35], v[4:7], v[144:147]
  v_mfma_f32_16x16x32_bf16 v[176:179], v[36:39], v[4:7], v[176:179]
  v_mfma_f32_16x16x32_bf16 v[208:211], v[40:43], v[4:7], v[208:211]
  v_mfma_f32_16x16x32_bf16 v[240:243], v[44:47], v[4:7], v[240:243]
  v_mfma_f32_16x16x32_bf16 v[116:119], v[28:31], v[8:11], v[116:119]
  ds_read_b128 v[4:7], v0 offset:61440
  v_mfma_f32_16x16x32_bf16 v[148:151], v[32:35], v[8:11], v[148:151]
  s_add_u32 s29, s20, 36864
  buffer_load_dwordx4 v[28:31], v0, s[8:11], s29 offen offset:0
  v_mfma_f32_16x16x32_bf16 v[180:183], v[36:39], v[8:11], v[180:183]
  v_mfma_f32_16x16x32_bf16 v[212:215], v[40:43], v[8:11], v[212:215]
  v_mfma_f32_16x16x32_bf16 v[244:247], v[44:47], v[8:11], v[244:247]
  s_waitcnt vmcnt(6) lgkmcnt(4)
  v_mfma_f32_16x16x32_bf16 v[88:91], v[48:51], v[12:15], v[88:91]
  ds_read_b128 v[8:11], v0 offset:62464
  v_mfma_f32_16x16x32_bf16 v[120:123], v[52:55], v[12:15], v[120:123]
  buffer_load_dwordx4 v[32:35], v0, s[8:11], s29 offen offset:1024
  v_mfma_f32_16x16x32_bf16 v[152:155], v[56:59], v[12:15], v[152:155]
  v_mfma_f32_16x16x32_bf16 v[184:187], v[60:63], v[12:15], v[184:187]
  v_mfma_f32_16x16x32_bf16 v[216:219], v[64:67], v[12:15], v[216:219]
  s_waitcnt lgkmcnt(4)
  v_mfma_f32_16x16x32_bf16 v[92:95], v[48:51], v[16:19], v[92:95]
  ds_read_b128 v[12:15], v0 offset:63488
  v_mfma_f32_16x16x32_bf16 v[124:127], v[52:55], v[16:19], v[124:127]
  buffer_load_dwordx4 v[36:39], v0, s[8:11], s29 offen offset:2048
  v_mfma_f32_16x16x32_bf16 v[156:159], v[56:59], v[16:19], v[156:159]
  v_mfma_f32_16x16x32_bf16 v[188:191], v[60:63], v[16:19], v[188:191]
  v_mfma_f32_16x16x32_bf16 v[220:223], v[64:67], v[16:19], v[220:223]
  s_waitcnt lgkmcnt(4)
  v_mfma_f32_16x16x32_bf16 v[96:99], v[48:51], v[20:23], v[96:99]
  ds_read_b128 v[16:19], v0 offset:64512
  ds_read_b32 v250, v254 offset:1024
  v_mfma_f32_16x16x32_bf16 v[128:131], v[52:55], v[20:23], v[128:131]
  buffer_load_dwordx4 v[40:43], v0, s[8:11], s29 offen offset:3072
  v_mfma_f32_16x16x32_bf16 v[160:163], v[56:59], v[20:23], v[160:163]
  v_mfma_f32_16x16x32_bf16 v[192:195], v[60:63], v[20:23], v[192:195]
  v_mfma_f32_16x16x32_bf16 v[224:227], v[64:67], v[20:23], v[224:227]
  s_waitcnt lgkmcnt(5)
  v_mfma_f32_16x16x32_bf16 v[100:103], v[48:51], v[24:27], v[100:103]
  s_waitcnt lgkmcnt(0)
  v_cmp_gt_u32 vcc, 9, v250
  s_cbranch_vccnz per_A_x8s
per_A_x8r:
  ds_read_b128 v[20:23], v1 offset:0
  v_mfma_f32_16x16x32_bf16 v[132:135], v[52:55], v[24:27], v[132:135]
  s_add_u32 s28, s21, 36864
  buffer_load_dwordx4 v[44:47], v0, s[8:11], s28 offen offset:0
  v_mfma_f32_16x16x32_bf16 v[164:167], v[56:59], v[24:27], v[164:167]
  v_mfma_f32_16x16x32_bf16 v[196:199], v[60:63], v[24:27], v[196:199]
  v_mfma_f32_16x16x32_bf16 v[228:231], v[64:67], v[24:27], v[228:231]
  v_mfma_f32_16x16x32_bf16 v[104:107], v[48:51], v[4:7], v[104:107]
  ds_read_b128 v[24:27], v1 offset:1024
  v_mfma_f32_16x16x32_bf16 v[136:139], v[52:55], v[4:7], v[136:139]
  v_mfma_f32_16x16x32_bf16 v[168:171], v[56:59], v[4:7], v[168:171]
  v_mfma_f32_16x16x32_bf16 v[200:203], v[60:63], v[4:7], v[200:203]
  v_mfma_f32_16x16x32_bf16 v[232:235], v[64:67], v[4:7], v[232:235]
  v_mfma_f32_16x16x32_bf16 v[108:111], v[48:51], v[8:11], v[108:111]
  ds_read_b128 v[4:7], v1 offset:2048
  v_mfma_f32_16x16x32_bf16 v[140:143], v[52:55], v[8:11], v[140:143]
  v_mfma_f32_16x16x32_bf16 v[172:175], v[56:59], v[8:11], v[172:175]
  v_mfma_f32_16x16x32_bf16 v[204:207], v[60:63], v[8:11], v[204:207]
  v_mfma_f32_16x16x32_bf16 v[236:239], v[64:67], v[8:11], v[236:239]
  v_mfma_f32_16x16x32_bf16 v[112:115], v[48:51], v[12:15], v[112:115]
  ds_read_b128 v[8:11], v1 offset:3072
  v_mfma_f32_16x16x32_bf16 v[144:147], v[52:55], v[12:15], v[144:147]
  v_mfma_f32_16x16x32_bf16 v[176:179], v[56:59], v[12:15], v[176:179]
  v_mfma_f32_16x16x32_bf16 v[208:211], v[60:63], v[12:15], v[208:211]
  v_mfma_f32_16x16x32_bf16 v[240:243], v[64:67], v[12:15], v[240:243]
  v_mfma_f32_16x16x32_bf16 v[116:119], v[48:51], v[16:19], v[116:119]
  ds_read_b128 v[12:15], v1 offset:4096
  v_mfma_f32_16x16x32_bf16 v[148:151], v[52:55], v[16:19], v[148:151]
  s_add_u32 s29, s20, 40960
  buffer_load_dwordx4 v[48:51], v0, s[8:11], s29 offen offset:0
  v_mfma_f32_16x16x32_bf16 v[180:183], v[56:59], v[16:19], v[180:183]
  v_mfma_f32_16x16x32_bf16 v[212:215], v[60:63], v[16:19], v[212:215]
  v_mfma_f32_16x16x32_bf16 v[244:247], v[64:67], v[16:19], v[244:247]
  s_waitcnt vmcnt(6) lgkmcnt(4)
  v_mfma_f32_16x16x32_bf16 v[88:91], v[68:71], v[20:23], v[88:91]
  ds_read_b128 v[16:19], v1 offset:5120
  v_mfma_f32_16x16x32_bf16 v[120:123], v[72:75], v[20:23], v[120:123]
  buffer_load_dwordx4 v[52:55], v0, s[8:11], s29 offen offset:1024
  v_mfma_f32_16x16x32_bf16 v[152:155], v[76:79], v[20:23], v[152:155]
  v_mfma_f32_16x16x32_bf16 v[184:187], v[80:83], v[20:23], v[184:187]
  v_mfma_f32_16x16x32_bf16 v[216:219], v[84:87], v[20:23], v[216:219]
  s_waitcnt lgkmcnt(4)
  v_mfma_f32_16x16x32_bf16 v[92:95], v[68:71], v[24:27], v[92:95]
  ds_read_b128 v[20:23], v1 offset:6144
  v_mfma_f32_16x16x32_bf16 v[124:127], v[72:75], v[24:27], v[124:127]
  buffer_load_dwordx4 v[56:59], v0, s[8:11], s29 offen offset:2048
  v_mfma_f32_16x16x32_bf16 v[156:159], v[76:79], v[24:27], v[156:159]
  v_mfma_f32_16x16x32_bf16 v[188:191], v[80:83], v[24:27], v[188:191]
  v_mfma_f32_16x16x32_bf16 v[220:223], v[84:87], v[24:27], v[220:223]
  s_waitcnt lgkmcnt(4)
  v_mfma_f32_16x16x32_bf16 v[96:99], v[68:71], v[4:7], v[96:99]
  ds_read_b128 v[24:27], v1 offset:7168
  ds_read_b32 v250, v254 offset:1024
  v_mfma_f32_16x16x32_bf16 v[128:131], v[72:75], v[4:7], v[128:131]
  buffer_load_dwordx4 v[60:63], v0, s[8:11], s29 offen offset:3072
  v_mfma_f32_16x16x32_bf16 v[160:163], v[76:79], v[4:7], v[160:163]
  v_mfma_f32_16x16x32_bf16 v[192:195], v[80:83], v[4:7], v[192:195]
  v_mfma_f32_16x16x32_bf16 v[224:227], v[84:87], v[4:7], v[224:227]
  s_waitcnt lgkmcnt(5)
  v_mfma_f32_16x16x32_bf16 v[100:103], v[68:71], v[8:11], v[100:103]
  s_waitcnt lgkmcnt(0)
  v_cmp_gt_u32 vcc, 10, v250
  s_cbranch_vccnz per_A_x9s
per_A_x9r:
  ds_read_b128 v[4:7], v1 offset:8192
  v_mfma_f32_16x16x32_bf16 v[132:135], v[72:75], v[8:11], v[132:135]
  s_add_u32 s28, s21, 40960
  buffer_load_dwordx4 v[64:67], v0, s[8:11], s28 offen offset:0
  v_mfma_f32_16x16x32_bf16 v[164:167], v[76:79], v[8:11], v[164:167]
  v_mfma_f32_16x16x32_bf16 v[196:199], v[80:83], v[8:11], v[196:199]
  v_mfma_f32_16x16x32_bf16 v[228:231], v[84:87], v[8:11], v[228:231]
  v_mfma_f32_16x16x32_bf16 v[104:107], v[68:71], v[12:15], v[104:107]
  ds_read_b128 v[8:11], v1 offset:9216
  v_mfma_f32_16x16x32_bf16 v[136:139], v[72:75], v[12:15], v[136:139]
  v_mfma_f32_16x16x32_bf16 v[168:171], v[76:79], v[12:15], v[168:171]
  v_mfma_f32_16x16x32_bf16 v[200:203], v[80:83], v[12:15], v[200:203]
  v_mfma_f32_16x16x32_bf16 v[232:235], v[84:87], v[12:15], v[232:235]
  v_mfma_f32_16x16x32_bf16 v[108:111], v[68:71], v[16:19], v[108:111]
  ds_read_b128 v[12:15], v1 offset:10240
  v_mfma_f32_16x16x32_bf16 v[140:143], v[72:75], v[16:19], v[140:143]
  v_mfma_f32_16x16x32_bf16 v[172:175], v[76:79], v[16:19], v[172:175]
  v_mfma_f32_16x16x32_bf16 v[204:207], v[80:83], v[16:19], v[204:207]
  v_mfma_f32_16x16x32_bf16 v[236:239], v[84:87], v[16:19], v[236:239]
  v_mfma_f32_16x16x32_bf16 v[112:115], v[68:71], v[20:23], v[112:115]
  ds_read_b128 v[16:19], v1 offset:11264
  v_mfma_f32_16x16x32_bf16 v[144:147], v[72:75], v[20:23], v[144:147]
  v_mfma_f32_16x16x32_bf16 v[176:179], v[76:79], v[20:23], v[176:179]
  v_mfma_f32_16x16x32_bf16 v[208:211], v[80:83], v[20:23], v[208:211]
  v_mfma_f32_16x16x32_bf16 v[240:243], v[84:87], v[20:23], v[240:243]
  v_mfma_f32_16x16x32_bf16 v[116:119], v[68:71], v[24:27], v[116:119]
  ds_read_b128 v[20:23], v1 offset:12288
  v_mfma_f32_16x16x32_bf16 v[148:151], v[72:75], v[24:27], v[148:151]
  s_add_u32 s29, s20, 45056
  buffer_load_dwordx4 v[68:71], v0, s[8:11], s29 offen offset:0
  v_mfma_f32_16x16x32_bf16 v[180:183], v[76:79], v[24:27], v[180:183]
  v_mfma_f32_16x16x32_bf16 v[212:215], v[80:83], v[24:27], v[212:215]
  v_mfma_f32_16x16x32_bf16 v[244:247], v[84:87], v[24:27], v[244:247]
  s_waitcnt vmcnt(6) lgkmcnt(4)
  v_mfma_f32_16x16x32_bf16 v[88:91], v[28:31], v[4:7], v[88:91]
  ds_read_b128 v[24:27], v1 offset:13312
  v_mfma_f32_16x16x32_bf16 v[120:123], v[32:35], v[4:7], v[120:123]
  buffer_load_dwordx4 v[72:75], v0, s[8:11], s29 offen offset:1024
  v_mfma_f32_16x16x32_bf16 v[152:155], v[36:39], v[4:7], v[152:155]
  v_mfma_f32_16x16x32_bf16 v[184:187], v[40:43], v[4:7], v[184:187]
  v_mfma_f32_16x16x32_bf16 v[216:219], v[44:47], v[4:7], v[216:219]
  s_waitcnt lgkmcnt(4)
  v_mfma_f32_16x16x32_bf16 v[92:95], v[28:31], v[8:11], v[92:95]
  ds_read_b128 v[4:7], v1 offset:14336
  v_mfma_f32_16x16x32_bf16 v[124:127], v[32:35], v[8:11], v[124:127]
  buffer_load_dwordx4 v[76:79], v0, s[8:11], s29 offen offset:2048
  v_mfma_f32_16x16x32_bf16 v[156:159], v[36:39], v[8:11], v[156:159]
  v_mfma_f32_16x16x32_bf16 v[188:191], v[40:43], v[8:11], v[188:191]
  v_mfma_f32_16x16x32_bf16 v[220:223], v[44:47], v[8:11], v[220:223]
  s_waitcnt lgkmcnt(4)
  v_mfma_f32_16x16x32_bf16 v[96:99], v[28:31], v[12:15], v[96:99]
  ds_read_b128 v[8:11], v1 offset:15360
  ds_read_b32 v250, v254 offset:1024
  v_mfma_f32_16x16x32_bf16 v[128:131], v[32:35], v[12:15], v[128:131]
  buffer_load_dwordx4 v[80:83], v0, s[8:11], s29 offen offset:3072
  v_mfma_f32_16x16x32_bf16 v[160:163], v[36:39], v[12:15], v[160:163]
  v_mfma_f32_16x16x32_bf16 v[192:195], v[40:43], v[12:15], v[192:195]
  v_mfma_f32_16x16x32_bf16 v[224:227], v[44:47], v[12:15], v[224:227]
  s_waitcnt lgkmcnt(5)
  v_mfma_f32_16x16x32_bf16 v[100:103], v[28:31], v[16:19], v[100:103]
  s_waitcnt lgkmcnt(0)
  v_cmp_gt_u32 vcc, 11, v250
  s_cbranch_vccnz per_A_x10s
per_A_x10r:
  ds_read_b128 v[12:15], v1 offset:16384
  v_mfma_f32_16x16x32_bf16 v[132:135], v[32:35], v[16:19], v[132:135]
  s_add_u32 s28, s21, 45056
  buffer_load_dwordx4 v[84:87], v0, s[8:11], s28 offen offset:0
  v_mfma_f32_16x16x32_bf16 v[164:167], v[36:39], v[16:19], v[164:167]
  v_mfma_f32_16x16x32_bf16 v[196:199], v[40:43], v[16:19], v[196:199]
  v_mfma_f32_16x16x32_bf16 v[228:231], v[44:47], v[16:19], v[228:231]
  v_mfma_f32_16x16x32_bf16 v[104:107], v[28:31], v[20:23], v[104:107]
  ds_read_b128 v[16:19], v1 offset:17408
  v_mfma_f32_16x16x32_bf16 v[136:139], v[32:35], v[20:23], v[136:139]
  v_mfma_f32_16x16x32_bf16 v[168:171], v[36:39], v[20:23], v[168:171]
  v_mfma_f32_16x16x32_bf16 v[200:203], v[40:43], v[20:23], v[200:203]
  v_mfma_f32_16x16x32_bf16 v[232:235], v[44:47], v[20:23], v[232:235]
  v_mfma_f32_16x16x32_bf16 v[108:111], v[28:31], v[24:27], v[108:111]
  ds_read_b128 v[20:23], v1 offset:18432
  v_mfma_f32_16x16x32_bf16 v[140:143], v[32:35], v[24:27], v[140:143]
  v_mfma_f32_16x16x32_bf16 v[172:175], v[36:39], v[24:27], v[172:175]
  v_mfma_f32_16x16x32_bf16 v[204:207], v[40:43], v[24:27], v[204:207]
  v_mfma_f32_16x16x32_bf16 v[236:239], v[44:47], v[24:27], v[236:239]
  v_mfma_f32_16x16x32_bf16 v[112:115], v[28:31], v[4:7], v[112:115]
  ds_read_b128 v[24:27], v1 offset:19456
  v_mfma_f32_16x16x32_bf16 v[144:147], v[32:35], v[4:7], v[144:147]
  v_mfma_f32_16x16x32_bf16 v[176:179], v[36:39], v[4:7], v[176:179]
  v_mfma_f32_16x16x32_bf16 v[208:211], v[40:43], v[4:7], v[208:211]
  v_mfma_f32_16x16x32_bf16 v[240:243], v[44:47], v[4:7], v[240:243]
  v_mfma_f32_16x16x32_bf16 v[116:119], v[28:31], v[8:11], v[116:119]
  ds_read_b128 v[4:7], v1 offset:20480
  v_mfma_f32_16x16x32_bf16 v[148:151], v[32:35], v[8:11], v[148:151]
  s_add_u32 s29, s20, 49152
  buffer_load_dwordx4 v[28:31], v0, s[8:11], s29 offen offset:0
  v_mfma_f32_16x16x32_bf16 v[180:183], v[36:39], v[8:11], v[180:183]
  v_mfma_f32_16x16x32_bf16 v[212:215], v[40:43], v[8:11], v[212:215]
  v_mfma_f32_16x16x32_bf16 v[244:247], v[44:47], v[8:11], v[244:247]
  s_waitcnt vmcnt(6) lgkmcnt(4)
  v_mfma_f32_16x16x32_bf16 v[88:91], v[48:51], v[12:15], v[88:91]
  ds_read_b128 v[8:11], v1 offset:21504
  v_mfma_f32_16x16x32_bf16 v[120:123], v[52:55], v[12:15], v[120:123]
  buffer_load_dwordx4 v[32:35], v0, s[8:11], s29 offen offset:1024
  v_mfma_f32_16x16x32_bf16 v[152:155], v[56:59], v[12:15], v[152:155]
  v_mfma_f32_16x16x32_bf16 v[184:187], v[60:63], v[12:15], v[184:187]
  v_mfma_f32_16x16x32_bf16 v[216:219], v[64:67], v[12:15], v[216:219]
  s_waitcnt lgkmcnt(4)
  v_mfma_f32_16x16x32_bf16 v[92:95], v[48:51], v[16:19], v[92:95]
  ds_read_b128 v[12:15], v1 offset:22528
  v_mfma_f32_16x16x32_bf16 v[124:127], v[52:55], v[16:19], v[124:127]
  buffer_load_dwordx4 v[36:39], v0, s[8:11], s29 offen offset:2048
  v_mfma_f32_16x16x32_bf16 v[156:159], v[56:59], v[16:19], v[156:159]
  v_mfma_f32_16x16x32_bf16 v[188:191], v[60:63], v[16:19], v[188:191]
  v_mfma_f32_16x16x32_bf16 v[220:223], v[64:67], v[16:19], v[220:223]
  s_waitcnt lgkmcnt(4)
  v_mfma_f32_16x16x32_bf16 v[96:99], v[48:51], v[20:23], v[96:99]
  ds_read_b128 v[16:19], v1 offset:23552
  ds_read_b32 v250, v254 offset:1024
  v_mfma_f32_16x16x32_bf16 v[128:131], v[52:55], v[20:23], v[128:131]
  buffer_load_dwordx4 v[40:43], v0, s[8:11], s29 offen offset:3072
  v_mfma_f32_16x16x32_bf16 v[160:163], v[56:59], v[20:23], v[160:163]
  v_mfma_f32_16x16x32_bf16 v[192:195], v[60:63], v[20:23], v[192:195]
  v_mfma_f32_16x16x32_bf16 v[224:227], v[64:67], v[20:23], v[224:227]
  s_waitcnt lgkmcnt(5)
  v_mfma_f32_16x16x32_bf16 v[100:103], v[48:51], v[24:27], v[100:103]
  s_waitcnt lgkmcnt(0)
  v_cmp_gt_u32 vcc, 12, v250
  s_cbranch_vccnz per_A_x11s
per_A_x11r:
  ds_read_b128 v[20:23], v1 offset:24576
  v_mfma_f32_16x16x32_bf16 v[132:135], v[52:55], v[24:27], v[132:135]
  s_add_u32 s28, s21, 49152
  buffer_load_dwordx4 v[44:47], v0, s[8:11], s28 offen offset:0
  v_mfma_f32_16x16x32_bf16 v[164:167], v[56:59], v[24:27], v[164:167]
  v_mfma_f32_16x16x32_bf16 v[196:199], v[60:63], v[24:27], v[196:199]
  v_mfma_f32_16x16x32_bf16 v[228:231], v[64:67], v[24:27], v[228:231]
  v_mfma_f32_16x16x32_bf16 v[104:107], v[48:51], v[4:7], v[104:107]
  ds_read_b128 v[24:27], v1 offset:25600
  v_mfma_f32_16x16x32_bf16 v[136:139], v[52:55], v[4:7], v[136:139]
  v_mfma_f32_16x16x32_bf16 v[168:171], v[56:59], v[4:7], v[168:171]
  v_mfma_f32_16x16x32_bf16 v[200:203], v[60:63], v[4:7], v[200:203]
  v_mfma_f32_16x16x32_bf16 v[232:235], v[64:67], v[4:7], v[232:235]
  v_mfma_f32_16x16x32_bf16 v[108:111], v[48:51], v[8:11], v[108:111]
  ds_read_b128 v[4:7], v1 offset:26624
  v_mfma_f32_16x16x32_bf16 v[140:143], v[52:55], v[8:11], v[140:143]
  v_mfma_f32_16x16x32_bf16 v[172:175], v[56:59], v[8:11], v[172:175]
  v_mfma_f32_16x16x32_bf16 v[204:207], v[60:63], v[8:11], v[204:207]
  v_mfma_f32_16x16x32_bf16 v[236:239], v[64:67], v[8:11], v[236:239]
  v_mfma_f32_16x16x32_bf16 v[112:115], v[48:51], v[12:15], v[112:115]
  ds_read_b128 v[8:11], v1 offset:27648
  v_mfma_f32_16x16x32_bf16 v[144:147], v[52:55], v[12:15], v[144:147]
  v_mfma_f32_16x16x32_bf16 v[176:179], v[56:59], v[12:15], v[176:179]
  v_mfma_f32_16x16x32_bf16 v[208:211], v[60:63], v[12:15], v[208:211]
  v_mfma_f32_16x16x32_bf16 v[240:243], v[64:67], v[12:15], v[240:243]
  v_mfma_f32_16x16x32_bf16 v[116:119], v[48:51], v[16:19], v[116:119]
  ds_read_b128 v[12:15], v1 offset:28672
  v_mfma_f32_16x16x32_bf16 v[148:151], v[52:55], v[16:19], v[148:151]
  s_add_u32 s29, s20, 53248
  buffer_load_dwordx4 v[48:51], v0, s[8:11], s29 offen offset:0
  v_mfma_f32_16x16x32_bf16 v[180:183], v[56:59], v[16:19], v[180:183]
  v_mfma_f32_16x16x32_bf16 v[212:215], v[60:63], v[16:19], v[212:215]
  v_mfma_f32_16x16x32_bf16 v[244:247], v[64:67], v[16:19], v[244:247]
  s_waitcnt vmcnt(6) lgkmcnt(4)
  v_mfma_f32_16x16x32_bf16 v[88:91], v[68:71], v[20:23], v[88:91]
  ds_read_b128 v[16:19], v1 offset:29696
  v_mfma_f32_16x16x32_bf16 v[120:123], v[72:75], v[20:23], v[120:123]
  buffer_load_dwordx4 v[52:55], v0, s[8:11], s29 offen offset:1024
  v_mfma_f32_16x16x32_bf16 v[152:155], v[76:79], v[20:23], v[152:155]
  v_mfma_f32_16x16x32_bf16 v[184:187], v[80:83], v[20:23], v[184:187]
  v_mfma_f32_16x16x32_bf16 v[216:219], v[84:87], v[20:23], v[216:219]
  s_waitcnt lgkmcnt(4)
  v_mfma_f32_16x16x32_bf16 v[92:95], v[68:71], v[24:27], v[92:95]
  ds_read_b128 v[20:23], v1 offset:30720
  v_mfma_f32_16x16x32_bf16 v[124:127], v[72:75], v[24:27], v[124:127]
  buffer_load_dwordx4 v[56:59], v0, s[8:11], s29 offen offset:2048
  v_mfma_f32_16x16x32_bf16 v[156:159], v[76:79], v[24:27], v[156:159]
  v_mfma_f32_16x16x32_bf16 v[188:191], v[80:83], v[24:27], v[188:191]
  v_mfma_f32_16x16x32_bf16 v[220:223], v[84:87], v[24:27], v[220:223]
  s_waitcnt lgkmcnt(4)
  v_mfma_f32_16x16x32_bf16 v[96:99], v[68:71], v[4:7], v[96:99]
  ds_read_b128 v[24:27], v1 offset:31744
  ds_read_b32 v250, v254 offset:1024
  v_mfma_f32_16x16x32_bf16 v[128:131], v[72:75], v[4:7], v[128:131]
  buffer_load_dwordx4 v[60:63], v0, s[8:11], s29 offen offset:3072
  v_mfma_f32_16x16x32_bf16 v[160:163], v[76:79], v[4:7], v[160:163]
  v_mfma_f32_16x16x32_bf16 v[192:195], v[80:83], v[4:7], v[192:195]
  v_mfma_f32_16x16x32_bf16 v[224:227], v[84:87], v[4:7], v[224:227]
  s_waitcnt lgkmcnt(5)
  v_mfma_f32_16x16x32_bf16 v[100:103], v[68:71], v[8:11], v[100:103]
  s_waitcnt lgkmcnt(0)
  v_cmp_gt_u32 vcc, 13, v250
  s_cbranch_vccnz per_A_x12s
per_A_x12r:
  ds_read_b128 v[4:7], v1 offset:32768
  v_mfma_f32_16x16x32_bf16 v[132:135], v[72:75], v[8:11], v[132:135]
  s_add_u32 s28, s21, 53248
  buffer_load_dwordx4 v[64:67], v0, s[8:11], s28 offen offset:0
  v_mfma_f32_16x16x32_bf16 v[164:167], v[76:79], v[8:11], v[164:167]
  v_mfma_f32_16x16x32_bf16 v[196:199], v[80:83], v[8:11], v[196:199]
  v_mfma_f32_16x16x32_bf16 v[228:231], v[84:87], v[8:11], v[228:231]
  v_mfma_f32_16x16x32_bf16 v[104:107], v[68:71], v[12:15], v[104:107]
  ds_read_b128 v[8:11], v1 offset:33792
  v_mfma_f32_16x16x32_bf16 v[136:139], v[72:75], v[12:15], v[136:139]
  v_mfma_f32_16x16x32_bf16 v[168:171], v[76:79], v[12:15], v[168:171]
  v_mfma_f32_16x16x32_bf16 v[200:203], v[80:83], v[12:15], v[200:203]
  v_mfma_f32_16x16x32_bf16 v[232:235], v[84:87], v[12:15], v[232:235]
  v_mfma_f32_16x16x32_bf16 v[108:111], v[68:71], v[16:19], v[108:111]
  ds_read_b128 v[12:15], v1 offset:34816
  v_mfma_f32_16x16x32_bf16 v[140:143], v[72:75], v[16:19], v[140:143]
  v_mfma_f32_16x16x32_bf16 v[172:175], v[76:79], v[16:19], v[172:175]
  v_mfma_f32_16x16x32_bf16 v[204:207], v[80:83], v[16:19], v[204:207]
  v_mfma_f32_16x16x32_bf16 v[236:239], v[84:87], v[16:19], v[236:239]
  v_mfma_f32_16x16x32_bf16 v[112:115], v[68:71], v[20:23], v[112:115]
  ds_read_b128 v[16:19], v1 offset:35840
  v_mfma_f32_16x16x32_bf16 v[144:147], v[72:75], v[20:23], v[144:147]
  v_mfma_f32_16x16x32_bf16 v[176:179], v[76:79], v[20:23], v[176:179]
  v_mfma_f32_16x16x32_bf16 v[208:211], v[80:83], v[20:23], v[208:211]
  v_mfma_f32_16x16x32_bf16 v[240:243], v[84:87], v[20:23], v[240:243]
  v_mfma_f32_16x16x32_bf16 v[116:119], v[68:71], v[24:27], v[116:119]
  ds_read_b128 v[20:23], v1 offset:36864
  v_mfma_f32_16x16x32_bf16 v[148:151], v[72:75], v[24:27], v[148:151]
  s_add_u32 s29, s20, 57344
  buffer_load_dwordx4 v[68:71], v0, s[8:11], s29 offen offset:0
  v_mfma_f32_16x16x32_bf16 v[180:183], v[76:79], v[24:27], v[180:183]
  v_mfma_f32_16x16x32_bf16 v[212:215], v[80:83], v[24:27], v[212:215]
  v_mfma_f32_16x16x32_bf16 v[244:247], v[84:87], v[24:27], v[244:247]
  s_waitcnt vmcnt(6) lgkmcnt(4)
  v_mfma_f32_16x16x32_bf16 v[88:91], v[28:31], v[4:7], v[88:91]
  ds_read_b128 v[24:27], v1 offset:37888
  v_mfma_f32_16x16x32_bf16 v[120:123], v[32:35], v[4:7], v[120:123]
  buffer_load_dwordx4 v[72:75], v0, s[8:11], s29 offen offset:1024
  v_mfma_f32_16x16x32_bf16 v[152:155], v[36:39], v[4:7], v[152:155]
  v_mfma_f32_16x16x32_bf16 v[184:187], v[40:43], v[4:7], v[184:187]
  v_mfma_f32_16x16x32_bf16 v[216:219], v[44:47], v[4:7], v[216:219]
  s_waitcnt lgkmcnt(4)
  v_mfma_f32_16x16x32_bf16 v[92:95], v[28:31], v[8:11], v[92:95]
  ds_read_b128 v[4:7], v1 offset:38912
  v_mfma_f32_16x16x32_bf16 v[124:127], v[32:35], v[8:11], v[124:127]
  buffer_load_dwordx4 v[76:79], v0, s[8:11], s29 offen offset:2048
  v_mfma_f32_16x16x32_bf16 v[156:159], v[36:39], v[8:11], v[156:159]
  v_mfma_f32_16x16x32_bf16 v[188:191], v[40:43], v[8:11], v[188:191]
  v_mfma_f32_16x16x32_bf16 v[220:223], v[44:47], v[8:11], v[220:223]
  s_waitcnt lgkmcnt(4)
  v_mfma_f32_16x16x32_bf16 v[96:99], v[28:31], v[12:15], v[96:99]
  ds_read_b128 v[8:11], v1 offset:39936
  ds_read_b32 v250, v254 offset:1024
  v_mfma_f32_16x16x32_bf16 v[128:131], v[32:35], v[12:15], v[128:131]
  buffer_load_dwordx4 v[80:83], v0, s[8:11], s29 offen offset:3072
  v_mfma_f32_16x16x32_bf16 v[160:163], v[36:39], v[12:15], v[160:163]
  v_mfma_f32_16x16x32_bf16 v[192:195], v[40:43], v[12:15], v[192:195]
  v_mfma_f32_16x16x32_bf16 v[224:227], v[44:47], v[12:15], v[224:227]
  s_waitcnt lgkmcnt(5)
  v_mfma_f32_16x16x32_bf16 v[100:103], v[28:31], v[16:19], v[100:103]
  s_waitcnt lgkmcnt(0)
  v_cmp_gt_u32 vcc, 14, v250
  s_cbranch_vccnz per_A_x13s
per_A_x13r:
  ds_read_b128 v[12:15], v1 offset:40960
  v_mfma_f32_16x16x32_bf16 v[132:135], v[32:35], v[16:19], v[132:135]
  s_add_u32 s28, s21, 57344
  buffer_load_dwordx4 v[84:87], v0, s[8:11], s28 offen offset:0
  v_mfma_f32_16x16x32_bf16 v[164:167], v[36:39], v[16:19], v[164:167]
  v_mfma_f32_16x16x32_bf16 v[196:199], v[40:43], v[16:19], v[196:199]
  v_mfma_f32_16x16x32_bf16 v[228:231], v[44:47], v[16:19], v[228:231]
  v_mfma_f32_16x16x32_bf16 v[104:107], v[28:31], v[20:23], v[104:107]
  ds_read_b128 v[16:19], v1 offset:41984
  v_mfma_f32_16x16x32_bf16 v[136:139], v[32:35], v[20:23], v[136:139]
  v_mfma_f32_16x16x32_bf16 v[168:171], v[36:39], v[20:23], v[168:171]
  v_mfma_f32_16x16x32_bf16 v[200:203], v[40:43], v[20:23], v[200:203]
  v_mfma_f32_16x16x32_bf16 v[232:235], v[44:47], v[20:23], v[232:235]
  v_mfma_f32_16x16x32_bf16 v[108:111], v[28:31], v[24:27], v[108:111]
  ds_read_b128 v[20:23], v1 offset:43008
  v_mfma_f32_16x16x32_bf16 v[140:143], v[32:35], v[24:27], v[140:143]
  v_mfma_f32_16x16x32_bf16 v[172:175], v[36:39], v[24:27], v[172:175]
  v_mfma_f32_16x16x32_bf16 v[204:207], v[40:43], v[24:27], v[204:207]
  v_mfma_f32_16x16x32_bf16 v[236:239], v[44:47], v[24:27], v[236:239]
  v_mfma_f32_16x16x32_bf16 v[112:115], v[28:31], v[4:7], v[112:115]
  ds_read_b128 v[24:27], v1 offset:44032
  v_mfma_f32_16x16x32_bf16 v[144:147], v[32:35], v[4:7], v[144:147]
  v_mfma_f32_16x16x32_bf16 v[176:179], v[36:39], v[4:7], v[176:179]
  v_mfma_f32_16x16x32_bf16 v[208:211], v[40:43], v[4:7], v[208:211]
  v_mfma_f32_16x16x32_bf16 v[240:243], v[44:47], v[4:7], v[240:243]
  v_mfma_f32_16x16x32_bf16 v[116:119], v[28:31], v[8:11], v[116:119]
  ds_read_b128 v[4:7], v1 offset:45056
  v_mfma_f32_16x16x32_bf16 v[148:151], v[32:35], v[8:11], v[148:151]
  s_add_u32 s29, s20, 61440
  buffer_load_dwordx4 v[28:31], v0, s[8:11], s29 offen offset:0
  v_mfma_f32_16x16x32_bf16 v[180:183], v[36:39], v[8:11], v[180:183]
  v_mfma_f32_16x16x32_bf16 v[212:215], v[40:43], v[8:11], v[212:215]
  v_mfma_f32_16x16x32_bf16 v[244:247], v[44:47], v[8:11], v[244:247]
  s_waitcnt vmcnt(6) lgkmcnt(4)
  v_mfma_f32_16x16x32_bf16 v[88:91], v[48:51], v[12:15], v[88:91]
  ds_read_b128 v[8:11], v1 offset:46080
  v_mfma_f32_16x16x32_bf16 v[120:123], v[52:55], v[12:15], v[120:123]
  buffer_load_dwordx4 v[32:35], v0, s[8:11], s29 offen offset:1024
  v_mfma_f32_16x16x32_bf16 v[152:155], v[56:59], v[12:15], v[152:155]
  v_mfma_f32_16x16x32_bf16 v[184:187], v[60:63], v[12:15], v[184:187]
  v_mfma_f32_16x16x32_bf16 v[216:219], v[64:67], v[12:15], v[216:219]
  s_waitcnt lgkmcnt(4)
  v_mfma_f32_16x16x32_bf16 v[92:95], v[48:51], v[16:19], v[92:95]
  ds_read_b128 v[12:15], v1 offset:47104
  v_mfma_f32_16x16x32_bf16 v[124:127], v[52:55], v[16:19], v[124:127]
  buffer_load_dwordx4 v[36:39], v0, s[8:11], s29 offen offset:2048
  v_mfma_f32_16x16x32_bf16 v[156:159], v[56:59], v[16:19], v[156:159]
  v_mfma_f32_16x16x32_bf16 v[188:191], v[60:63], v[16:19], v[188:191]
  v_mfma_f32_16x16x32_bf16 v[220:223], v[64:67], v[16:19], v[220:223]
  s_waitcnt lgkmcnt(4)
  v_mfma_f32_16x16x32_bf16 v[96:99], v[48:51], v[20:23], v[96:99]
  ds_read_b128 v[16:19], v1 offset:48128
  ds_read_b32 v250, v254 offset:1024
  v_mfma_f32_16x16x32_bf16 v[128:131], v[52:55], v[20:23], v[128:131]
  buffer_load_dwordx4 v[40:43], v0, s[8:11], s29 offen offset:3072
  v_mfma_f32_16x16x32_bf16 v[160:163], v[56:59], v[20:23], v[160:163]
  v_mfma_f32_16x16x32_bf16 v[192:195], v[60:63], v[20:23], v[192:195]
  v_mfma_f32_16x16x32_bf16 v[224:227], v[64:67], v[20:23], v[224:227]
  s_waitcnt lgkmcnt(5)
  v_mfma_f32_16x16x32_bf16 v[100:103], v[48:51], v[24:27], v[100:103]
  s_waitcnt lgkmcnt(0)
  v_cmp_gt_u32 vcc, 15, v250
  s_cbranch_vccnz per_A_x14s
per_A_x14r:
  ds_read_b128 v[20:23], v1 offset:49152
  v_mfma_f32_16x16x32_bf16 v[132:135], v[52:55], v[24:27], v[132:135]
  s_add_u32 s28, s21, 61440
  buffer_load_dwordx4 v[44:47], v0, s[8:11], s28 offen offset:0
  v_mfma_f32_16x16x32_bf16 v[164:167], v[56:59], v[24:27], v[164:167]
  v_mfma_f32_16x16x32_bf16 v[196:199], v[60:63], v[24:27], v[196:199]
  v_mfma_f32_16x16x32_bf16 v[228:231], v[64:67], v[24:27], v[228:231]
  v_mfma_f32_16x16x32_bf16 v[104:107], v[48:51], v[4:7], v[104:107]
  ds_read_b128 v[24:27], v1 offset:50176
  v_mfma_f32_16x16x32_bf16 v[136:139], v[52:55], v[4:7], v[136:139]
  v_mfma_f32_16x16x32_bf16 v[168:171], v[56:59], v[4:7], v[168:171]
  v_mfma_f32_16x16x32_bf16 v[200:203], v[60:63], v[4:7], v[200:203]
  v_mfma_f32_16x16x32_bf16 v[232:235], v[64:67], v[4:7], v[232:235]
  v_mfma_f32_16x16x32_bf16 v[108:111], v[48:51], v[8:11], v[108:111]
  ds_read_b128 v[4:7], v1 offset:51200
  v_mfma_f32_16x16x32_bf16 v[140:143], v[52:55], v[8:11], v[140:143]
  v_mfma_f32_16x16x32_bf16 v[172:175], v[56:59], v[8:11], v[172:175]
  v_mfma_f32_16x16x32_bf16 v[204:207], v[60:63], v[8:11], v[204:207]
  v_mfma_f32_16x16x32_bf16 v[236:239], v[64:67], v[8:11], v[236:239]
  v_mfma_f32_16x16x32_bf16 v[112:115], v[48:51], v[12:15], v[112:115]
  ds_read_b128 v[8:11], v1 offset:52224
  v_mfma_f32_16x16x32_bf16 v[144:147], v[52:55], v[12:15], v[144:147]
  v_mfma_f32_16x16x32_bf16 v[176:179], v[56:59], v[12:15], v[176:179]
  v_mfma_f32_16x16x32_bf16 v[208:211], v[60:63], v[12:15], v[208:211]
  v_mfma_f32_16x16x32_bf16 v[240:243], v[64:67], v[12:15], v[240:243]
  v_mfma_f32_16x16x32_bf16 v[116:119], v[48:51], v[16:19], v[116:119]
  ds_read_b128 v[12:15], v1 offset:53248
  v_mfma_f32_16x16x32_bf16 v[148:151], v[52:55], v[16:19], v[148:151]
  s_add_u32 s29, s20, 65536
  buffer_load_dwordx4 v[48:51], v0, s[8:11], s29 offen offset:0
  v_mfma_f32_16x16x32_bf16 v[180:183], v[56:59], v[16:19], v[180:183]
  v_mfma_f32_16x16x32_bf16 v[212:215], v[60:63], v[16:19], v[212:215]
  v_mfma_f32_16x16x32_bf16 v[244:247], v[64:67], v[16:19], v[244:247]
  s_waitcnt vmcnt(6) lgkmcnt(4)
  v_mfma_f32_16x16x32_bf16 v[88:91], v[68:71], v[20:23], v[88:91]
  ds_read_b128 v[16:19], v1 offset:54272
  v_mfma_f32_16x16x32_bf16 v[120:123], v[72:75], v[20:23], v[120:123]
  buffer_load_dwordx4 v[52:55], v0, s[8:11], s29 offen offset:1024
  v_mfma_f32_16x16x32_bf16 v[152:155], v[76:79], v[20:23], v[152:155]
  v_mfma_f32_16x16x32_bf16 v[184:187], v[80:83], v[20:23], v[184:187]
  v_mfma_f32_16x16x32_bf16 v[216:219], v[84:87], v[20:23], v[216:219]
  s_waitcnt lgkmcnt(4)
  v_mfma_f32_16x16x32_bf16 v[92:95], v[68:71], v[24:27], v[92:95]
  ds_read_b128 v[20:23], v1 offset:55296
  v_mfma_f32_16x16x32_bf16 v[124:127], v[72:75], v[24:27], v[124:127]
  buffer_load_dwordx4 v[56:59], v0, s[8:11], s29 offen offset:2048
  v_mfma_f32_16x16x32_bf16 v[156:159], v[76:79], v[24:27], v[156:159]
  v_mfma_f32_16x16x32_bf16 v[188:191], v[80:83], v[24:27], v[188:191]
  v_mfma_f32_16x16x32_bf16 v[220:223], v[84:87], v[24:27], v[220:223]
  s_waitcnt lgkmcnt(4)
  v_mfma_f32_16x16x32_bf16 v[96:99], v[68:71], v[4:7], v[96:99]
  ds_read_b128 v[24:27], v1 offset:56320
  ds_read_b32 v250, v254 offset:1024
  v_mfma_f32_16x16x32_bf16 v[128:131], v[72:75], v[4:7], v[128:131]
  buffer_load_dwordx4 v[60:63], v0, s[8:11], s29 offen offset:3072
  v_mfma_f32_16x16x32_bf16 v[160:163], v[76:79], v[4:7], v[160:163]
  v_mfma_f32_16x16x32_bf16 v[192:195], v[80:83], v[4:7], v[192:195]
  v_mfma_f32_16x16x32_bf16 v[224:227], v[84:87], v[4:7], v[224:227]
  s_waitcnt lgkmcnt(5)
  v_mfma_f32_16x16x32_bf16 v[100:103], v[68:71], v[8:11], v[100:103]
  s_waitcnt lgkmcnt(0)
  v_cmp_gt_u32 vcc, 16, v250
  s_cbranch_vccnz per_A_x15s
per_A_x15r:
  ds_read_b128 v[4:7], v1 offset:57344
  v_mfma_f32_16x16x32_bf16 v[132:135], v[72:75], v[8:11], v[132:135]
  s_add_u32 s28, s21, 65536
  buffer_load_dwordx4 v[64:67], v0, s[8:11], s28 offen offset:0
  v_mfma_f32_16x16x32_bf16 v[164:167], v[76:79], v[8:11], v[164:167]
  v_mfma_f32_16x16x32_bf16 v[196:199], v[80:83], v[8:11], v[196:199]
  v_mfma_f32_16x16x32_bf16 v[228:231], v[84:87], v[8:11], v[228:231]
  v_mfma_f32_16x16x32_bf16 v[104:107], v[68:71], v[12:15], v[104:107]
  ds_read_b128 v[8:11], v1 offset:58368
  v_mfma_f32_16x16x32_bf16 v[136:139], v[72:75], v[12:15], v[136:139]
  v_mfma_f32_16x16x32_bf16 v[168:171], v[76:79], v[12:15], v[168:171]
  v_mfma_f32_16x16x32_bf16 v[200:203], v[80:83], v[12:15], v[200:203]
  v_mfma_f32_16x16x32_bf16 v[232:235], v[84:87], v[12:15], v[232:235]
  v_mfma_f32_16x16x32_bf16 v[108:111], v[68:71], v[16:19], v[108:111]
  ds_read_b128 v[12:15], v1 offset:59392
  v_mfma_f32_16x16x32_bf16 v[140:143], v[72:75], v[16:19], v[140:143]
  v_mfma_f32_16x16x32_bf16 v[172:175], v[76:79], v[16:19], v[172:175]
  v_mfma_f32_16x16x32_bf16 v[204:207], v[80:83], v[16:19], v[204:207]
  v_mfma_f32_16x16x32_bf16 v[236:239], v[84:87], v[16:19], v[236:239]
  v_mfma_f32_16x16x32_bf16 v[112:115], v[68:71], v[20:23], v[112:115]
  ds_read_b128 v[16:19], v1 offset:60416
  v_mfma_f32_16x16x32_bf16 v[144:147], v[72:75], v[20:23], v[144:147]
  v_mfma_f32_16x16x32_bf16 v[176:179], v[76:79], v[20:23], v[176:179]
  v_mfma_f32_16x16x32_bf16 v[208:211], v[80:83], v[20:23], v[208:211]
  v_mfma_f32_16x16x32_bf16 v[240:243], v[84:87], v[20:23], v[240:243]
  v_mfma_f32_16x16x32_bf16 v[116:119], v[68:71], v[24:27], v[116:119]
  ds_read_b128 v[20:23], v1 offset:61440
  v_mfma_f32_16x16x32_bf16 v[148:151], v[72:75], v[24:27], v[148:151]
  s_add_u32 s29, s20, 69632
  buffer_load_dwordx4 v[68:71], v0, s[8:11], s29 offen offset:0
  v_mfma_f32_16x16x32_bf16 v[180:183], v[76:79], v[24:27], v[180:183]
  v_mfma_f32_16x16x32_bf16 v[212:215], v[80:83], v[24:27], v[212:215]
  v_mfma_f32_16x16x32_bf16 v[244:247], v[84:87], v[24:27], v[244:247]
  s_waitcnt vmcnt(6) lgkmcnt(4)
  v_mfma_f32_16x16x32_bf16 v[88:91], v[28:31], v[4:7], v[88:91]
  ds_read_b128 v[24:27], v1 offset:62464
  v_mfma_f32_16x16x32_bf16 v[120:123], v[32:35], v[4:7], v[120:123]
  buffer_load_dwordx4 v[72:75], v0, s[8:11], s29 offen offset:1024
  v_mfma_f32_16x16x32_bf16 v[152:155], v[36:39], v[4:7], v[152:155]
  v_mfma_f32_16x16x32_bf16 v[184:187], v[40:43], v[4:7], v[184:187]
  v_mfma_f32_16x16x32_bf16 v[216:219], v[44:47], v[4:7], v[216:219]
  s_waitcnt lgkmcnt(4)
  v_mfma_f32_16x16x32_bf16 v[92:95], v[28:31], v[8:11], v[92:95]
  ds_read_b128 v[4:7], v1 offset:63488
  v_mfma_f32_16x16x32_bf16 v[124:127], v[32:35], v[8:11], v[124:127]
  buffer_load_dwordx4 v[76:79], v0, s[8:11], s29 offen offset:2048
  v_mfma_f32_16x16x32_bf16 v[156:159], v[36:39], v[8:11], v[156:159]
  v_mfma_f32_16x16x32_bf16 v[188:191], v[40:43], v[8:11], v[188:191]
  v_mfma_f32_16x16x32_bf16 v[220:223], v[44:47], v[8:11], v[220:223]
  s_waitcnt lgkmcnt(4)
  v_mfma_f32_16x16x32_bf16 v[96:99], v[28:31], v[12:15], v[96:99]
  ds_read_b128 v[8:11], v1 offset:64512
  ds_read_b32 v250, v254 offset:1024
  v_mfma_f32_16x16x32_bf16 v[128:131], v[32:35], v[12:15], v[128:131]
  buffer_load_dwordx4 v[80:83], v0, s[8:11], s29 offen offset:3072
  v_mfma_f32_16x16x32_bf16 v[160:163], v[36:39], v[12:15], v[160:163]
  v_mfma_f32_16x16x32_bf16 v[192:195], v[40:43], v[12:15], v[192:195]
  v_mfma_f32_16x16x32_bf16 v[224:227], v[44:47], v[12:15], v[224:227]
  s_waitcnt lgkmcnt(5)
  v_mfma_f32_16x16x32_bf16 v[100:103], v[28:31], v[16:19], v[100:103]
  s_waitcnt lgkmcnt(0)
  v_cmp_gt_u32 vcc, 17, v250
  s_cbranch_vccnz per_A_x16s
per_A_x16r:
  ds_read_b128 v[12:15], v2 offset:0
  v_mfma_f32_16x16x32_bf16 v[132:135], v[32:35], v[16:19], v[132:135]
  s_add_u32 s28, s21, 69632
  buffer_load_dwordx4 v[84:87], v0, s[8:11], s28 offen offset:0
  v_mfma_f32_16x16x32_bf16 v[164:167], v[36:39], v[16:19], v[164:167]
  v_mfma_f32_16x16x32_bf16 v[196:199], v[40:43], v[16:19], v[196:199]
  v_mfma_f32_16x16x32_bf16 v[228:231], v[44:47], v[16:19], v[228:231]
  v_mfma_f32_16x16x32_bf16 v[104:107], v[28:31], v[20:23], v[104:107]
  ds_read_b128 v[16:19], v2 offset:1024
  v_mfma_f32_16x16x32_bf16 v[136:139], v[32:35], v[20:23], v[136:139]
  v_mfma_f32_16x16x32_bf16 v[168:171], v[36:39], v[20:23], v[168:171]
  v_mfma_f32_16x16x32_bf16 v[200:203], v[40:43], v[20:23], v[200:203]
  v_mfma_f32_16x16x32_bf16 v[232:235], v[44:47], v[20:23], v[232:235]
  v_mfma_f32_16x16x32_bf16 v[108:111], v[28:31], v[24:27], v[108:111]
  ds_read_b128 v[20:23], v2 offset:2048
  v_mfma_f32_16x16x32_bf16 v[140:143], v[32:35], v[24:27], v[140:143]
  v_mfma_f32_16x16x32_bf16 v[172:175], v[36:39], v[24:27], v[172:175]
  v_mfma_f32_16x16x32_bf16 v[204:207], v[40:43], v[24:27], v[204:207]
  v_mfma_f32_16x16x32_bf16 v[236:239], v[44:47], v[24:27], v[236:239]
  v_mfma_f32_16x16x32_bf16 v[112:115], v[28:31], v[4:7], v[112:115]
  ds_read_b128 v[24:27], v2 offset:3072
  v_mfma_f32_16x16x32_bf16 v[144:147], v[32:35], v[4:7], v[144:147]
  v_mfma_f32_16x16x32_bf16 v[176:179], v[36:39], v[4:7], v[176:179]
  v_mfma_f32_16x16x32_bf16 v[208:211], v[40:43], v[4:7], v[208:211]
  v_mfma_f32_16x16x32_bf16 v[240:243], v[44:47], v[4:7], v[240:243]
  v_mfma_f32_16x16x32_bf16 v[116:119], v[28:31], v[8:11], v[116:119]
  ds_read_b128 v[4:7], v2 offset:4096
  v_mfma_f32_16x16x32_bf16 v[148:151], v[32:35], v[8:11], v[148:151]
  s_add_u32 s29, s22, 0
  buffer_load_dwordx4 v[28:31], v0, s[8:11], s29 offen offset:0
  v_mfma_f32_16x16x32_bf16 v[180:183], v[36:39], v[8:11], v[180:183]
  v_mfma_f32_16x16x32_bf16 v[212:215], v[40:43], v[8:11], v[212:215]
  v_mfma_f32_16x16x32_bf16 v[244:247], v[44:47], v[8:11], v[244:247]
  s_waitcnt vmcnt(6) lgkmcnt(4)
  v_mfma_f32_16x16x32_bf16 v[88:91], v[48:51], v[12:15], v[88:91]
  ds_read_b128 v[8:11], v2 offset:5120
  v_mfma_f32_16x16x32_bf16 v[120:123], v[52:55], v[12:15], v[120:123]
  buffer_load_dwordx4 v[32:35], v0, s[8:11], s29 offen offset:1024
  v_mfma_f32_16x16x32_bf16 v[152:155], v[56:59], v[12:15], v[152:155]
  v_mfma_f32_16x16x32_bf16 v[184:187], v[60:63], v[12:15], v[184:187]
  v_mfma_f32_16x16x32_bf16 v[216:219], v[64:67], v[12:15], v[216:219]
  s_waitcnt lgkmcnt(4)
  v_mfma_f32_16x16x32_bf16 v[92:95], v[48:51], v[16:19], v[92:95]
  ds_read_b128 v[12:15], v2 offset:6144
  v_mfma_f32_16x16x32_bf16 v[124:127], v[52:55], v[16:19], v[124:127]
  s_add_u32 s28, s23, 0
  buffer_load_dwordx4 v[36:39], v0, s[8:11], s28 offen offset:0
  v_mfma_f32_16x16x32_bf16 v[156:159], v[56:59], v[16:19], v[156:159]
  v_mfma_f32_16x16x32_bf16 v[188:191], v[60:63], v[16:19], v[188:191]
  v_mfma_f32_16x16x32_bf16 v[220:223], v[64:67], v[16:19], v[220:223]
  s_waitcnt lgkmcnt(4)
  v_mfma_f32_16x16x32_bf16 v[96:99], v[48:51], v[20:23], v[96:99]
  ds_read_b128 v[16:19], v2 offset:7168
  ds_read_b32 v250, v254 offset:1024
  v_mfma_f32_16x16x32_bf16 v[128:131], v[52:55], v[20:23], v[128:131]
  s_add_u32 s29, s22, 36864
  buffer_load_dwordx4 v[40:43], v0, s[8:11], s29 offen offset:0
  v_mfma_f32_16x16x32_bf16 v[160:163], v[56:59], v[20:23], v[160:163]
  v_mfma_f32_16x16x32_bf16 v[192:195], v[60:63], v[20:23], v[192:195]
  v_mfma_f32_16x16x32_bf16 v[224:227], v[64:67], v[20:23], v[224:227]
  s_waitcnt lgkmcnt(5)
  v_mfma_f32_16x16x32_bf16 v[100:103], v[48:51], v[24:27], v[100:103]
  s_waitcnt lgkmcnt(0)
  v_cmp_gt_u32 vcc, 18, v250
  s_cbranch_vccnz per_A_x17s
per_A_x17r:
  ds_read_b128 v[20:23], v2 offset:8192
  v_mfma_f32_16x16x32_bf16 v[132:135], v[52:55], v[24:27], v[132:135]
  buffer_load_dwordx4 v[44:47], v0, s[8:11], s29 offen offset:1024
  v_mfma_f32_16x16x32_bf16 v[164:167], v[56:59], v[24:27], v[164:167]
  v_mfma_f32_16x16x32_bf16 v[196:199], v[60:63], v[24:27], v[196:199]
  v_mfma_f32_16x16x32_bf16 v[228:231], v[64:67], v[24:27], v[228:231]
  v_mfma_f32_16x16x32_bf16 v[104:107], v[48:51], v[4:7], v[104:107]
  ds_read_b128 v[24:27], v2 offset:9216
  v_mfma_f32_16x16x32_bf16 v[136:139], v[52:55], v[4:7], v[136:139]
  v_mfma_f32_16x16x32_bf16 v[168:171], v[56:59], v[4:7], v[168:171]
  v_mfma_f32_16x16x32_bf16 v[200:203], v[60:63], v[4:7], v[200:203]
  v_mfma_f32_16x16x32_bf16 v[232:235], v[64:67], v[4:7], v[232:235]
  v_mfma_f32_16x16x32_bf16 v[108:111], v[48:51], v[8:11], v[108:111]
  ds_read_b128 v[4:7], v2 offset:10240
  v_mfma_f32_16x16x32_bf16 v[140:143], v[52:55], v[8:11], v[140:143]
  v_mfma_f32_16x16x32_bf16 v[172:175], v[56:59], v[8:11], v[172:175]
  v_mfma_f32_16x16x32_bf16 v[204:207], v[60:63], v[8:11], v[204:207]
  v_mfma_f32_16x16x32_bf16 v[236:239], v[64:67], v[8:11], v[236:239]
  v_mfma_f32_16x16x32_bf16 v[112:115], v[48:51], v[12:15], v[112:115]
  ds_read_b128 v[8:11], v2 offset:11264
  v_mfma_f32_16x16x32_bf16 v[144:147], v[52:55], v[12:15], v[144:147]
  v_mfma_f32_16x16x32_bf16 v[176:179], v[56:59], v[12:15], v[176:179]
  v_mfma_f32_16x16x32_bf16 v[208:211], v[60:63], v[12:15], v[208:211]
  v_mfma_f32_16x16x32_bf16 v[240:243], v[64:67], v[12:15], v[240:243]
  v_mfma_f32_16x16x32_bf16 v[116:119], v[48:51], v[16:19], v[116:119]
  ds_read_b128 v[12:15], v2 offset:12288
  v_mfma_f32_16x16x32_bf16 v[148:151], v[52:55], v[16:19], v[148:151]
  s_add_u32 s28, s23, 36864
  buffer_load_dwordx4 v[48:51], v0, s[8:11], s28 offen offset:0
  v_mfma_f32_16x16x32_bf16 v[180:183], v[56:59], v[16:19], v[180:183]
  v_mfma_f32_16x16x32_bf16 v[212:215], v[60:63], v[16:19], v[212:215]
  v_mfma_f32_16x16x32_bf16 v[244:247], v[64:67], v[16:19], v[244:247]
  s_waitcnt vmcnt(6) lgkmcnt(4)
  v_mfma_f32_16x16x32_bf16 v[88:91], v[68:71], v[20:23], v[88:91]
  ds_read_b128 v[16:19], v2 offset:13312
  v_mfma_f32_16x16x32_bf16 v[120:123], v[72:75], v[20:23], v[120:123]
  s_add_u32 s29, s22, 73728
  buffer_load_dwordx4 v[52:55], v0, s[8:11], s29 offen offset:0
  v_mfma_f32_16x16x32_bf16 v[152:155], v[76:79], v[20:23], v[152:155]
  v_mfma_f32_16x16x32_bf16 v[184:187], v[80:83], v[20:23], v[184:187]
  v_mfma_f32_16x16x32_bf16 v[216:219], v[84:87], v[20:23], v[216:219]
  s_waitcnt lgkmcnt(4)
  v_mfma_f32_16x16x32_bf16 v[92:95], v[68:71], v[24:27], v[92:95]
  ds_read_b128 v[20:23], v2 offset:14336
  v_mfma_f32_16x16x32_bf16 v[124:127], v[72:75], v[24:27], v[124:127]
  buffer_load_dwordx4 v[56:59], v0, s[8:11], s29 offen offset:1024
  v_mfma_f32_16x16x32_bf16 v[156:159], v[76:79], v[24:27], v[156:159]
  v_mfma_f32_16x16x32_bf16 v[188:191], v[80:83], v[24:27], v[188:191]
  v_mfma_f32_16x16x32_bf16 v[220:223], v[84:87], v[24:27], v[220:223]
  s_waitcnt lgkmcnt(4)
  v_mfma_f32_16x16x32_bf16 v[96:99], v[68:71], v[4:7], v[96:99]
  ds_read_b128 v[24:27], v2 offset:15360
  v_mfma_f32_16x16x32_bf16 v[128:131], v[72:75], v[4:7], v[128:131]
  s_add_u32 s28, s23, 73728
  buffer_load_dwordx4 v[60:63], v0, s[8:11], s28 offen offset:0
  v_mfma_f32_16x16x32_bf16 v[160:163], v[76:79], v[4:7], v[160:163]
  v_mfma_f32_16x16x32_bf16 v[192:195], v[80:83], v[4:7], v[192:195]
  v_mfma_f32_16x16x32_bf16 v[224:227], v[84:87], v[4:7], v[224:227]
  s_waitcnt lgkmcnt(4)
  v_mfma_f32_16x16x32_bf16 v[100:103], v[68:71], v[8:11], v[100:103]
  v_mfma_f32_16x16x32_bf16 v[132:135], v[72:75], v[8:11], v[132:135]
  s_add_u32 s29, s22, 110592
  buffer_load_dwordx4 v[64:67], v0, s[8:11], s29 offen offset:0
  v_mfma_f32_16x16x32_bf16 v[164:167], v[76:79], v[8:11], v[164:167]
  v_mfma_f32_16x16x32_bf16 v[196:199], v[80:83], v[8:11], v[196:199]
  v_mfma_f32_16x16x32_bf16 v[228:231], v[84:87], v[8:11], v[228:231]
  s_waitcnt lgkmcnt(3)
  v_mfma_f32_16x16x32_bf16 v[104:107], v[68:71], v[12:15], v[104:107]
  v_mfma_f32_16x16x32_bf16 v[136:139], v[72:75], v[12:15], v[136:139]
  v_mfma_f32_16x16x32_bf16 v[168:171], v[76:79], v[12:15], v[168:171]
  v_mfma_f32_16x16x32_bf16 v[200:203], v[80:83], v[12:15], v[200:203]
  v_mfma_f32_16x16x32_bf16 v[232:235], v[84:87], v[12:15], v[232:235]
  s_waitcnt lgkmcnt(2)
  v_mfma_f32_16x16x32_bf16 v[108:111], v[68:71], v[16:19], v[108:111]
  v_mfma_f32_16x16x32_bf16 v[140:143], v[72:75], v[16:19], v[140:143]
  v_mfma_f32_16x16x32_bf16 v[172:175], v[76:79], v[16:19], v[172:175]
  v_mfma_f32_16x16x32_bf16 v[204:207], v[80:83], v[16:19], v[204:207]
  v_mfma_f32_16x16x32_bf16 v[236:239], v[84:87], v[16:19], v[236:239]
  s_waitcnt lgkmcnt(1)
  v_mfma_f32_16x16x32_bf16 v[112:115], v[68:71], v[20:23], v[112:115]
  v_mfma_f32_16x16x32_bf16 v[144:147], v[72:75], v[20:23], v[144:147]
  v_mfma_f32_16x16x32_bf16 v[176:179], v[76:79], v[20:23], v[176:179]
  v_mfma_f32_16x16x32_bf16 v[208:211], v[80:83], v[20:23], v[208:211]
  v_mfma_f32_16x16x32_bf16 v[240:243], v[84:87], v[20:23], v[240:243]
  s_waitcnt lgkmcnt(0)
  v_mfma_f32_16x16x32_bf16 v[116:119], v[68:71], v[24:27], v[116:119]
  v_mfma_f32_16x16x32_bf16 v[148:151], v[72:75], v[24:27], v[148:151]
  buffer_load_dwordx4 v[68:71], v0, s[8:11], s29 offen offset:1024
  v_mfma_f32_16x16x32_bf16 v[180:183], v[76:79], v[24:27], v[180:183]
  v_mfma_f32_16x16x32_bf16 v[212:215], v[80:83], v[24:27], v[212:215]
  v_mfma_f32_16x16x32_bf16 v[244:247], v[84:87], v[24:27], v[244:247]
  v_mov_b32 v248, 2
  ds_write_b32 v251, v248
  s_setprio 0
  s_add_u32 s28, s23, 110592
  buffer_load_dwordx4 v[72:75], v0, s[8:11], s28 offen offset:0
  v_fmaak_f32 v4, v88, v88, 0x409d30fc
  v_fmaak_f32 v5, v89, v89, 0x409d30fc
  v_fmaak_f32 v6, v120, v120, 0x409d30fc
  v_fmaak_f32 v7, v121, v121, 0x409d30fc
  v_mul_f32 v90, v88, v90
  v_mul_f32 v91, v89, v91
  v_mul_f32 v122, v120, v122
  v_mul_f32 v123, v121, v123
  v_mul_f32 v88, v4, v88
  v_mul_f32 v89, v5, v89
  v_mul_f32 v120, v6, v120
  v_mul_f32 v121, v7, v121
  v_exp_f32_e64 v88, -v88
  v_exp_f32_e64 v89, -v89
  v_exp_f32_e64 v120, -v120
  v_exp_f32_e64 v121, -v121
  v_add_f32 v88, 1.0, v88
  v_add_f32 v89, 1.0, v89
  v_add_f32 v120, 1.0, v120
  v_add_f32 v121, 1.0, v121
  v_rcp_f32 v88, v88
  v_rcp_f32 v89, v89
  v_rcp_f32 v120, v120
  v_rcp_f32 v121, v121
  v_mul_f32 v90, v90, v88
  v_mul_f32 v91, v91, v89
  v_mul_f32 v122, v122, v120
  v_mul_f32 v123, v123, v121
  v_cvt_pk_bf16_f32 v88, v90, v91
  v_cvt_pk_bf16_f32 v89, v122, v123
  v_fmaak_f32 v4, v152, v152, 0x409d30fc
  v_fmaak_f32 v5, v153, v153, 0x409d30fc
  v_fmaak_f32 v6, v184, v184, 0x409d30fc
  v_fmaak_f32 v7, v185, v185, 0x409d30fc
  v_mul_f32 v154, v152, v154
  v_mul_f32 v155, v153, v155
  v_mul_f32 v186, v184, v186
  v_mul_f32 v187, v185, v187
  v_mul_f32 v152, v4, v152
  v_mul_f32 v153, v5, v153
  v_mul_f32 v184, v6, v184
  v_mul_f32 v185, v7, v185
  v_exp_f32_e64 v152, -v152
  v_exp_f32_e64 v153, -v153
  v_exp_f32_e64 v184, -v184
  v_exp_f32_e64 v185, -v185
  v_add_f32 v152, 1.0, v152
  v_add_f32 v153, 1.0, v153
  v_add_f32 v184, 1.0, v184
  v_add_f32 v185, 1.0, v185
  v_rcp_f32 v152, v152
  v_rcp_f32 v153, v153
  v_rcp_f32 v184, v184
  v_rcp_f32 v185, v185
  v_mul_f32 v154, v154, v152
  v_mul_f32 v155, v155, v153
  v_mul_f32 v186, v186, v184
  v_mul_f32 v187, v187, v185
  v_cvt_pk_bf16_f32 v90, v154, v155
  v_cvt_pk_bf16_f32 v91, v186, v187
  v_fmaak_f32 v4, v216, v216, 0x409d30fc
  v_fmaak_f32 v5, v217, v217, 0x409d30fc
  v_mul_f32 v218, v216, v218
  v_mul_f32 v219, v217, v219
  v_mul_f32 v216, v4, v216
  v_mul_f32 v217, v5, v217
  v_exp_f32_e64 v216, -v216
  v_exp_f32_e64 v217, -v217
  v_add_f32 v216, 1.0, v216
  v_add_f32 v217, 1.0, v217
  v_rcp_f32 v216, v216
  v_rcp_f32 v217, v217
  v_mul_f32 v218, v218, v216
  v_mul_f32 v219, v219, v217
  v_cvt_pk_bf16_f32 v216, v218, v219
  s_add_u32 s30, s34, 0
  buffer_store_dwordx4 v[88:91], v0, s[8:11], s30 offen offset:0 sc1
  v_fmaak_f32 v4, v92, v92, 0x409d30fc
  v_fmaak_f32 v5, v93, v93, 0x409d30fc
  v_fmaak_f32 v6, v124, v124, 0x409d30fc
  v_fmaak_f32 v7, v125, v125, 0x409d30fc
  v_mul_f32 v94, v92, v94
  v_mul_f32 v95, v93, v95
  v_mul_f32 v126, v124, v126
  v_mul_f32 v127, v125, v127
  v_mul_f32 v92, v4, v92
  v_mul_f32 v93, v5, v93
  v_mul_f32 v124, v6, v124
  v_mul_f32 v125, v7, v125
  v_exp_f32_e64 v92, -v92
  v_exp_f32_e64 v93, -v93
  v_exp_f32_e64 v124, -v124
  v_exp_f32_e64 v125, -v125
  v_add_f32 v92, 1.0, v92
  v_add_f32 v93, 1.0, v93
  v_add_f32 v124, 1.0, v124
  v_add_f32 v125, 1.0, v125
  v_rcp_f32 v92, v92
  v_rcp_f32 v93, v93
  v_rcp_f32 v124, v124
  v_rcp_f32 v125, v125
  v_mul_f32 v94, v94, v92
  v_mul_f32 v95, v95, v93
  v_mul_f32 v126, v126, v124
  v_mul_f32 v127, v127, v125
  v_cvt_pk_bf16_f32 v92, v94, v95
  v_cvt_pk_bf16_f32 v93, v126, v127
  v_fmaak_f32 v4, v156, v156, 0x409d30fc
  v_fmaak_f32 v5, v157, v157, 0x409d30fc
  v_fmaak_f32 v6, v188, v188, 0x409d30fc
  v_fmaak_f32 v7, v189, v189, 0x409d30fc
  v_mul_f32 v158, v156, v158
  v_mul_f32 v159, v157, v159
  v_mul_f32 v190, v188, v190
  v_mul_f32 v191, v189, v191
  v_mul_f32 v156, v4, v156
  v_mul_f32 v157, v5, v157
  v_mul_f32 v188, v6, v188
  v_mul_f32 v189, v7, v189
  v_exp_f32_e64 v156, -v156
  v_exp_f32_e64 v157, -v157
  v_exp_f32_e64 v188, -v188
  v_exp_f32_e64 v189, -v189
  v_add_f32 v156, 1.0, v156
  v_add_f32 v157, 1.0, v157
  v_add_f32 v188, 1.0, v188
  v_add_f32 v189, 1.0, v189
  v_rcp_f32 v156, v156
  v_rcp_f32 v157, v157
  v_rcp_f32 v188, v188
  v_rcp_f32 v189, v189
  v_mul_f32 v158, v158, v156
  v_mul_f32 v159, v159, v157
  v_mul_f32 v190, v190, v188
  v_mul_f32 v191, v191, v189
  v_cvt_pk_bf16_f32 v94, v158, v159
  v_cvt_pk_bf16_f32 v95, v190, v191
  v_fmaak_f32 v4, v220, v220, 0x409d30fc
  v_fmaak_f32 v5, v221, v221, 0x409d30fc
  v_mul_f32 v222, v220, v222
  v_mul_f32 v223, v221, v223
  v_mul_f32 v220, v4, v220
  v_mul_f32 v221, v5, v221
  v_exp_f32_e64 v220, -v220
  v_exp_f32_e64 v221, -v221
  v_add_f32 v220, 1.0, v220
  v_add_f32 v221, 1.0, v221
  v_rcp_f32 v220, v220
  v_rcp_f32 v221, v221
  v_mul_f32 v222, v222, v220
  v_mul_f32 v223, v223, v221
  v_cvt_pk_bf16_f32 v217, v222, v223
  s_add_u32 s30, s34, 0
  buffer_store_dwordx4 v[92:95], v0, s[8:11], s30 offen offset:1024 sc1
  v_fmaak_f32 v4, v96, v96, 0x409d30fc
  v_fmaak_f32 v5, v97, v97, 0x409d30fc
  v_fmaak_f32 v6, v128, v128, 0x409d30fc
  v_fmaak_f32 v7, v129, v129, 0x409d30fc
  v_mul_f32 v98, v96, v98
  v_mul_f32 v99, v97, v99
  v_mul_f32 v130, v128, v130
  v_mul_f32 v131, v129, v131
  v_mul_f32 v96, v4, v96
  v_mul_f32 v97, v5, v97
  v_mul_f32 v128, v6, v128
  v_mul_f32 v129, v7, v129
  v_exp_f32_e64 v96, -v96
  v_exp_f32_e64 v97, -v97
  v_exp_f32_e64 v128, -v128
  v_exp_f32_e64 v129, -v129
  v_add_f32 v96, 1.0, v96
  v_add_f32 v97, 1.0, v97
  v_add_f32 v128, 1.0, v128
  v_add_f32 v129, 1.0, v129
  v_rcp_f32 v96, v96
  v_rcp_f32 v97, v97
  v_rcp_f32 v128, v128
  v_rcp_f32 v129, v129
  v_mul_f32 v98, v98, v96
  v_mul_f32 v99, v99, v97
  v_mul_f32 v130, v130, v128
  v_mul_f32 v131, v131, v129
  v_cvt_pk_bf16_f32 v96, v98, v99
  v_cvt_pk_bf16_f32 v97, v130, v131
  v_fmaak_f32 v4, v160, v160, 0x409d30fc
  v_fmaak_f32 v5, v161, v161, 0x409d30fc
  v_fmaak_f32 v6, v192, v192, 0x409d30fc
  v_fmaak_f32 v7, v193, v193, 0x409d30fc
  v_mul_f32 v162, v160, v162
  v_mul_f32 v163, v161, v163
  v_mul_f32 v194, v192, v194
  v_mul_f32 v195, v193, v195
  v_mul_f32 v160, v4, v160
  v_mul_f32 v161, v5, v161
  v_mul_f32 v192, v6, v192
  v_mul_f32 v193, v7, v193
  v_exp_f32_e64 v160, -v160
  v_exp_f32_e64 v161, -v161
  v_exp_f32_e64 v192, -v192
  v_exp_f32_e64 v193, -v193
  v_add_f32 v160, 1.0, v160
  v_add_f32 v161, 1.0, v161
  v_add_f32 v192, 1.0, v192
  v_add_f32 v193, 1.0, v193
  v_rcp_f32 v160, v160
  v_rcp_f32 v161, v161
  v_rcp_f32 v192, v192
  v_rcp_f32 v193, v193
  v_mul_f32 v162, v162, v160
  v_mul_f32 v163, v163, v161
  v_mul_f32 v194, v194, v192
  v_mul_f32 v195, v195, v193
  v_cvt_pk_bf16_f32 v98, v162, v163
  v_cvt_pk_bf16_f32 v99, v194, v195
  v_fmaak_f32 v4, v224, v224, 0x409d30fc
  v_fmaak_f32 v5, v225, v225, 0x409d30fc
  v_mul_f32 v226, v224, v226
  v_mul_f32 v227, v225, v227
  v_mul_f32 v224, v4, v224
  v_mul_f32 v225, v5, v225
  v_exp_f32_e64 v224, -v224
  v_exp_f32_e64 v225, -v225
  v_add_f32 v224, 1.0, v224
  v_add_f32 v225, 1.0, v225
  v_rcp_f32 v224, v224
  v_rcp_f32 v225, v225
  v_mul_f32 v226, v226, v224
  v_mul_f32 v227, v227, v225
  v_cvt_pk_bf16_f32 v218, v226, v227
  s_add_u32 s30, s34, 0
  buffer_store_dwordx4 v[96:99], v0, s[8:11], s30 offen offset:2048 sc1
  v_fmaak_f32 v4, v100, v100, 0x409d30fc
  v_fmaak_f32 v5, v101, v101, 0x409d30fc
  v_fmaak_f32 v6, v132, v132, 0x409d30fc
  v_fmaak_f32 v7, v133, v133, 0x409d30fc
  v_mul_f32 v102, v100, v102
  v_mul_f32 v103, v101, v103
  v_mul_f32 v134, v132, v134
  v_mul_f32 v135, v133, v135
  v_mul_f32 v100, v4, v100
  v_mul_f32 v101, v5, v101
  v_mul_f32 v132, v6, v132
  v_mul_f32 v133, v7, v133
  v_exp_f32_e64 v100, -v100
  v_exp_f32_e64 v101, -v101
  v_exp_f32_e64 v132, -v132
  v_exp_f32_e64 v133, -v133
  v_add_f32 v100, 1.0, v100
  v_add_f32 v101, 1.0, v101
  v_add_f32 v132, 1.0, v132
  v_add_f32 v133, 1.0, v133
  v_rcp_f32 v100, v100
  v_rcp_f32 v101, v101
  v_rcp_f32 v132, v132
  v_rcp_f32 v133, v133
  v_mul_f32 v102, v102, v100
  v_mul_f32 v103, v103, v101
  v_mul_f32 v134, v134, v132
  v_mul_f32 v135, v135, v133
  v_cvt_pk_bf16_f32 v100, v102, v103
  v_cvt_pk_bf16_f32 v101, v134, v135
  v_fmaak_f32 v4, v164, v164, 0x409d30fc
  v_fmaak_f32 v5, v165, v165, 0x409d30fc
  v_fmaak_f32 v6, v196, v196, 0x409d30fc
  v_fmaak_f32 v7, v197, v197, 0x409d30fc
  v_mul_f32 v166, v164, v166
  v_mul_f32 v167, v165, v167
  v_mul_f32 v198, v196, v198
  v_mul_f32 v199, v197, v199
  v_mul_f32 v164, v4, v164
  v_mul_f32 v165, v5, v165
  v_mul_f32 v196, v6, v196
  v_mul_f32 v197, v7, v197
  v_exp_f32_e64 v164, -v164
  v_exp_f32_e64 v165, -v165
  v_exp_f32_e64 v196, -v196
  v_exp_f32_e64 v197, -v197
  v_add_f32 v164, 1.0, v164
  v_add_f32 v165, 1.0, v165
  v_add_f32 v196, 1.0, v196
  v_add_f32 v197, 1.0, v197
  v_rcp_f32 v164, v164
  v_rcp_f32 v165, v165
  v_rcp_f32 v196, v196
  v_rcp_f32 v197, v197
  v_mul_f32 v166, v166, v164
  v_mul_f32 v167, v167, v165
  v_mul_f32 v198, v198, v196
  v_mul_f32 v199, v199, v197
  v_cvt_pk_bf16_f32 v102, v166, v167
  v_cvt_pk_bf16_f32 v103, v198, v199
  v_fmaak_f32 v4, v228, v228, 0x409d30fc
  v_fmaak_f32 v5, v229, v229, 0x409d30fc
  v_mul_f32 v230, v228, v230
  v_mul_f32 v231, v229, v231
  v_mul_f32 v228, v4, v228
  v_mul_f32 v229, v5, v229
  v_exp_f32_e64 v228, -v228
  v_exp_f32_e64 v229, -v229
  v_add_f32 v228, 1.0, v228
  v_add_f32 v229, 1.0, v229
  v_rcp_f32 v228, v228
  v_rcp_f32 v229, v229
  v_mul_f32 v230, v230, v228
  v_mul_f32 v231, v231, v229
  v_cvt_pk_bf16_f32 v219, v230, v231
  s_add_u32 s30, s34, 0
  buffer_store_dwordx4 v[100:103], v0, s[8:11], s30 offen offset:3072 sc1
  v_fmaak_f32 v4, v104, v104, 0x409d30fc
  v_fmaak_f32 v5, v105, v105, 0x409d30fc
  v_fmaak_f32 v6, v136, v136, 0x409d30fc
  v_fmaak_f32 v7, v137, v137, 0x409d30fc
  v_mul_f32 v106, v104, v106
  v_mul_f32 v107, v105, v107
  v_mul_f32 v138, v136, v138
  v_mul_f32 v139, v137, v139
  v_mul_f32 v104, v4, v104
  v_mul_f32 v105, v5, v105
  v_mul_f32 v136, v6, v136
  v_mul_f32 v137, v7, v137
  v_exp_f32_e64 v104, -v104
  v_exp_f32_e64 v105, -v105
  v_exp_f32_e64 v136, -v136
  v_exp_f32_e64 v137, -v137
  v_add_f32 v104, 1.0, v104
  v_add_f32 v105, 1.0, v105
  v_add_f32 v136, 1.0, v136
  v_add_f32 v137, 1.0, v137
  ds_read_b32 v250, v254 offset:0
  v_rcp_f32 v104, v104
  v_rcp_f32 v105, v105
  v_rcp_f32 v136, v136
  v_rcp_f32 v137, v137
  v_mul_f32 v106, v106, v104
  v_mul_f32 v107, v107, v105
  v_mul_f32 v138, v138, v136
  v_mul_f32 v139, v139, v137
  v_cvt_pk_bf16_f32 v104, v106, v107
  v_cvt_pk_bf16_f32 v105, v138, v139
  v_fmaak_f32 v4, v168, v168, 0x409d30fc
  v_fmaak_f32 v5, v169, v169, 0x409d30fc
  v_fmaak_f32 v6, v200, v200, 0x409d30fc
  v_fmaak_f32 v7, v201, v201, 0x409d30fc
  v_mul_f32 v170, v168, v170
  v_mul_f32 v171, v169, v171
  v_mul_f32 v202, v200, v202
  v_mul_f32 v203, v201, v203
  v_mul_f32 v168, v4, v168
  v_mul_f32 v169, v5, v169
  s_waitcnt lgkmcnt(0)
  v_cmp_gt_u32 vcc, 2, v250
  s_cbranch_vccnz per_A_x18s
per_A_x18r:
  ds_read_b32 v250, v254 offset:1024
  v_mul_f32 v200, v6, v200
  v_mul_f32 v201, v7, v201
  v_exp_f32_e64 v168, -v168
  v_exp_f32_e64 v169, -v169
  v_exp_f32_e64 v200, -v200
  v_exp_f32_e64 v201, -v201
  v_add_f32 v168, 1.0, v168
  v_add_f32 v169, 1.0, v169
  v_add_f32 v200, 1.0, v200
  v_add_f32 v201, 1.0, v201
  v_rcp_f32 v168, v168
  v_rcp_f32 v169, v169
  v_rcp_f32 v200, v200
  v_rcp_f32 v201, v201
  v_mul_f32 v170, v170, v168
  v_mul_f32 v171, v171, v169
  v_mul_f32 v202, v202, v200
  v_mul_f32 v203, v203, v201
  v_cvt_pk_bf16_f32 v106, v170, v171
  v_cvt_pk_bf16_f32 v107, v202, v203
  v_fmaak_f32 v4, v232, v232, 0x409d30fc
  v_fmaak_f32 v5, v233, v233, 0x409d30fc
  v_mul_f32 v234, v232, v234
  v_mul_f32 v235, v233, v235
  v_mul_f32 v232, v4, v232
  v_mul_f32 v233, v5, v233
  v_exp_f32_e64 v232, -v232
  v_exp_f32_e64 v233, -v233
  v_add_f32 v232, 1.0, v232
  v_add_f32 v233, 1.0, v233
  v_rcp_f32 v232, v232
  v_rcp_f32 v233, v233
  v_mul_f32 v234, v234, v232
  v_mul_f32 v235, v235, v233
  v_cvt_pk_bf16_f32 v232, v234, v235
  s_add_u32 s30, s34, 4096
  buffer_store_dwordx4 v[104:107], v0, s[8:11], s30 offen offset:0 sc1
  s_waitcnt lgkmcnt(0)
  v_cmp_gt_u32 vcc, 19, v250
  s_cbranch_vccnz per_A_x19s
per_A_x19r:
  ds_write_b32 v253, v216 offset:0
  ds_write_b128 v252, v[88:91] offset:0
  ds_write_b32 v253, v217 offset:1024
  ds_write_b128 v252, v[92:95] offset:1024
  ds_write_b32 v253, v218 offset:2048
  ds_write_b128 v252, v[96:99] offset:2048
  ds_write_b32 v253, v219 offset:3072
  ds_write_b128 v252, v[100:103] offset:3072
  ds_write_b32 v253, v232 offset:4096
  ds_write_b128 v252, v[104:107] offset:4096
  v_fmaak_f32 v4, v108, v108, 0x409d30fc
  v_fmaak_f32 v5, v109, v109, 0x409d30fc
  v_fmaak_f32 v6, v140, v140, 0x409d30fc
  v_fmaak_f32 v7, v141, v141, 0x409d30fc
  v_mul_f32 v110, v108, v110
  v_mul_f32 v111, v109, v111
  v_mul_f32 v142, v140, v142
  v_mul_f32 v143, v141, v143
  v_mul_f32 v108, v4, v108
  v_mul_f32 v109, v5, v109
  v_mul_f32 v140, v6, v140
  v_mul_f32 v141, v7, v141
  v_exp_f32_e64 v108, -v108
  v_exp_f32_e64 v109, -v109
  v_exp_f32_e64 v140, -v140
  v_exp_f32_e64 v141, -v141
  v_add_f32 v108, 1.0, v108
  v_add_f32 v109, 1.0, v109
  v_add_f32 v140, 1.0, v140
  v_add_f32 v141, 1.0, v141
  v_rcp_f32 v108, v108
  v_rcp_f32 v109, v109
  v_rcp_f32 v140, v140
  v_rcp_f32 v141, v141
  v_mul_f32 v110, v110, v108
  v_mul_f32 v111, v111, v109
  v_mul_f32 v142, v142, v140
  v_mul_f32 v143, v143, v141
  v_cvt_pk_bf16_f32 v108, v110, v111
  v_cvt_pk_bf16_f32 v109, v142, v143
  v_fmaak_f32 v4, v172, v172, 0x409d30fc
  v_fmaak_f32 v5, v173, v173, 0x409d30fc
  v_fmaak_f32 v6, v204, v204, 0x409d30fc
  v_fmaak_f32 v7, v205, v205, 0x409d30fc
  v_mul_f32 v174, v172, v174
  v_mul_f32 v175, v173, v175
  v_mul_f32 v206, v204, v206
  v_mul_f32 v207, v205, v207
  v_mul_f32 v172, v4, v172
  v_mul_f32 v173, v5, v173
  v_mul_f32 v204, v6, v204
  v_mul_f32 v205, v7, v205
  v_exp_f32_e64 v172, -v172
  v_exp_f32_e64 v173, -v173
  v_exp_f32_e64 v204, -v204
  v_exp_f32_e64 v205, -v205
  v_add_f32 v172, 1.0, v172
  v_add_f32 v173, 1.0, v173
  v_add_f32 v204, 1.0, v204
  v_add_f32 v205, 1.0, v205
  v_rcp_f32 v172, v172
  v_rcp_f32 v173, v173
  v_rcp_f32 v204, v204
  v_rcp_f32 v205, v205
  v_mul_f32 v174, v174, v172
  v_mul_f32 v175, v175, v173
  v_mul_f32 v206, v206, v204
  v_mul_f32 v207, v207, v205
  v_cvt_pk_bf16_f32 v110, v174, v175
  v_cvt_pk_bf16_f32 v111, v206, v207
  v_fmaak_f32 v4, v236, v236, 0x409d30fc
  v_fmaak_f32 v5, v237, v237, 0x409d30fc
  v_mul_f32 v238, v236, v238
  v_mul_f32 v239, v237, v239
  v_mul_f32 v236, v4, v236
  v_mul_f32 v237, v5, v237
  v_exp_f32_e64 v236, -v236
  v_exp_f32_e64 v237, -v237
  v_add_f32 v236, 1.0, v236
  v_add_f32 v237, 1.0, v237
  v_rcp_f32 v236, v236
  v_rcp_f32 v237, v237
  v_mul_f32 v238, v238, v236
  v_mul_f32 v239, v239, v237
  v_cvt_pk_bf16_f32 v233, v238, v239
  s_add_u32 s30, s34, 4096
  buffer_store_dwordx4 v[108:111], v0, s[8:11], s30 offen offset:1024 sc1
  ds_write_b32 v253, v233 offset:5120
  ds_write_b128 v252, v[108:111] offset:5120
  s_waitcnt vmcnt(2)
  v_mov_b32 v248, 0
  v_mov_b32 v249, s96
  buffer_store_dword v249, v248, s[8:11], s38 offen offset:0 sc1
  v_fmaak_f32 v4, v112, v112, 0x409d30fc
  v_fmaak_f32 v5, v113, v113, 0x409d30fc
  v_fmaak_f32 v6, v144, v144, 0x409d30fc
  v_fmaak_f32 v7, v145, v145, 0x409d30fc
  v_mul_f32 v114, v112, v114
  v_mul_f32 v115, v113, v115
  v_mul_f32 v146, v144, v146
  v_mul_f32 v147, v145, v147
  v_mul_f32 v112, v4, v112
  v_mul_f32 v113, v5, v113
  v_mul_f32 v144, v6, v144
  v_mul_f32 v145, v7, v145
  v_exp_f32_e64 v112, -v112
  v_exp_f32_e64 v113, -v113
  v_exp_f32_e64 v144, -v144
  v_exp_f32_e64 v145, -v145
  v_add_f32 v112, 1.0, v112
  v_add_f32 v113, 1.0, v113
  v_add_f32 v144, 1.0, v144
  v_add_f32 v145, 1.0, v145
  v_rcp_f32 v112, v112
  v_rcp_f32 v113, v113
  v_rcp_f32 v144, v144
  v_rcp_f32 v145, v145
  v_mul_f32 v114, v114, v112
  v_mul_f32 v115, v115, v113
  v_mul_f32 v146, v146, v144
  v_mul_f32 v147, v147, v145
  v_cvt_pk_bf16_f32 v112, v114, v115
  v_cvt_pk_bf16_f32 v113, v146, v147
  v_fmaak_f32 v4, v176, v176, 0x409d30fc
  v_fmaak_f32 v5, v177, v177, 0x409d30fc
  v_fmaak_f32 v6, v208, v208, 0x409d30fc
  v_fmaak_f32 v7, v209, v209, 0x409d30fc
  v_mul_f32 v178, v176, v178
  v_mul_f32 v179, v177, v179
  v_mul_f32 v210, v208, v210
  v_mul_f32 v211, v209, v211
  v_mul_f32 v176, v4, v176
  v_mul_f32 v177, v5, v177
  v_mul_f32 v208, v6, v208
  v_mul_f32 v209, v7, v209
  v_exp_f32_e64 v176, -v176
  v_exp_f32_e64 v177, -v177
  v_exp_f32_e64 v208, -v208
  v_exp_f32_e64 v209, -v209
  v_add_f32 v176, 1.0, v176
  v_add_f32 v177, 1.0, v177
  v_add_f32 v208, 1.0, v208
  v_add_f32 v209, 1.0, v209
  v_rcp_f32 v176, v176
  v_rcp_f32 v177, v177
  v_rcp_f32 v208, v208
  v_rcp_f32 v209, v209
  v_mul_f32 v178, v178, v176
  v_mul_f32 v179, v179, v177
  v_mul_f32 v210, v210, v208
  v_mul_f32 v211, v211, v209
  v_cvt_pk_bf16_f32 v114, v178, v179
  v_cvt_pk_bf16_f32 v115, v210, v211
  v_fmaak_f32 v4, v240, v240, 0x409d30fc
  v_fmaak_f32 v5, v241, v241, 0x409d30fc
  v_mul_f32 v242, v240, v242
  v_mul_f32 v243, v241, v243
  v_mul_f32 v240, v4, v240
  v_mul_f32 v241, v5, v241
  v_exp_f32_e64 v240, -v240
  v_exp_f32_e64 v241, -v241
  v_add_f32 v240, 1.0, v240
  v_add_f32 v241, 1.0, v241
  v_rcp_f32 v240, v240
  v_rcp_f32 v241, v241
  v_mul_f32 v242, v242, v240
  v_mul_f32 v243, v243, v241
  v_cvt_pk_bf16_f32 v234, v242, v243
  s_add_u32 s30, s34, 4096
  buffer_store_dwordx4 v[112:115], v0, s[8:11], s30 offen offset:2048 sc1
  ds_write_b32 v253, v234 offset:6144
  ds_write_b128 v252, v[112:115] offset:6144
  v_fmaak_f32 v4, v116, v116, 0x409d30fc
  v_fmaak_f32 v5, v117, v117, 0x409d30fc
  v_fmaak_f32 v6, v148, v148, 0x409d30fc
  v_fmaak_f32 v7, v149, v149, 0x409d30fc
  v_mul_f32 v118, v116, v118
  v_mul_f32 v119, v117, v119
  v_mul_f32 v150, v148, v150
  v_mul_f32 v151, v149, v151
  v_mul_f32 v116, v4, v116
  v_mul_f32 v117, v5, v117
  v_mul_f32 v148, v6, v148
  v_mul_f32 v149, v7, v149
  v_exp_f32_e64 v116, -v116
  v_exp_f32_e64 v117, -v117
  v_exp_f32_e64 v148, -v148
  v_exp_f32_e64 v149, -v149
  v_add_f32 v116, 1.0, v116
  v_add_f32 v117, 1.0, v117
  v_add_f32 v148, 1.0, v148
  v_add_f32 v149, 1.0, v149
  v_rcp_f32 v116, v116
  v_rcp_f32 v117, v117
  v_rcp_f32 v148, v148
  v_rcp_f32 v149, v149
  v_mul_f32 v118, v118, v116
  v_mul_f32 v119, v119, v117
  v_mul_f32 v150, v150, v148
  v_mul_f32 v151, v151, v149
  v_cvt_pk_bf16_f32 v116, v118, v119
  v_cvt_pk_bf16_f32 v117, v150, v151
  v_fmaak_f32 v4, v180, v180, 0x409d30fc
  v_fmaak_f32 v5, v181, v181, 0x409d30fc
  v_fmaak_f32 v6, v212, v212, 0x409d30fc
  v_fmaak_f32 v7, v213, v213, 0x409d30fc
  v_mul_f32 v182, v180, v182
  v_mul_f32 v183, v181, v183
  v_mul_f32 v214, v212, v214
  v_mul_f32 v215, v213, v215
  v_mul_f32 v180, v4, v180
  v_mul_f32 v181, v5, v181
  v_mul_f32 v212, v6, v212
  v_mul_f32 v213, v7, v213
  v_exp_f32_e64 v180, -v180
  v_exp_f32_e64 v181, -v181
  v_exp_f32_e64 v212, -v212
  v_exp_f32_e64 v213, -v213
  v_add_f32 v180, 1.0, v180
  v_add_f32 v181, 1.0, v181
  v_add_f32 v212, 1.0, v212
  v_add_f32 v213, 1.0, v213
  v_rcp_f32 v180, v180
  v_rcp_f32 v181, v181
  v_rcp_f32 v212, v212
  v_rcp_f32 v213, v213
  v_mul_f32 v182, v182, v180
  v_mul_f32 v183, v183, v181
  v_mul_f32 v214, v214, v212
  v_mul_f32 v215, v215, v213
  v_cvt_pk_bf16_f32 v118, v182, v183
  v_cvt_pk_bf16_f32 v119, v214, v215
  v_fmaak_f32 v4, v244, v244, 0x409d30fc
  v_fmaak_f32 v5, v245, v245, 0x409d30fc
  v_mul_f32 v246, v244, v246
  v_mul_f32 v247, v245, v247
  v_mul_f32 v244, v4, v244
  v_mul_f32 v245, v5, v245
  v_exp_f32_e64 v244, -v244
  v_exp_f32_e64 v245, -v245
  v_add_f32 v244, 1.0, v244
  v_add_f32 v245, 1.0, v245
  v_rcp_f32 v244, v244
  v_rcp_f32 v245, v245
  v_mul_f32 v246, v246, v244
  v_mul_f32 v247, v247, v245
  v_cvt_pk_bf16_f32 v235, v246, v247
  v_mov_b32 v248, 0
  buffer_load_dword v249, v248, s[8:11], s39 offen offset:0 sc1
  s_add_u32 s30, s34, 4096
  buffer_store_dwordx4 v[116:119], v0, s[8:11], s30 offen offset:3072 sc1
  ds_write_b32 v253, v235 offset:7168
  ds_write_b128 v252, v[116:119] offset:7168
  v_mov_b32 v248, 3
  ds_write_b32 v251, v248
  v_add_u32 v208, s17, v0
  v_subrev_u32 v211, s17, v0
  v_add_u32 v209, s17, v1
  v_subrev_u32 v212, s17, v1
  v_add_u32 v210, s17, v2
  v_subrev_u32 v213, s17, v2
  v_add_u32 v214, s25, v0
  ds_read_b32 v250, v254 offset:0
  s_waitcnt lgkmcnt(0)
  v_cmp_gt_u32 vcc, 3, v250
  s_cbranch_vccnz per_A_x20s
per_A_x20r:
  ds_read_b128 v[240:243], v214 offset:32768
  ds_read_b128 v[244:247], v214 offset:33792
  ds_read_b32 v250, v254 offset:1024
  s_waitcnt lgkmcnt(0)
  v_cmp_gt_u32 vcc, 20, v250
  s_cbranch_vccnz per_A_x21s
per_A_x21r:
  s_setprio 0
  ds_read_b128 v[4:7], v208 offset:0
  ds_read_b128 v[8:11], v211 offset:1024
  ds_read_b128 v[12:15], v208 offset:2048
  ds_read_b128 v[16:19], v211 offset:3072
  ds_read_b128 v[20:23], v208 offset:4096
  ds_read_b128 v[24:27], v211 offset:5120
  ds_read_b128 v[168:171], v208 offset:6144
  ds_read_b128 v[172:175], v211 offset:7168
  s_waitcnt lgkmcnt(7)
  v_mfma_f32_16x16x32_bf16 v[88:91], v[28:31], v[4:7], 0
  v_mfma_f32_16x16x32_bf16 v[120:123], v[32:35], v[4:7], 0
  s_add_u32 s29, s22, 294912
  buffer_load_dwordx4 v[76:79], v0, s[8:11], s29 offen offset:0
  v_mfma_f32_16x16x32_bf16 v[152:155], v[36:39], v[4:7], 0
  buffer_store_dwordx4 v[240:243], v0, s[8:11], s36 offen offset:0 sc1
  buffer_store_dwordx4 v[244:247], v0, s[8:11], s36 offen offset:1024 sc1
  s_waitcnt lgkmcnt(6)
  v_mfma_f32_16x16x32_bf16 v[92:95], v[28:31], v[8:11], 0
  ds_read_b128 v[4:7], v208 offset:8192
  v_mfma_f32_16x16x32_bf16 v[124:127], v[32:35], v[8:11], 0
  buffer_load_dwordx4 v[80:83], v0, s[8:11], s29 offen offset:1024
  s_waitcnt vmcnt(5)
  v_cmp_ne_u32 vcc, s96, v249
  s_cbranch_vccnz per_A_poll0s
per_A_poll0r:
  s_add_u32 m0, s18, 40960
  s_add_u32 s30, s35, 0
  buffer_load_dwordx4 v0, s[8:11], s30 offen offset:0 sc1 lds
  s_waitcnt lgkmcnt(6)
  v_mfma_f32_16x16x32_bf16 v[96:99], v[28:31], v[12:15], 0
  ds_read_b128 v[8:11], v211 offset:9216
  v_mfma_f32_16x16x32_bf16 v[128:131], v[32:35], v[12:15], 0
  s_add_u32 s28, s23, 294912
  buffer_load_dwordx4 v[84:87], v0, s[8:11], s28 offen offset:0
  v_mfma_f32_16x16x32_bf16 v[156:159], v[36:39], v[12:15], 0
  s_waitcnt lgkmcnt(6)
  v_mfma_f32_16x16x32_bf16 v[100:103], v[28:31], v[16:19], 0
  ds_read_b128 v[12:15], v208 offset:10240
  v_mfma_f32_16x16x32_bf16 v[132:135], v[32:35], v[16:19], 0
  s_add_u32 m0, s18, 40960
  s_add_u32 s30, s35, 0
  buffer_load_dwordx4 v0, s[8:11], s30 offen offset:1024 sc1 lds
  s_waitcnt lgkmcnt(6)
  v_mfma_f32_16x16x32_bf16 v[104:107], v[28:31], v[20:23], 0
  ds_read_b128 v[16:19], v211 offset:11264
  v_mfma_f32_16x16x32_bf16 v[136:139], v[32:35], v[20:23], 0
  v_mfma_f32_16x16x32_bf16 v[160:163], v[36:39], v[20:23], 0
  s_waitcnt lgkmcnt(6)
  v_mfma_f32_16x16x32_bf16 v[108:111], v[28:31], v[24:27], 0
  ds_read_b128 v[20:23], v208 offset:12288
  v_mfma_f32_16x16x32_bf16 v[140:143], v[32:35], v[24:27], 0
  s_waitcnt lgkmcnt(6)
  v_mfma_f32_16x16x32_bf16 v[112:115], v[28:31], v[168:171], 0
  ds_read_b128 v[24:27], v211 offset:13312
  v_mfma_f32_16x16x32_bf16 v[144:147], v[32:35], v[168:171], 0
  v_mfma_f32_16x16x32_bf16 v[164:167], v[36:39], v[168:171], 0
  s_add_u32 m0, s18, 40960
  s_add_u32 s30, s35, 0
  buffer_load_dwordx4 v0, s[8:11], s30 offen offset:2048 sc1 lds
  s_waitcnt lgkmcnt(6)
  v_mfma_f32_16x16x32_bf16 v[116:119], v[28:31], v[172:175], 0
  ds_read_b128 v[168:171], v208 offset:14336
  v_mfma_f32_16x16x32_bf16 v[148:151], v[32:35], v[172:175], 0
  s_waitcnt lgkmcnt(6)
  v_mfma_f32_16x16x32_bf16 v[88:91], v[40:43], v[4:7], v[88:91]
  ds_read_b128 v[172:175], v211 offset:15360
  v_mfma_f32_16x16x32_bf16 v[120:123], v[44:47], v[4:7], v[120:123]
  s_add_u32 s29, s32, 0
  buffer_load_dwordx4 v[176:179], v0, s[8:11], s29 offen offset:0
  v_mfma_f32_16x16x32_bf16 v[152:155], v[48:51], v[4:7], v[152:155]
  s_waitcnt lgkmcnt(6)
  v_mfma_f32_16x16x32_bf16 v[92:95], v[40:43], v[8:11], v[92:95]
  ds_read_b128 v[4:7], v208 offset:16384
  v_mfma_f32_16x16x32_bf16 v[124:127], v[44:47], v[8:11], v[124:127]
  buffer_load_dwordx4 v[180:183], v0, s[8:11], s29 offen offset:1024
  s_add_u32 m0, s18, 40960
  s_add_u32 s30, s35, 0
  buffer_load_dwordx4 v0, s[8:11], s30 offen offset:3072 sc1 lds
  s_waitcnt lgkmcnt(6)
  v_mfma_f32_16x16x32_bf16 v[96:99], v[40:43], v[12:15], v[96:99]
  ds_read_b128 v[8:11], v211 offset:17408
  v_mfma_f32_16x16x32_bf16 v[128:131], v[44:47], v[12:15], v[128:131]
  s_add_u32 s28, s33, 0
  buffer_load_dwordx4 v[184:187], v0, s[8:11], s28 offen offset:0
  v_mfma_f32_16x16x32_bf16 v[156:159], v[48:51], v[12:15], v[156:159]
  s_waitcnt lgkmcnt(6)
  v_mfma_f32_16x16x32_bf16 v[100:103], v[40:43], v[16:19], v[100:103]
  ds_read_b128 v[12:15], v208 offset:18432
  v_mfma_f32_16x16x32_bf16 v[132:135], v[44:47], v[16:19], v[132:135]
  s_waitcnt lgkmcnt(6)
  v_mfma_f32_16x16x32_bf16 v[104:107], v[40:43], v[20:23], v[104:107]
  ds_read_b128 v[16:19], v211 offset:19456
  v_mfma_f32_16x16x32_bf16 v[136:139], v[44:47], v[20:23], v[136:139]
  v_mfma_f32_16x16x32_bf16 v[160:163], v[48:51], v[20:23], v[160:163]
  s_waitcnt lgkmcnt(6)
  v_mfma_f32_16x16x32_bf16 v[108:111], v[40:43], v[24:27], v[108:111]
  ds_read_b128 v[20:23], v208 offset:20480
  v_mfma_f32_16x16x32_bf16 v[140:143], v[44:47], v[24:27], v[140:143]
  s_waitcnt lgkmcnt(6)
  v_mfma_f32_16x16x32_bf16 v[112:115], v[40:43], v[168:171], v[112:115]
  ds_read_b128 v[24:27], v211 offset:21504
  v_mfma_f32_16x16x32_bf16 v[144:147], v[44:47], v[168:171], v[144:147]
  v_mfma_f32_16x16x32_bf16 v[164:167], v[48:51], v[168:171], v[164:167]
  s_waitcnt lgkmcnt(6)
  v_mfma_f32_16x16x32_bf16 v[116:119], v[40:43], v[172:175], v[116:119]
  ds_read_b128 v[168:171], v208 offset:22528
  v_mfma_f32_16x16x32_bf16 v[148:151], v[44:47], v[172:175], v[148:151]
  s_waitcnt vmcnt(9)
  v_mov_b32 v248, 0
  v_mov_b32 v249, s96
  buffer_store_dword v249, v248, s[8:11], s38 offen offset:4 sc1
  s_waitcnt lgkmcnt(6)
  v_mfma_f32_16x16x32_bf16 v[88:91], v[52:55], v[4:7], v[88:91]
  ds_read_b128 v[172:175], v211 offset:23552
  v_mfma_f32_16x16x32_bf16 v[120:123], v[56:59], v[4:7], v[120:123]
  s_add_u32 s29, s32, 36864
  buffer_load_dwordx4 v[188:191], v0, s[8:11], s29 offen offset:0
  v_mfma_f32_16x16x32_bf16 v[152:155], v[60:63], v[4:7], v[152:155]
  s_waitcnt lgkmcnt(6)
  v_mfma_f32_16x16x32_bf16 v[92:95], v[52:55], v[8:11], v[92:95]
  ds_read_b128 v[4:7], v208 offset:24576
  v_mfma_f32_16x16x32_bf16 v[124:127], v[56:59], v[8:11], v[124:127]
  buffer_load_dwordx4 v[192:195], v0, s[8:11], s29 offen offset:1024
  s_waitcnt lgkmcnt(6)
  v_mfma_f32_16x16x32_bf16 v[96:99], v[52:55], v[12:15], v[96:99]
  ds_read_b128 v[8:11], v211 offset:25600
  v_mfma_f32_16x16x32_bf16 v[128:131], v[56:59], v[12:15], v[128:131]
  s_add_u32 s28, s33, 36864
  buffer_load_dwordx4 v[196:199], v0, s[8:11], s28 offen offset:0
  v_mfma_f32_16x16x32_bf16 v[156:159], v[60:63], v[12:15], v[156:159]
  s_waitcnt lgkmcnt(6)
  v_mfma_f32_16x16x32_bf16 v[100:103], v[52:55], v[16:19], v[100:103]
  ds_read_b128 v[12:15], v208 offset:26624
  v_mfma_f32_16x16x32_bf16 v[132:135], v[56:59], v[16:19], v[132:135]
  s_waitcnt lgkmcnt(6)
  v_mfma_f32_16x16x32_bf16 v[104:107], v[52:55], v[20:23], v[104:107]
  ds_read_b128 v[16:19], v211 offset:27648
  v_mfma_f32_16x16x32_bf16 v[136:139], v[56:59], v[20:23], v[136:139]
  v_mfma_f32_16x16x32_bf16 v[160:163], v[60:63], v[20:23], v[160:163]
  s_waitcnt lgkmcnt(6)
  v_mfma_f32_16x16x32_bf16 v[108:111], v[52:55], v[24:27], v[108:111]
  ds_read_b128 v[20:23], v208 offset:28672
  v_mfma_f32_16x16x32_bf16 v[140:143], v[56:59], v[24:27], v[140:143]
  s_waitcnt lgkmcnt(6)
  v_mfma_f32_16x16x32_bf16 v[112:115], v[52:55], v[168:171], v[112:115]
  ds_read_b128 v[24:27], v211 offset:29696
  v_mfma_f32_16x16x32_bf16 v[144:147], v[56:59], v[168:171], v[144:147]
  v_mfma_f32_16x16x32_bf16 v[164:167], v[60:63], v[168:171], v[164:167]
  s_waitcnt lgkmcnt(6)
  v_mfma_f32_16x16x32_bf16 v[116:119], v[52:55], v[172:175], v[116:119]
  ds_read_b128 v[168:171], v208 offset:30720
  v_mfma_f32_16x16x32_bf16 v[148:151], v[56:59], v[172:175], v[148:151]
  s_waitcnt vmcnt(5)
  v_mov_b32 v248, 4
  ds_write_b32 v251, v248
  s_waitcnt lgkmcnt(7)
  v_mfma_f32_16x16x32_bf16 v[88:91], v[64:67], v[4:7], v[88:91]
  ds_read_b128 v[172:175], v211 offset:31744
  v_mfma_f32_16x16x32_bf16 v[120:123], v[68:71], v[4:7], v[120:123]
  s_add_u32 s29, s32, 73728
  buffer_load_dwordx4 v[200:203], v0, s[8:11], s29 offen offset:0
  v_mfma_f32_16x16x32_bf16 v[152:155], v[72:75], v[4:7], v[152:155]
  s_waitcnt lgkmcnt(7)
  v_mfma_f32_16x16x32_bf16 v[92:95], v[64:67], v[8:11], v[92:95]
  ds_read_b128 v[4:7], v208 offset:32768
  v_mfma_f32_16x16x32_bf16 v[124:127], v[68:71], v[8:11], v[124:127]
  buffer_load_dwordx4 v[204:207], v0, s[8:11], s29 offen offset:1024
  v_mov_b32 v248, 0
  buffer_load_dword v249, v248, s[8:11], s39 offen offset:4 sc1
  s_waitcnt lgkmcnt(7)
  v_mfma_f32_16x16x32_bf16 v[96:99], v[64:67], v[12:15], v[96:99]
  ds_read_b128 v[8:11], v211 offset:33792
  v_mfma_f32_16x16x32_bf16 v[128:131], v[68:71], v[12:15], v[128:131]
  s_add_u32 s28, s33, 73728
  buffer_load_dwordx4 v[216:219], v0, s[8:11], s28 offen offset:0
  v_mfma_f32_16x16x32_bf16 v[156:159], v[72:75], v[12:15], v[156:159]
  s_waitcnt lgkmcnt(7)
  v_mfma_f32_16x16x32_bf16 v[100:103], v[64:67], v[16:19], v[100:103]
  ds_read_b128 v[12:15], v208 offset:34816
  v_mfma_f32_16x16x32_bf16 v[132:135], v[68:71], v[16:19], v[132:135]
  s_waitcnt lgkmcnt(7)
  v_mfma_f32_16x16x32_bf16 v[104:107], v[64:67], v[20:23], v[104:107]
  ds_read_b128 v[16:19], v211 offset:35840
  v_mfma_f32_16x16x32_bf16 v[136:139], v[68:71], v[20:23], v[136:139]
  v_mfma_f32_16x16x32_bf16 v[160:163], v[72:75], v[20:23], v[160:163]
  s_waitcnt lgkmcnt(7)
  v_mfma_f32_16x16x32_bf16 v[108:111], v[64:67], v[24:27], v[108:111]
  ds_read_b128 v[20:23], v208 offset:36864
  v_mfma_f32_16x16x32_bf16 v[140:143], v[68:71], v[24:27], v[140:143]
  s_waitcnt lgkmcnt(7)
  v_mfma_f32_16x16x32_bf16 v[112:115], v[64:67], v[168:171], v[112:115]
  ds_read_b128 v[24:27], v211 offset:37888
  v_mfma_f32_16x16x32_bf16 v[144:147], v[68:71], v[168:171], v[144:147]
  v_mfma_f32_16x16x32_bf16 v[164:167], v[72:75], v[168:171], v[164:167]
  s_waitcnt lgkmcnt(6)
  v_mfma_f32_16x16x32_bf16 v[116:119], v[64:67], v[172:175], v[116:119]
  ds_read_b128 v[168:171], v208 offset:38912
  v_mfma_f32_16x16x32_bf16 v[148:151], v[68:71], v[172:175], v[148:151]
  s_waitcnt vmcnt(1)
  v_cmp_ne_u32 vcc, s96, v249
  s_cbranch_vccnz per_A_poll1s
per_A_poll1r:
  s_add_u32 m0, s18, 45056
  s_add_u32 s30, s35, 4096
  buffer_load_dwordx4 v0, s[8:11], s30 offen offset:0 sc1 lds
  s_waitcnt lgkmcnt(6)
  v_mfma_f32_16x16x32_bf16 v[88:91], v[76:79], v[4:7], v[88:91]
  ds_read_b128 v[172:175], v211 offset:39936
  ds_read_b32 v250, v254 offset:0
  v_mfma_f32_16x16x32_bf16 v[120:123], v[80:83], v[4:7], v[120:123]
  s_add_u32 s29, s32, 110592
  buffer_load_dwordx4 v[220:223], v0, s[8:11], s29 offen offset:0
  v_mfma_f32_16x16x32_bf16 v[152:155], v[84:87], v[4:7], v[152:155]
  s_waitcnt lgkmcnt(7)
  v_mfma_f32_16x16x32_bf16 v[92:95], v[76:79], v[8:11], v[92:95]
  s_waitcnt lgkmcnt(0)
  v_cmp_gt_u32 vcc, 4, v250
  s_cbranch_vccnz per_A_x22s
per_A_x22r:
  ds_read_b128 v[4:7], v208 offset:40960
  v_mfma_f32_16x16x32_bf16 v[124:127], v[80:83], v[8:11], v[124:127]
  buffer_load_dwordx4 v[224:227], v0, s[8:11], s29 offen offset:1024
  s_add_u32 m0, s18, 45056
  s_add_u32 s30, s35, 4096
  buffer_load_dwordx4 v0, s[8:11], s30 offen offset:1024 sc1 lds
  v_mfma_f32_16x16x32_bf16 v[96:99], v[76:79], v[12:15], v[96:99]
  ds_read_b128 v[8:11], v211 offset:41984
  v_mfma_f32_16x16x32_bf16 v[128:131], v[80:83], v[12:15], v[128:131]
  s_add_u32 s28, s33, 110592
  buffer_load_dwordx4 v[228:231], v0, s[8:11], s28 offen offset:0
  v_mfma_f32_16x16x32_bf16 v[156:159], v[84:87], v[12:15], v[156:159]
  v_mfma_f32_16x16x32_bf16 v[100:103], v[76:79], v[16:19], v[100:103]
  ds_read_b128 v[12:15], v208 offset:43008
  v_mfma_f32_16x16x32_bf16 v[132:135], v[80:83], v[16:19], v[132:135]
  v_mfma_f32_16x16x32_bf16 v[104:107], v[76:79], v[20:23], v[104:107]
  ds_read_b128 v[16:19], v211 offset:44032
  v_mfma_f32_16x16x32_bf16 v[136:139], v[80:83], v[20:23], v[136:139]
  v_mfma_f32_16x16x32_bf16 v[160:163], v[84:87], v[20:23], v[160:163]
  s_add_u32 m0, s18, 45056
  s_add_u32 s30, s35, 4096
  buffer_load_dwordx4 v0, s[8:11], s30 offen offset:2048 sc1 lds
  v_mfma_f32_16x16x32_bf16 v[108:111], v[76:79], v[24:27], v[108:111]
  ds_read_b128 v[20:23], v208 offset:49152
  v_mfma_f32_16x16x32_bf16 v[140:143], v[80:83], v[24:27], v[140:143]
  v_mfma_f32_16x16x32_bf16 v[112:115], v[76:79], v[168:171], v[112:115]
  ds_read_b128 v[24:27], v211 offset:50176
  v_mfma_f32_16x16x32_bf16 v[144:147], v[80:83], v[168:171], v[144:147]
  v_mfma_f32_16x16x32_bf16 v[164:167], v[84:87], v[168:171], v[164:167]
  v_mfma_f32_16x16x32_bf16 v[116:119], v[76:79], v[172:175], v[116:119]
  ds_read_b128 v[168:171], v208 offset:51200
  v_mfma_f32_16x16x32_bf16 v[148:151], v[80:83], v[172:175], v[148:151]
  s_add_u32 m0, s18, 45056
  s_add_u32 s30, s35, 4096
  buffer_load_dwordx4 v0, s[8:11], s30 offen offset:3072 sc1 lds
  s_waitcnt lgkmcnt(6)
  v_mfma_f32_16x16x32_bf16 v[88:91], v[176:179], v[4:7], v[88:91]
  ds_read_b128 v[172:175], v211 offset:52224
  v_mfma_f32_16x16x32_bf16 v[120:123], v[180:183], v[4:7], v[120:123]
  s_add_u32 s29, s22, 147456
  buffer_load_dwordx4 v[232:235], v0, s[8:11], s29 offen offset:0
  v_mfma_f32_16x16x32_bf16 v[152:155], v[184:187], v[4:7], v[152:155]
  s_waitcnt lgkmcnt(6)
  v_mfma_f32_16x16x32_bf16 v[92:95], v[176:179], v[8:11], v[92:95]
  ds_read_b128 v[4:7], v208 offset:57344
  v_mfma_f32_16x16x32_bf16 v[124:127], v[180:183], v[8:11], v[124:127]
  buffer_load_dwordx4 v[236:239], v0, s[8:11], s29 offen offset:1024
  s_waitcnt lgkmcnt(6)
  v_mfma_f32_16x16x32_bf16 v[96:99], v[176:179], v[12:15], v[96:99]
  ds_read_b128 v[8:11], v211 offset:58368
  v_mfma_f32_16x16x32_bf16 v[128:131], v[180:183], v[12:15], v[128:131]
  s_add_u32 s28, s23, 147456
  buffer_load_dwordx4 v[240:243], v0, s[8:11], s28 offen offset:0
  v_mfma_f32_16x16x32_bf16 v[156:159], v[184:187], v[12:15], v[156:159]
  s_add_u32 m0, s25, 73728
  s_nop 0
  buffer_load_dwordx4 v0, s[8:11], s37 offen offset:0 sc1 lds
  s_waitcnt lgkmcnt(6)
  v_mfma_f32_16x16x32_bf16 v[100:103], v[176:179], v[16:19], v[100:103]
  ds_read_b128 v[12:15], v208 offset:59392
  v_mfma_f32_16x16x32_bf16 v[132:135], v[180:183], v[16:19], v[132:135]
  s_waitcnt lgkmcnt(6)
  v_mfma_f32_16x16x32_bf16 v[88:91], v[188:191], v[20:23], v[88:91]
  ds_read_b128 v[16:19], v211 offset:60416
  v_mfma_f32_16x16x32_bf16 v[120:123], v[192:195], v[20:23], v[120:123]
  s_add_u32 s29, s22, 184320
  buffer_load_dwordx4 v[244:247], v0, s[8:11], s29 offen offset:0
  v_mfma_f32_16x16x32_bf16 v[152:155], v[196:199], v[20:23], v[152:155]
  s_waitcnt lgkmcnt(6)
  v_mfma_f32_16x16x32_bf16 v[92:95], v[188:191], v[24:27], v[92:95]
  ds_read_b128 v[20:23], v209 offset:0
  v_mfma_f32_16x16x32_bf16 v[124:127], v[192:195], v[24:27], v[124:127]
  buffer_load_dwordx4 v[36:39], v0, s[8:11], s29 offen offset:1024
  s_add_u32 m0, s25, 73728
  s_nop 0
  buffer_load_dwordx4 v0, s[8:11], s37 offen offset:1024 sc1 lds
  s_waitcnt lgkmcnt(6)
  v_mfma_f32_16x16x32_bf16 v[96:99], v[188:191], v[168:171], v[96:99]
  ds_read_b128 v[24:27], v212 offset:1024
  v_mfma_f32_16x16x32_bf16 v[128:131], v[192:195], v[168:171], v[128:131]
  s_add_u32 s28, s23, 184320
  buffer_load_dwordx4 v[28:31], v0, s[8:11], s28 offen offset:0
  v_mfma_f32_16x16x32_bf16 v[156:159], v[196:199], v[168:171], v[156:159]
  s_waitcnt lgkmcnt(6)
  v_mfma_f32_16x16x32_bf16 v[100:103], v[188:191], v[172:175], v[100:103]
  ds_read_b128 v[168:171], v209 offset:2048
  v_mfma_f32_16x16x32_bf16 v[132:135], v[192:195], v[172:175], v[132:135]
  s_waitcnt vmcnt(15) lgkmcnt(6)
  v_mfma_f32_16x16x32_bf16 v[88:91], v[200:203], v[4:7], v[88:91]
  ds_read_b128 v[172:175], v212 offset:3072
  ds_read_b32 v250, v254 offset:1024
  v_mfma_f32_16x16x32_bf16 v[120:123], v[204:207], v[4:7], v[120:123]
  s_add_u32 s29, s22, 221184
  buffer_load_dwordx4 v[32:35], v0, s[8:11], s29 offen offset:0
  v_mfma_f32_16x16x32_bf16 v[152:155], v[216:219], v[4:7], v[152:155]
  s_waitcnt lgkmcnt(7)
  v_mfma_f32_16x16x32_bf16 v[92:95], v[200:203], v[8:11], v[92:95]
  s_waitcnt lgkmcnt(0)
  v_cmp_gt_u32 vcc, 22, v250
  s_cbranch_vccnz per_A_x23s
per_A_x23r:
  ds_read_b128 v[4:7], v209 offset:16384
  v_mfma_f32_16x16x32_bf16 v[124:127], v[204:207], v[8:11], v[124:127]
  buffer_load_dwordx4 v[48:51], v0, s[8:11], s29 offen offset:1024
  v_mfma_f32_16x16x32_bf16 v[96:99], v[200:203], v[12:15], v[96:99]
  ds_read_b128 v[8:11], v212 offset:17408
  v_mfma_f32_16x16x32_bf16 v[128:131], v[204:207], v[12:15], v[128:131]
  s_add_u32 s28, s23, 221184
  buffer_load_dwordx4 v[40:43], v0, s[8:11], s28 offen offset:0
  v_mfma_f32_16x16x32_bf16 v[156:159], v[216:219], v[12:15], v[156:159]
  v_mfma_f32_16x16x32_bf16 v[100:103], v[200:203], v[16:19], v[100:103]
  ds_read_b128 v[12:15], v209 offset:18432
  v_mfma_f32_16x16x32_bf16 v[132:135], v[204:207], v[16:19], v[132:135]
  s_waitcnt vmcnt(13)
  v_mfma_f32_16x16x32_bf16 v[88:91], v[220:223], v[20:23], v[88:91]
  ds_read_b128 v[16:19], v212 offset:19456
  v_mfma_f32_16x16x32_bf16 v[120:123], v[224:227], v[20:23], v[120:123]
  s_add_u32 s29, s22, 258048
  buffer_load_dwordx4 v[44:47], v0, s[8:11], s29 offen offset:0
  v_mfma_f32_16x16x32_bf16 v[152:155], v[228:231], v[20:23], v[152:155]
  v_mfma_f32_16x16x32_bf16 v[92:95], v[220:223], v[24:27], v[92:95]
  ds_read_b128 v[20:23], v209 offset:24576
  v_mfma_f32_16x16x32_bf16 v[124:127], v[224:227], v[24:27], v[124:127]
  buffer_load_dwordx4 v[60:63], v0, s[8:11], s29 offen offset:1024
  v_mfma_f32_16x16x32_bf16 v[96:99], v[220:223], v[168:171], v[96:99]
  ds_read_b128 v[24:27], v212 offset:25600
  v_mfma_f32_16x16x32_bf16 v[128:131], v[224:227], v[168:171], v[128:131]
  s_add_u32 s28, s23, 258048
  buffer_load_dwordx4 v[52:55], v0, s[8:11], s28 offen offset:0
  v_mfma_f32_16x16x32_bf16 v[156:159], v[228:231], v[168:171], v[156:159]
  v_mfma_f32_16x16x32_bf16 v[100:103], v[220:223], v[172:175], v[100:103]
  ds_read_b128 v[168:171], v209 offset:26624
  v_mfma_f32_16x16x32_bf16 v[132:135], v[224:227], v[172:175], v[132:135]
  s_waitcnt vmcnt(7)
  v_mov_b32 v248, 5
  ds_write_b32 v251, v248
  s_waitcnt lgkmcnt(7)
  v_mfma_f32_16x16x32_bf16 v[88:91], v[232:235], v[4:7], v[88:91]
  ds_read_b128 v[172:175], v212 offset:27648
  v_mfma_f32_16x16x32_bf16 v[120:123], v[236:239], v[4:7], v[120:123]
  s_add_u32 s29, s32, 294912
  buffer_load_dwordx4 v[56:59], v0, s[8:11], s29 offen offset:0
  v_mfma_f32_16x16x32_bf16 v[152:155], v[240:243], v[4:7], v[152:155]
  s_waitcnt lgkmcnt(7)
  v_mfma_f32_16x16x32_bf16 v[92:95], v[232:235], v[8:11], v[92:95]
  ds_read_b128 v[4:7], v209 offset:32768
  v_mfma_f32_16x16x32_bf16 v[124:127], v[236:239], v[8:11], v[124:127]
  buffer_load_dwordx4 v[72:75], v0, s[8:11], s29 offen offset:1024
  s_waitcnt lgkmcnt(7)
  v_mfma_f32_16x16x32_bf16 v[96:99], v[232:235], v[12:15], v[96:99]
  ds_read_b128 v[8:11], v212 offset:33792
  v_mfma_f32_16x16x32_bf16 v[128:131], v[236:239], v[12:15], v[128:131]
  s_add_u32 s28, s33, 294912
  buffer_load_dwordx4 v[64:67], v0, s[8:11], s28 offen offset:0
  v_mfma_f32_16x16x32_bf16 v[156:159], v[240:243], v[12:15], v[156:159]
  s_waitcnt lgkmcnt(7)
  v_mfma_f32_16x16x32_bf16 v[100:103], v[232:235], v[16:19], v[100:103]
  ds_read_b128 v[12:15], v209 offset:34816
  v_mfma_f32_16x16x32_bf16 v[132:135], v[236:239], v[16:19], v[132:135]
  v_mov_b32 v248, 0
  buffer_load_dword v249, v248, s[8:11], s39 offen offset:128 sc1
  s_waitcnt vmcnt(10) lgkmcnt(7)
  v_mfma_f32_16x16x32_bf16 v[88:91], v[244:247], v[20:23], v[88:91]
  ds_read_b128 v[16:19], v212 offset:35840
  v_mfma_f32_16x16x32_bf16 v[120:123], v[36:39], v[20:23], v[120:123]
  s_add_u32 s29, s32, 147456
  buffer_load_dwordx4 v[68:71], v0, s[8:11], s29 offen offset:0
  v_mfma_f32_16x16x32_bf16 v[152:155], v[28:31], v[20:23], v[152:155]
  s_waitcnt lgkmcnt(7)
  v_mfma_f32_16x16x32_bf16 v[92:95], v[244:247], v[24:27], v[92:95]
  ds_read_b128 v[20:23], v209 offset:40960
  v_mfma_f32_16x16x32_bf16 v[124:127], v[36:39], v[24:27], v[124:127]
  buffer_load_dwordx4 v[84:87], v0, s[8:11], s29 offen offset:1024
  s_waitcnt lgkmcnt(7)
  v_mfma_f32_16x16x32_bf16 v[96:99], v[244:247], v[168:171], v[96:99]
  ds_read_b128 v[24:27], v212 offset:41984
  v_mfma_f32_16x16x32_bf16 v[128:131], v[36:39], v[168:171], v[128:131]
  s_add_u32 s28, s33, 147456
  buffer_load_dwordx4 v[76:79], v0, s[8:11], s28 offen offset:0
  v_mfma_f32_16x16x32_bf16 v[156:159], v[28:31], v[168:171], v[156:159]
  s_waitcnt lgkmcnt(6)
  v_mfma_f32_16x16x32_bf16 v[100:103], v[244:247], v[172:175], v[100:103]
  ds_read_b128 v[168:171], v209 offset:43008
  v_mfma_f32_16x16x32_bf16 v[132:135], v[36:39], v[172:175], v[132:135]
  s_waitcnt vmcnt(10) lgkmcnt(6)
  v_mfma_f32_16x16x32_bf16 v[88:91], v[32:35], v[4:7], v[88:91]
  ds_read_b128 v[172:175], v212 offset:44032
  ds_read_b32 v250, v254 offset:0
  v_mfma_f32_16x16x32_bf16 v[120:123], v[48:51], v[4:7], v[120:123]
  s_add_u32 s29, s32, 184320
  buffer_load_dwordx4 v[80:83], v0, s[8:11], s29 offen offset:0
  v_mfma_f32_16x16x32_bf16 v[152:155], v[40:43], v[4:7], v[152:155]
  s_waitcnt lgkmcnt(7)
  v_mfma_f32_16x16x32_bf16 v[92:95], v[32:35], v[8:11], v[92:95]
  s_waitcnt lgkmcnt(0)
  v_cmp_gt_u32 vcc, 5, v250
  s_cbranch_vccnz per_A_x24s
per_A_x24r:
  ds_read_b128 v[4:7], v208 offset:45056
  v_mfma_f32_16x16x32_bf16 v[124:127], v[48:51], v[8:11], v[124:127]
  s_waitcnt vmcnt(4)
  v_cmp_ne_u32 vcc, s96, v249
  s_cbranch_vccnz per_A_poll2s
per_A_poll2r:
  s_add_u32 m0, s18, 114688
  s_add_u32 s30, s35, 40960
  buffer_load_dwordx4 v0, s[8:11], s30 offen offset:0 sc1 lds
  v_mfma_f32_16x16x32_bf16 v[96:99], v[32:35], v[12:15], v[96:99]
  ds_read_b128 v[8:11], v211 offset:46080
  v_mfma_f32_16x16x32_bf16 v[128:131], v[48:51], v[12:15], v[128:131]
  v_mfma_f32_16x16x32_bf16 v[156:159], v[40:43], v[12:15], v[156:159]
  s_add_u32 m0, s18, 114688
  s_add_u32 s30, s35, 40960
  buffer_load_dwordx4 v0, s[8:11], s30 offen offset:1024 sc1 lds
  v_mfma_f32_16x16x32_bf16 v[100:103], v[32:35], v[16:19], v[100:103]
  ds_read_b128 v[12:15], v208 offset:47104
  v_mfma_f32_16x16x32_bf16 v[132:135], v[48:51], v[16:19], v[132:135]
  v_mfma_f32_16x16x32_bf16 v[88:91], v[44:47], v[20:23], v[88:91]
  ds_read_b128 v[16:19], v211 offset:48128
  v_mfma_f32_16x16x32_bf16 v[120:123], v[60:63], v[20:23], v[120:123]
  v_mfma_f32_16x16x32_bf16 v[152:155], v[52:55], v[20:23], v[152:155]
  v_mfma_f32_16x16x32_bf16 v[92:95], v[44:47], v[24:27], v[92:95]
  ds_read_b128 v[20:23], v208 offset:53248
  v_mfma_f32_16x16x32_bf16 v[124:127], v[60:63], v[24:27], v[124:127]
  s_add_u32 m0, s18, 114688
  s_add_u32 s30, s35, 40960
  buffer_load_dwordx4 v0, s[8:11], s30 offen offset:2048 sc1 lds
  v_mfma_f32_16x16x32_bf16 v[96:99], v[44:47], v[168:171], v[96:99]
  ds_read_b128 v[24:27], v211 offset:54272
  v_mfma_f32_16x16x32_bf16 v[128:131], v[60:63], v[168:171], v[128:131]
  v_mfma_f32_16x16x32_bf16 v[156:159], v[52:55], v[168:171], v[156:159]
  v_mfma_f32_16x16x32_bf16 v[100:103], v[44:47], v[172:175], v[100:103]
  ds_read_b128 v[168:171], v208 offset:55296
  v_mfma_f32_16x16x32_bf16 v[132:135], v[60:63], v[172:175], v[132:135]
  s_waitcnt lgkmcnt(6)
  v_mfma_f32_16x16x32_bf16 v[104:107], v[176:179], v[4:7], v[104:107]
  ds_read_b128 v[172:175], v211 offset:56320
  v_mfma_f32_16x16x32_bf16 v[136:139], v[180:183], v[4:7], v[136:139]
  v_mfma_f32_16x16x32_bf16 v[160:163], v[184:187], v[4:7], v[160:163]
  s_add_u32 m0, s18, 114688
  s_add_u32 s30, s35, 40960
  buffer_load_dwordx4 v0, s[8:11], s30 offen offset:3072 sc1 lds
  s_waitcnt lgkmcnt(6)
  v_mfma_f32_16x16x32_bf16 v[108:111], v[176:179], v[8:11], v[108:111]
  ds_read_b128 v[4:7], v208 offset:61440
  v_mfma_f32_16x16x32_bf16 v[140:143], v[180:183], v[8:11], v[140:143]
  s_waitcnt lgkmcnt(6)
  v_mfma_f32_16x16x32_bf16 v[112:115], v[176:179], v[12:15], v[112:115]
  ds_read_b128 v[8:11], v211 offset:62464
  v_mfma_f32_16x16x32_bf16 v[144:147], v[180:183], v[12:15], v[144:147]
  v_mfma_f32_16x16x32_bf16 v[164:167], v[184:187], v[12:15], v[164:167]
  buffer_load_dwordx4 v[184:187], v0, s[8:11], s29 offen offset:1024
  s_waitcnt lgkmcnt(6)
  v_mfma_f32_16x16x32_bf16 v[116:119], v[176:179], v[16:19], v[116:119]
  ds_read_b128 v[12:15], v208 offset:63488
  v_mfma_f32_16x16x32_bf16 v[148:151], v[180:183], v[16:19], v[148:151]
  s_add_u32 s28, s33, 184320
  buffer_load_dwordx4 v[176:179], v0, s[8:11], s28 offen offset:0
  s_waitcnt lgkmcnt(6)
  v_mfma_f32_16x16x32_bf16 v[104:107], v[188:191], v[20:23], v[104:107]
  ds_read_b128 v[16:19], v211 offset:64512
  v_mfma_f32_16x16x32_bf16 v[136:139], v[192:195], v[20:23], v[136:139]
  s_add_u32 s29, s32, 221184
  buffer_load_dwordx4 v[180:183], v0, s[8:11], s29 offen offset:0
  v_mfma_f32_16x16x32_bf16 v[160:163], v[196:199], v[20:23], v[160:163]
  s_waitcnt lgkmcnt(6)
  v_mfma_f32_16x16x32_bf16 v[108:111], v[188:191], v[24:27], v[108:111]
  ds_read_b128 v[20:23], v209 offset:4096
  v_mfma_f32_16x16x32_bf16 v[140:143], v[192:195], v[24:27], v[140:143]
  s_waitcnt lgkmcnt(6)
  v_mfma_f32_16x16x32_bf16 v[112:115], v[188:191], v[168:171], v[112:115]
  ds_read_b128 v[24:27], v212 offset:5120
  v_mfma_f32_16x16x32_bf16 v[144:147], v[192:195], v[168:171], v[144:147]
  v_mfma_f32_16x16x32_bf16 v[164:167], v[196:199], v[168:171], v[164:167]
  buffer_load_dwordx4 v[196:199], v0, s[8:11], s29 offen offset:1024
  s_waitcnt lgkmcnt(6)
  v_mfma_f32_16x16x32_bf16 v[116:119], v[188:191], v[172:175], v[116:119]
  ds_read_b128 v[168:171], v209 offset:6144
  v_mfma_f32_16x16x32_bf16 v[148:151], v[192:195], v[172:175], v[148:151]
  s_add_u32 s28, s33, 221184
  buffer_load_dwordx4 v[188:191], v0, s[8:11], s28 offen offset:0
  s_waitcnt lgkmcnt(6)
  v_mfma_f32_16x16x32_bf16 v[104:107], v[200:203], v[4:7], v[104:107]
  ds_read_b128 v[172:175], v212 offset:7168
  v_mfma_f32_16x16x32_bf16 v[136:139], v[204:207], v[4:7], v[136:139]
  v_mfma_f32_16x16x32_bf16 v[160:163], v[216:219], v[4:7], v[160:163]
  s_waitcnt lgkmcnt(6)
  v_mfma_f32_16x16x32_bf16 v[108:111], v[200:203], v[8:11], v[108:111]
  ds_read_b128 v[4:7], v209 offset:8192
  v_mfma_f32_16x16x32_bf16 v[140:143], v[204:207], v[8:11], v[140:143]
  s_waitcnt lgkmcnt(6)
  v_mfma_f32_16x16x32_bf16 v[112:115], v[200:203], v[12:15], v[112:115]
  ds_read_b128 v[8:11], v212 offset:9216
  v_mfma_f32_16x16x32_bf16 v[144:147], v[204:207], v[12:15], v[144:147]
  v_mfma_f32_16x16x32_bf16 v[164:167], v[216:219], v[12:15], v[164:167]
  s_waitcnt lgkmcnt(6)
  v_mfma_f32_16x16x32_bf16 v[116:119], v[200:203], v[16:19], v[116:119]
  ds_read_b128 v[12:15], v209 offset:10240
  v_mfma_f32_16x16x32_bf16 v[148:151], v[204:207], v[16:19], v[148:151]
  s_waitcnt lgkmcnt(6)
  v_mfma_f32_16x16x32_bf16 v[104:107], v[220:223], v[20:23], v[104:107]
  ds_read_b128 v[16:19], v212 offset:11264
  v_mfma_f32_16x16x32_bf16 v[136:139], v[224:227], v[20:23], v[136:139]
  v_mfma_f32_16x16x32_bf16 v[160:163], v[228:231], v[20:23], v[160:163]
  s_waitcnt lgkmcnt(6)
  v_mfma_f32_16x16x32_bf16 v[108:111], v[220:223], v[24:27], v[108:111]
  ds_read_b128 v[20:23], v209 offset:12288
  v_mfma_f32_16x16x32_bf16 v[140:143], v[224:227], v[24:27], v[140:143]
  s_waitcnt lgkmcnt(6)
  v_mfma_f32_16x16x32_bf16 v[112:115], v[220:223], v[168:171], v[112:115]
  ds_read_b128 v[24:27], v212 offset:13312
  v_mfma_f32_16x16x32_bf16 v[144:147], v[224:227], v[168:171], v[144:147]
  v_mfma_f32_16x16x32_bf16 v[164:167], v[228:231], v[168:171], v[164:167]
  s_waitcnt lgkmcnt(6)
  v_mfma_f32_16x16x32_bf16 v[116:119], v[220:223], v[172:175], v[116:119]
  ds_read_b128 v[168:171], v209 offset:14336
  v_mfma_f32_16x16x32_bf16 v[148:151], v[224:227], v[172:175], v[148:151]
  s_waitcnt lgkmcnt(6)
  v_mfma_f32_16x16x32_bf16 v[88:91], v[56:59], v[4:7], v[88:91]
  ds_read_b128 v[172:175], v212 offset:15360
  ds_read_b32 v250, v254 offset:1024
  v_mfma_f32_16x16x32_bf16 v[120:123], v[72:75], v[4:7], v[120:123]
  s_add_u32 s29, s32, 258048
  buffer_load_dwordx4 v[192:195], v0, s[8:11], s29 offen offset:0
  v_mfma_f32_16x16x32_bf16 v[152:155], v[64:67], v[4:7], v[152:155]
  s_waitcnt lgkmcnt(7)
  v_mfma_f32_16x16x32_bf16 v[92:95], v[56:59], v[8:11], v[92:95]
  s_waitcnt lgkmcnt(0)
  v_cmp_gt_u32 vcc, 23, v250
  s_cbranch_vccnz per_A_x25s
per_A_x25r:
  ds_read_b128 v[4:7], v209 offset:20480
  v_mfma_f32_16x16x32_bf16 v[124:127], v[72:75], v[8:11], v[124:127]
  buffer_load_dwordx4 v[216:219], v0, s[8:11], s29 offen offset:1024
  v_mfma_f32_16x16x32_bf16 v[96:99], v[56:59], v[12:15], v[96:99]
  ds_read_b128 v[8:11], v212 offset:21504
  v_mfma_f32_16x16x32_bf16 v[128:131], v[72:75], v[12:15], v[128:131]
  s_add_u32 s28, s33, 258048
  buffer_load_dwordx4 v[200:203], v0, s[8:11], s28 offen offset:0
  v_mfma_f32_16x16x32_bf16 v[156:159], v[64:67], v[12:15], v[156:159]
  v_mfma_f32_16x16x32_bf16 v[100:103], v[56:59], v[16:19], v[100:103]
  ds_read_b128 v[12:15], v209 offset:22528
  v_mfma_f32_16x16x32_bf16 v[132:135], v[72:75], v[16:19], v[132:135]
  s_waitcnt vmcnt(8)
  v_mov_b32 v248, 6
  ds_write_b32 v251, v248
  v_mfma_f32_16x16x32_bf16 v[104:107], v[56:59], v[20:23], v[104:107]
  ds_read_b128 v[16:19], v212 offset:23552
  v_mfma_f32_16x16x32_bf16 v[136:139], v[72:75], v[20:23], v[136:139]
  v_mfma_f32_16x16x32_bf16 v[160:163], v[64:67], v[20:23], v[160:163]
  v_mfma_f32_16x16x32_bf16 v[108:111], v[56:59], v[24:27], v[108:111]
  ds_read_b128 v[20:23], v209 offset:28672
  v_mfma_f32_16x16x32_bf16 v[140:143], v[72:75], v[24:27], v[140:143]
  v_mfma_f32_16x16x32_bf16 v[112:115], v[56:59], v[168:171], v[112:115]
  ds_read_b128 v[24:27], v212 offset:29696
  v_mfma_f32_16x16x32_bf16 v[144:147], v[72:75], v[168:171], v[144:147]
  v_mfma_f32_16x16x32_bf16 v[164:167], v[64:67], v[168:171], v[164:167]
  v_mfma_f32_16x16x32_bf16 v[116:119], v[56:59], v[172:175], v[116:119]
  ds_read_b128 v[168:171], v209 offset:30720
  v_mfma_f32_16x16x32_bf16 v[148:151], v[72:75], v[172:175], v[148:151]
  s_waitcnt lgkmcnt(7)
  v_mfma_f32_16x16x32_bf16 v[104:107], v[232:235], v[4:7], v[104:107]
  ds_read_b128 v[172:175], v212 offset:31744
  v_mfma_f32_16x16x32_bf16 v[136:139], v[236:239], v[4:7], v[136:139]
  v_mfma_f32_16x16x32_bf16 v[160:163], v[240:243], v[4:7], v[160:163]
  s_waitcnt lgkmcnt(7)
  v_mfma_f32_16x16x32_bf16 v[108:111], v[232:235], v[8:11], v[108:111]
  ds_read_b128 v[4:7], v209 offset:36864
  v_mfma_f32_16x16x32_bf16 v[140:143], v[236:239], v[8:11], v[140:143]
  s_waitcnt lgkmcnt(7)
  v_mfma_f32_16x16x32_bf16 v[112:115], v[232:235], v[12:15], v[112:115]
  ds_read_b128 v[8:11], v212 offset:37888
  v_mfma_f32_16x16x32_bf16 v[144:147], v[236:239], v[12:15], v[144:147]
  v_mfma_f32_16x16x32_bf16 v[164:167], v[240:243], v[12:15], v[164:167]
  s_waitcnt lgkmcnt(6)
  v_mfma_f32_16x16x32_bf16 v[116:119], v[232:235], v[16:19], v[116:119]
  ds_read_b128 v[12:15], v209 offset:38912
  v_mfma_f32_16x16x32_bf16 v[148:151], v[236:239], v[16:19], v[148:151]
  s_waitcnt lgkmcnt(6)
  v_mfma_f32_16x16x32_bf16 v[104:107], v[244:247], v[20:23], v[104:107]
  ds_read_b128 v[16:19], v212 offset:39936
  v_mfma_f32_16x16x32_bf16 v[136:139], v[36:39], v[20:23], v[136:139]
  v_mfma_f32_16x16x32_bf16 v[160:163], v[28:31], v[20:23], v[160:163]
  s_waitcnt lgkmcnt(6)
  v_mfma_f32_16x16x32_bf16 v[108:111], v[244:247], v[24:27], v[108:111]
  ds_read_b128 v[20:23], v209 offset:45056
  v_mfma_f32_16x16x32_bf16 v[140:143], v[36:39], v[24:27], v[140:143]
  s_waitcnt lgkmcnt(6)
  v_mfma_f32_16x16x32_bf16 v[112:115], v[244:247], v[168:171], v[112:115]
  ds_read_b128 v[24:27], v212 offset:46080
  v_mfma_f32_16x16x32_bf16 v[144:147], v[36:39], v[168:171], v[144:147]
  v_mfma_f32_16x16x32_bf16 v[164:167], v[28:31], v[168:171], v[164:167]
  s_waitcnt lgkmcnt(6)
  v_mfma_f32_16x16x32_bf16 v[116:119], v[244:247], v[172:175], v[116:119]
  ds_read_b128 v[168:171], v209 offset:47104
  v_mfma_f32_16x16x32_bf16 v[148:151], v[36:39], v[172:175], v[148:151]
  s_waitcnt lgkmcnt(6)
  v_mfma_f32_16x16x32_bf16 v[104:107], v[32:35], v[4:7], v[104:107]
  ds_read_b128 v[172:175], v212 offset:48128
  ds_read_b32 v250, v254 offset:0
  v_mfma_f32_16x16x32_bf16 v[136:139], v[48:51], v[4:7], v[136:139]
  v_mfma_f32_16x16x32_bf16 v[160:163], v[40:43], v[4:7], v[160:163]
  s_waitcnt lgkmcnt(7)
  v_mfma_f32_16x16x32_bf16 v[108:111], v[32:35], v[8:11], v[108:111]
  s_waitcnt lgkmcnt(0)
  v_cmp_gt_u32 vcc, 6, v250
  s_cbranch_vccnz per_A_x26s
per_A_x26r:
  ds_read_b128 v[4:7], v209 offset:49152
  v_mfma_f32_16x16x32_bf16 v[140:143], v[48:51], v[8:11], v[140:143]
  v_mov_b32 v248, 0
  buffer_load_dword v249, v248, s[8:11], s39 offen offset:132 sc1
  v_mfma_f32_16x16x32_bf16 v[112:115], v[32:35], v[12:15], v[112:115]
  ds_read_b128 v[8:11], v209 offset:57344
  v_mfma_f32_16x16x32_bf16 v[144:147], v[48:51], v[12:15], v[144:147]
  v_mfma_f32_16x16x32_bf16 v[164:167], v[40:43], v[12:15], v[164:167]
  v_mfma_f32_16x16x32_bf16 v[116:119], v[32:35], v[16:19], v[116:119]
  ds_read_b128 v[12:15], v210 offset:0
  v_mfma_f32_16x16x32_bf16 v[148:151], v[48:51], v[16:19], v[148:151]
  v_mfma_f32_16x16x32_bf16 v[104:107], v[44:47], v[20:23], v[104:107]
  ds_read_b128 v[16:19], v210 offset:8192
  v_mfma_f32_16x16x32_bf16 v[136:139], v[60:63], v[20:23], v[136:139]
  v_mfma_f32_16x16x32_bf16 v[160:163], v[52:55], v[20:23], v[160:163]
  v_mfma_f32_16x16x32_bf16 v[108:111], v[44:47], v[24:27], v[108:111]
  ds_read_b128 v[20:23], v212 offset:50176
  v_mfma_f32_16x16x32_bf16 v[140:143], v[60:63], v[24:27], v[140:143]
  v_mfma_f32_16x16x32_bf16 v[112:115], v[44:47], v[168:171], v[112:115]
  ds_read_b128 v[24:27], v212 offset:58368
  v_mfma_f32_16x16x32_bf16 v[144:147], v[60:63], v[168:171], v[144:147]
  v_mfma_f32_16x16x32_bf16 v[164:167], v[52:55], v[168:171], v[164:167]
  v_mfma_f32_16x16x32_bf16 v[116:119], v[44:47], v[172:175], v[116:119]
  ds_read_b128 v[168:171], v213 offset:1024
  v_mfma_f32_16x16x32_bf16 v[148:151], v[60:63], v[172:175], v[148:151]
  s_waitcnt vmcnt(0)
  v_cmp_ne_u32 vcc, s96, v249
  s_cbranch_vccnz per_A_poll3s
per_A_poll3r:
  s_add_u32 m0, s18, 118784
  s_add_u32 s30, s35, 45056
  buffer_load_dwordx4 v0, s[8:11], s30 offen offset:0 sc1 lds
  s_add_u32 m0, s18, 118784
  s_add_u32 s30, s35, 45056
  buffer_load_dwordx4 v0, s[8:11], s30 offen offset:1024 sc1 lds
  s_add_u32 m0, s18, 118784
  s_add_u32 s30, s35, 45056
  buffer_load_dwordx4 v0, s[8:11], s30 offen offset:2048 sc1 lds
  s_add_u32 m0, s18, 118784
  s_add_u32 s30, s35, 45056
  buffer_load_dwordx4 v0, s[8:11], s30 offen offset:3072 sc1 lds
  s_waitcnt lgkmcnt(6)
  v_mfma_f32_16x16x32_bf16 v[88:91], v[68:71], v[4:7], v[88:91]
  ds_read_b128 v[172:175], v213 offset:9216
  v_mfma_f32_16x16x32_bf16 v[120:123], v[84:87], v[4:7], v[120:123]
  v_mfma_f32_16x16x32_bf16 v[152:155], v[76:79], v[4:7], v[152:155]
  s_waitcnt lgkmcnt(6)
  v_mfma_f32_16x16x32_bf16 v[88:91], v[80:83], v[8:11], v[88:91]
  ds_read_b128 v[4:7], v209 offset:51200
  v_mfma_f32_16x16x32_bf16 v[120:123], v[184:187], v[8:11], v[120:123]
  v_mfma_f32_16x16x32_bf16 v[152:155], v[176:179], v[8:11], v[152:155]
  s_waitcnt lgkmcnt(6)
  v_mfma_f32_16x16x32_bf16 v[88:91], v[180:183], v[12:15], v[88:91]
  ds_read_b128 v[8:11], v209 offset:59392
  v_mfma_f32_16x16x32_bf16 v[120:123], v[196:199], v[12:15], v[120:123]
  v_mfma_f32_16x16x32_bf16 v[152:155], v[188:191], v[12:15], v[152:155]
  s_waitcnt lgkmcnt(6)
  v_mfma_f32_16x16x32_bf16 v[88:91], v[192:195], v[16:19], v[88:91]
  ds_read_b128 v[12:15], v210 offset:2048
  v_mfma_f32_16x16x32_bf16 v[120:123], v[216:219], v[16:19], v[120:123]
  v_mfma_f32_16x16x32_bf16 v[152:155], v[200:203], v[16:19], v[152:155]
  s_waitcnt lgkmcnt(6)
  v_mfma_f32_16x16x32_bf16 v[92:95], v[68:71], v[20:23], v[92:95]
  ds_read_b128 v[16:19], v210 offset:10240
  v_mfma_f32_16x16x32_bf16 v[124:127], v[84:87], v[20:23], v[124:127]
  s_waitcnt lgkmcnt(6)
  v_mfma_f32_16x16x32_bf16 v[92:95], v[80:83], v[24:27], v[92:95]
  ds_read_b128 v[20:23], v212 offset:52224
  s_add_u32 s30, s26, 0
  v_cvt_pk_bf16_f32 v88, v88, v89
  v_cvt_pk_bf16_f32 v89, v90, v91
  v_cvt_pk_bf16_f32 v90, v120, v121
  v_cvt_pk_bf16_f32 v91, v122, v123
  buffer_store_dwordx4 v[88:91], v3, s[8:11], s30 offen sc1
  s_add_u32 s30, s27, 0
  v_cvt_pk_bf16_f32 v152, v152, v153
  v_cvt_pk_bf16_f32 v153, v154, v155
  buffer_store_dwordx2 v[152:153], v255, s[8:11], s30 offen sc1
  v_mfma_f32_16x16x32_bf16 v[124:127], v[184:187], v[24:27], v[124:127]
  s_waitcnt lgkmcnt(6)
  v_mfma_f32_16x16x32_bf16 v[92:95], v[180:183], v[168:171], v[92:95]
  ds_read_b128 v[24:27], v212 offset:60416
  v_mfma_f32_16x16x32_bf16 v[124:127], v[196:199], v[168:171], v[124:127]
  s_waitcnt lgkmcnt(6)
  v_mfma_f32_16x16x32_bf16 v[92:95], v[192:195], v[172:175], v[92:95]
  ds_read_b128 v[168:171], v213 offset:3072
  v_mfma_f32_16x16x32_bf16 v[124:127], v[216:219], v[172:175], v[124:127]
  s_waitcnt lgkmcnt(6)
  v_mfma_f32_16x16x32_bf16 v[96:99], v[68:71], v[4:7], v[96:99]
  ds_read_b128 v[172:175], v213 offset:11264
  v_mfma_f32_16x16x32_bf16 v[128:131], v[84:87], v[4:7], v[128:131]
  v_mfma_f32_16x16x32_bf16 v[156:159], v[76:79], v[4:7], v[156:159]
  s_add_u32 s30, s16, 18432
  v_cvt_pk_bf16_f32 v92, v92, v93
  v_cvt_pk_bf16_f32 v93, v94, v95
  v_cvt_pk_bf16_f32 v94, v124, v125
  v_cvt_pk_bf16_f32 v95, v126, v127
  buffer_store_dwordx4 v[92:95], v3, s[8:11], s30 offen sc1
  s_waitcnt lgkmcnt(6)
  v_mfma_f32_16x16x32_bf16 v[96:99], v[80:83], v[8:11], v[96:99]
  v_mfma_f32_16x16x32_bf16 v[128:131], v[184:187], v[8:11], v[128:131]
  v_mfma_f32_16x16x32_bf16 v[156:159], v[176:179], v[8:11], v[156:159]
  s_waitcnt lgkmcnt(5)
  v_mfma_f32_16x16x32_bf16 v[96:99], v[180:183], v[12:15], v[96:99]
  v_mfma_f32_16x16x32_bf16 v[128:131], v[196:199], v[12:15], v[128:131]
  v_mfma_f32_16x16x32_bf16 v[156:159], v[188:191], v[12:15], v[156:159]
  s_waitcnt lgkmcnt(4)
  v_mfma_f32_16x16x32_bf16 v[96:99], v[192:195], v[16:19], v[96:99]
  v_mfma_f32_16x16x32_bf16 v[128:131], v[216:219], v[16:19], v[128:131]
  v_mfma_f32_16x16x32_bf16 v[156:159], v[200:203], v[16:19], v[156:159]
  s_waitcnt vmcnt(3)
  v_mov_b32 v248, 7
  ds_write_b32 v251, v248
  s_waitcnt lgkmcnt(4)
  v_mfma_f32_16x16x32_bf16 v[100:103], v[68:71], v[20:23], v[100:103]
  ds_read_b32 v250, v254 offset:0
  s_waitcnt lgkmcnt(0)
  v_cmp_gt_u32 vcc, 7, v250
  s_cbranch_vccnz per_A_x27s
per_A_x27r:
  ds_read_b128 v[4:7], v209 offset:53248
  v_mfma_f32_16x16x32_bf16 v[132:135], v[84:87], v[20:23], v[132:135]
  ds_read_b128 v[8:11], v209 offset:61440
  v_mfma_f32_16x16x32_bf16 v[100:103], v[80:83], v[24:27], v[100:103]
  ds_read_b128 v[12:15], v210 offset:4096
  s_add_u32 s30, s26, 36864
  v_cvt_pk_bf16_f32 v96, v96, v97
  v_cvt_pk_bf16_f32 v97, v98, v99
  v_cvt_pk_bf16_f32 v98, v128, v129
  v_cvt_pk_bf16_f32 v99, v130, v131
  buffer_store_dwordx4 v[96:99], v3, s[8:11], s30 offen sc1
  s_add_u32 s30, s27, 36864
  v_cvt_pk_bf16_f32 v156, v156, v157
  v_cvt_pk_bf16_f32 v157, v158, v159
  buffer_store_dwordx2 v[156:157], v255, s[8:11], s30 offen sc1
  v_mfma_f32_16x16x32_bf16 v[132:135], v[184:187], v[24:27], v[132:135]
  ds_read_b128 v[16:19], v210 offset:12288
  v_mfma_f32_16x16x32_bf16 v[100:103], v[180:183], v[168:171], v[100:103]
  ds_read_b128 v[20:23], v212 offset:54272
  v_mfma_f32_16x16x32_bf16 v[132:135], v[196:199], v[168:171], v[132:135]
  ds_read_b128 v[24:27], v212 offset:62464
  v_mfma_f32_16x16x32_bf16 v[100:103], v[192:195], v[172:175], v[100:103]
  ds_read_b128 v[168:171], v213 offset:5120
  v_mfma_f32_16x16x32_bf16 v[132:135], v[216:219], v[172:175], v[132:135]
  s_waitcnt lgkmcnt(6)
  v_mfma_f32_16x16x32_bf16 v[104:107], v[68:71], v[4:7], v[104:107]
  ds_read_b128 v[172:175], v213 offset:13312
  v_mfma_f32_16x16x32_bf16 v[136:139], v[84:87], v[4:7], v[136:139]
  v_mfma_f32_16x16x32_bf16 v[160:163], v[76:79], v[4:7], v[160:163]
  s_add_u32 s30, s16, 55296
  v_cvt_pk_bf16_f32 v100, v100, v101
  v_cvt_pk_bf16_f32 v101, v102, v103
  v_cvt_pk_bf16_f32 v102, v132, v133
  v_cvt_pk_bf16_f32 v103, v134, v135
  buffer_store_dwordx4 v[100:103], v3, s[8:11], s30 offen sc1
  s_waitcnt lgkmcnt(6)
  v_mfma_f32_16x16x32_bf16 v[104:107], v[80:83], v[8:11], v[104:107]
  ds_read_b128 v[4:7], v209 offset:55296
  v_mfma_f32_16x16x32_bf16 v[136:139], v[184:187], v[8:11], v[136:139]
  v_mfma_f32_16x16x32_bf16 v[160:163], v[176:179], v[8:11], v[160:163]
  s_waitcnt lgkmcnt(6)
  v_mfma_f32_16x16x32_bf16 v[104:107], v[180:183], v[12:15], v[104:107]
  ds_read_b128 v[8:11], v209 offset:63488
  v_mfma_f32_16x16x32_bf16 v[136:139], v[196:199], v[12:15], v[136:139]
  v_mfma_f32_16x16x32_bf16 v[160:163], v[188:191], v[12:15], v[160:163]
  s_waitcnt lgkmcnt(6)
  v_mfma_f32_16x16x32_bf16 v[104:107], v[192:195], v[16:19], v[104:107]
  ds_read_b128 v[12:15], v210 offset:6144
  v_mfma_f32_16x16x32_bf16 v[136:139], v[216:219], v[16:19], v[136:139]
  v_mfma_f32_16x16x32_bf16 v[160:163], v[200:203], v[16:19], v[160:163]
  s_waitcnt lgkmcnt(6)
  v_mfma_f32_16x16x32_bf16 v[108:111], v[68:71], v[20:23], v[108:111]
  ds_read_b128 v[16:19], v210 offset:14336
  v_mfma_f32_16x16x32_bf16 v[140:143], v[84:87], v[20:23], v[140:143]
  s_waitcnt lgkmcnt(6)
  v_mfma_f32_16x16x32_bf16 v[108:111], v[80:83], v[24:27], v[108:111]
  ds_read_b128 v[20:23], v212 offset:56320
  s_add_u32 s30, s26, 73728
  v_cvt_pk_bf16_f32 v104, v104, v105
  v_cvt_pk_bf16_f32 v105, v106, v107
  v_cvt_pk_bf16_f32 v106, v136, v137
  v_cvt_pk_bf16_f32 v107, v138, v139
  buffer_store_dwordx4 v[104:107], v3, s[8:11], s30 offen sc1
  s_add_u32 s30, s27, 73728
  v_cvt_pk_bf16_f32 v160, v160, v161
  v_cvt_pk_bf16_f32 v161, v162, v163
  buffer_store_dwordx2 v[160:161], v255, s[8:11], s30 offen sc1
  v_mfma_f32_16x16x32_bf16 v[140:143], v[184:187], v[24:27], v[140:143]
  s_waitcnt lgkmcnt(6)
  v_mfma_f32_16x16x32_bf16 v[108:111], v[180:183], v[168:171], v[108:111]
  ds_read_b128 v[24:27], v212 offset:64512
  v_mfma_f32_16x16x32_bf16 v[140:143], v[196:199], v[168:171], v[140:143]
  s_waitcnt lgkmcnt(6)
  v_mfma_f32_16x16x32_bf16 v[108:111], v[192:195], v[172:175], v[108:111]
  ds_read_b128 v[168:171], v213 offset:7168
  v_mfma_f32_16x16x32_bf16 v[140:143], v[216:219], v[172:175], v[140:143]
  s_waitcnt lgkmcnt(6)
  v_mfma_f32_16x16x32_bf16 v[112:115], v[68:71], v[4:7], v[112:115]
  ds_read_b128 v[172:175], v213 offset:15360
  v_mfma_f32_16x16x32_bf16 v[144:147], v[84:87], v[4:7], v[144:147]
  v_mfma_f32_16x16x32_bf16 v[164:167], v[76:79], v[4:7], v[164:167]
  s_add_u32 s30, s16, 92160
  v_cvt_pk_bf16_f32 v108, v108, v109
  v_cvt_pk_bf16_f32 v109, v110, v111
  v_cvt_pk_bf16_f32 v110, v140, v141
  v_cvt_pk_bf16_f32 v111, v142, v143
  buffer_store_dwordx4 v[108:111], v3, s[8:11], s30 offen sc1
  s_waitcnt lgkmcnt(6)
  v_mfma_f32_16x16x32_bf16 v[112:115], v[80:83], v[8:11], v[112:115]
  v_mfma_f32_16x16x32_bf16 v[144:147], v[184:187], v[8:11], v[144:147]
  v_mfma_f32_16x16x32_bf16 v[164:167], v[176:179], v[8:11], v[164:167]
  s_waitcnt lgkmcnt(5)
  v_mfma_f32_16x16x32_bf16 v[112:115], v[180:183], v[12:15], v[112:115]
  v_mfma_f32_16x16x32_bf16 v[144:147], v[196:199], v[12:15], v[144:147]
  v_mfma_f32_16x16x32_bf16 v[164:167], v[188:191], v[12:15], v[164:167]
  s_waitcnt lgkmcnt(4)
  v_mfma_f32_16x16x32_bf16 v[112:115], v[192:195], v[16:19], v[112:115]
  v_mfma_f32_16x16x32_bf16 v[144:147], v[216:219], v[16:19], v[144:147]
  v_mfma_f32_16x16x32_bf16 v[164:167], v[200:203], v[16:19], v[164:167]
  s_waitcnt lgkmcnt(3)
  v_mfma_f32_16x16x32_bf16 v[116:119], v[68:71], v[20:23], v[116:119]
  v_mfma_f32_16x16x32_bf16 v[148:151], v[84:87], v[20:23], v[148:151]
  s_waitcnt lgkmcnt(2)
  v_mfma_f32_16x16x32_bf16 v[116:119], v[80:83], v[24:27], v[116:119]
  s_add_u32 s30, s26, 110592
  v_cvt_pk_bf16_f32 v112, v112, v113
  v_cvt_pk_bf16_f32 v113, v114, v115
  v_cvt_pk_bf16_f32 v114, v144, v145
  v_cvt_pk_bf16_f32 v115, v146, v147
  buffer_store_dwordx4 v[112:115], v3, s[8:11], s30 offen sc1
  s_add_u32 s30, s27, 110592
  v_cvt_pk_bf16_f32 v164, v164, v165
  v_cvt_pk_bf16_f32 v165, v166, v167
  buffer_store_dwordx2 v[164:165], v255, s[8:11], s30 offen sc1
  v_mfma_f32_16x16x32_bf16 v[148:151], v[184:187], v[24:27], v[148:151]
  s_waitcnt lgkmcnt(1)
  v_mfma_f32_16x16x32_bf16 v[116:119], v[180:183], v[168:171], v[116:119]
  v_mfma_f32_16x16x32_bf16 v[148:151], v[196:199], v[168:171], v[148:151]
  s_waitcnt lgkmcnt(0)
  v_mfma_f32_16x16x32_bf16 v[116:119], v[192:195], v[172:175], v[116:119]
  v_mfma_f32_16x16x32_bf16 v[148:151], v[216:219], v[172:175], v[148:151]
  s_add_u32 s30, s16, 129024
  s_nop 5
  v_cvt_pk_bf16_f32 v116, v116, v117
  v_cvt_pk_bf16_f32 v117, v118, v119
  v_cvt_pk_bf16_f32 v118, v148, v149
  v_cvt_pk_bf16_f32 v119, v150, v151
  buffer_store_dwordx4 v[116:119], v3, s[8:11], s30 offen sc1
  s_branch per_seam
per_A_x0s:
  s_mov_b32 s31, 0x100000
per_A_x0l:
  ds_read_b32 v250, v254 offset:0
  s_waitcnt lgkmcnt(0)
  v_cmp_gt_u32 vcc, 1, v250
  s_cbranch_vccz per_A_x0r
  s_sub_u32 s31, s31, 1
  s_cbranch_scc0 per_A_x0l
  s_branch per_A_x0r
per_A_x1s:
  s_mov_b32 s31, 0x100000
per_A_x1l:
  ds_read_b32 v250, v254 offset:1024
  s_waitcnt lgkmcnt(0)
  v_cmp_gt_u32 vcc, 2, v250
  s_cbranch_vccz per_A_x1r
  s_sub_u32 s31, s31, 1
  s_cbranch_scc0 per_A_x1l
  s_branch per_A_x1r
per_A_x2s:
  s_mov_b32 s31, 0x100000
per_A_x2l:
  ds_read_b32 v250, v254 offset:1024
  s_waitcnt lgkmcnt(0)
  v_cmp_gt_u32 vcc, 3, v250
  s_cbranch_vccz per_A_x2r
  s_sub_u32 s31, s31, 1
  s_cbranch_scc0 per_A_x2l
  s_branch per_A_x2r
per_A_x3s:
  s_mov_b32 s31, 0x100000
per_A_x3l:
  ds_read_b32 v250, v254 offset:1024
  s_waitcnt lgkmcnt(0)
  v_cmp_gt_u32 vcc, 4, v250
  s_cbranch_vccz per_A_x3r
  s_sub_u32 s31, s31, 1
  s_cbranch_scc0 per_A_x3l
  s_branch per_A_x3r
per_A_x4s:
  s_mov_b32 s31, 0x100000
per_A_x4l:
  ds_read_b32 v250, v254 offset:1024
  s_waitcnt lgkmcnt(0)
  v_cmp_gt_u32 vcc, 5, v250
  s_cbranch_vccz per_A_x4r
  s_sub_u32 s31, s31, 1
  s_cbranch_scc0 per_A_x4l
  s_branch per_A_x4r
per_A_x5s:
  s_mov_b32 s31, 0x100000
per_A_x5l:
  ds_read_b32 v250, v254 offset:1024
  s_waitcnt lgkmcnt(0)
  v_cmp_gt_u32 vcc, 6, v250
  s_cbranch_vccz per_A_x5r
  s_sub_u32 s31, s31, 1
  s_cbranch_scc0 per_A_x5l
  s_branch per_A_x5r
per_A_x6s:
  s_mov_b32 s31, 0x100000
per_A_x6l:
  ds_read_b32 v250, v254 offset:1024
  s_waitcnt lgkmcnt(0)
  v_cmp_gt_u32 vcc, 7, v250
  s_cbranch_vccz per_A_x6r
  s_sub_u32 s31, s31, 1
  s_cbranch_scc0 per_A_x6l
  s_branch per_A_x6r
per_A_x7s:
  s_mov_b32 s31, 0x100000
per_A_x7l:
  ds_read_b32 v250, v254 offset:1024
  s_waitcnt lgkmcnt(0)
  v_cmp_gt_u32 vcc, 8, v250
  s_cbranch_vccz per_A_x7r
  s_sub_u32 s31, s31, 1
  s_cbranch_scc0 per_A_x7l
  s_branch per_A_x7r
per_A_x8s:
  s_mov_b32 s31, 0x100000
per_A_x8l:
  ds_read_b32 v250, v254 offset:1024
  s_waitcnt lgkmcnt(0)
  v_cmp_gt_u32 vcc, 9, v250
  s_cbranch_vccz per_A_x8r
  s_sub_u32 s31, s31, 1
  s_cbranch_scc0 per_A_x8l
  s_branch per_A_x8r
per_A_x9s:
  s_mov_b32 s31, 0x100000
per_A_x9l:
  ds_read_b32 v250, v254 offset:1024
  s_waitcnt lgkmcnt(0)
  v_cmp_gt_u32 vcc, 10, v250
  s_cbranch_vccz per_A_x9r
  s_sub_u32 s31, s31, 1
  s_cbranch_scc0 per_A_x9l
  s_branch per_A_x9r
per_A_x10s:
  s_mov_b32 s31, 0x100000
per_A_x10l:
  ds_read_b32 v250, v254 offset:1024
  s_waitcnt lgkmcnt(0)
  v_cmp_gt_u32 vcc, 11, v250
  s_cbranch_vccz per_A_x10r
  s_sub_u32 s31, s31, 1
  s_cbranch_scc0 per_A_x10l
  s_branch per_A_x10r
per_A_x11s:
  s_mov_b32 s31, 0x100000
per_A_x11l:
  ds_read_b32 v250, v254 offset:1024
  s_waitcnt lgkmcnt(0)
  v_cmp_gt_u32 vcc, 12, v250
  s_cbranch_vccz per_A_x11r
  s_sub_u32 s31, s31, 1
  s_cbranch_scc0 per_A_x11l
  s_branch per_A_x11r
per_A_x12s:
  s_mov_b32 s31, 0x100000
per_A_x12l:
  ds_read_b32 v250, v254 offset:1024
  s_waitcnt lgkmcnt(0)
  v_cmp_gt_u32 vcc, 13, v250
  s_cbranch_vccz per_A_x12r
  s_sub_u32 s31, s31, 1
  s_cbranch_scc0 per_A_x12l
  s_branch per_A_x12r
per_A_x13s:
  s_mov_b32 s31, 0x100000
per_A_x13l:
  ds_read_b32 v250, v254 offset:1024
  s_waitcnt lgkmcnt(0)
  v_cmp_gt_u32 vcc, 14, v250
  s_cbranch_vccz per_A_x13r
  s_sub_u32 s31, s31, 1
  s_cbranch_scc0 per_A_x13l
  s_branch per_A_x13r
per_A_x14s:
  s_mov_b32 s31, 0x100000
per_A_x14l:
  ds_read_b32 v250, v254 offset:1024
  s_waitcnt lgkmcnt(0)
  v_cmp_gt_u32 vcc, 15, v250
  s_cbranch_vccz per_A_x14r
  s_sub_u32 s31, s31, 1
  s_cbranch_scc0 per_A_x14l
  s_branch per_A_x14r
per_A_x15s:
  s_mov_b32 s31, 0x100000
per_A_x15l:
  ds_read_b32 v250, v254 offset:1024
  s_waitcnt lgkmcnt(0)
  v_cmp_gt_u32 vcc, 16, v250
  s_cbranch_vccz per_A_x15r
  s_sub_u32 s31, s31, 1
  s_cbranch_scc0 per_A_x15l
  s_branch per_A_x15r
per_A_x16s:
  s_mov_b32 s31, 0x100000
per_A_x16l:
  ds_read_b32 v250, v254 offset:1024
  s_waitcnt lgkmcnt(0)
  v_cmp_gt_u32 vcc, 17, v250
  s_cbranch_vccz per_A_x16r
  s_sub_u32 s31, s31, 1
  s_cbranch_scc0 per_A_x16l
  s_branch per_A_x16r
per_A_x17s:
  s_mov_b32 s31, 0x100000
per_A_x17l:
  ds_read_b32 v250, v254 offset:1024
  s_waitcnt lgkmcnt(0)
  v_cmp_gt_u32 vcc, 18, v250
  s_cbranch_vccz per_A_x17r
  s_sub_u32 s31, s31, 1
  s_cbranch_scc0 per_A_x17l
  s_branch per_A_x17r
per_A_x18s:
  s_mov_b32 s31, 0x100000
per_A_x18l:
  ds_read_b32 v250, v254 offset:0
  s_waitcnt lgkmcnt(0)
  v_cmp_gt_u32 vcc, 2, v250
  s_cbranch_vccz per_A_x18r
  s_sub_u32 s31, s31, 1
  s_cbranch_scc0 per_A_x18l
  s_branch per_A_x18r
per_A_x19s:
  s_mov_b32 s31, 0x100000
per_A_x19l:
  s_sleep 1
  ds_read_b32 v250, v254 offset:1024
  s_waitcnt lgkmcnt(0)
  v_cmp_gt_u32 vcc, 19, v250
  s_cbranch_vccz per_A_x19r
  s_sub_u32 s31, s31, 1
  s_cbranch_scc0 per_A_x19l
  s_branch per_A_x19r
per_A_x20s:
  s_mov_b32 s31, 0x100000
per_A_x20l:
  ds_read_b32 v250, v254 offset:0
  s_waitcnt lgkmcnt(0)
  v_cmp_gt_u32 vcc, 3, v250
  s_cbranch_vccz per_A_x20r
  s_sub_u32 s31, s31, 1
  s_cbranch_scc0 per_A_x20l
  s_branch per_A_x20r
per_A_x21s:
  s_mov_b32 s31, 0x100000
per_A_x21l:
  s_sleep 2
  ds_read_b32 v250, v254 offset:1024
  s_waitcnt lgkmcnt(0)
  v_cmp_gt_u32 vcc, 20, v250
  s_cbranch_vccz per_A_x21r
  s_sub_u32 s31, s31, 1
  s_cbranch_scc0 per_A_x21l
  s_branch per_A_x21r
per_A_poll0s:
  s_mov_b32 s31, 0x100000
  v_mov_b32 v248, 0
per_A_poll0l:
  buffer_load_dword v249, v248, s[8:11], s39 offen offset:0 sc1
  s_waitcnt vmcnt(0)
  v_cmp_ne_u32 vcc, s96, v249
  s_cbranch_vccz per_A_poll0r
  s_sleep 1
  s_sub_u32 s31, s31, 1
  s_cbranch_scc0 per_A_poll0l
  s_branch per_A_poll0r
per_A_poll1s:
  s_mov_b32 s31, 0x100000
  v_mov_b32 v248, 0
per_A_poll1l:
  buffer_load_dword v249, v248, s[8:11], s39 offen offset:4 sc1
  s_waitcnt vmcnt(0)
  v_cmp_ne_u32 vcc, s96, v249
  s_cbranch_vccz per_A_poll1r
  s_sleep 1
  s_sub_u32 s31, s31, 1
  s_cbranch_scc0 per_A_poll1l
  s_branch per_A_poll1r
per_A_x22s:
  s_mov_b32 s31, 0x100000
per_A_x22l:
  s_sleep 1
  ds_read_b32 v250, v254 offset:0
  s_waitcnt lgkmcnt(0)
  v_cmp_gt_u32 vcc, 4, v250
  s_cbranch_vccz per_A_x22r
  s_sub_u32 s31, s31, 1
  s_cbranch_scc0 per_A_x22l
  s_branch per_A_x22r
per_A_x23s:
  s_mov_b32 s31, 0x100000
per_A_x23l:
  s_sleep 1
  ds_read_b32 v250, v254 offset:1024
  s_waitcnt lgkmcnt(0)
  v_cmp_gt_u32 vcc, 22, v250
  s_cbranch_vccz per_A_x23r
  s_sub_u32 s31, s31, 1
  s_cbranch_scc0 per_A_x23l
  s_branch per_A_x23r
per_A_x24s:
  s_mov_b32 s31, 0x100000
per_A_x24l:
  s_sleep 1
  ds_read_b32 v250, v254 offset:0
  s_waitcnt lgkmcnt(0)
  v_cmp_gt_u32 vcc, 5, v250
  s_cbranch_vccz per_A_x24r
  s_sub_u32 s31, s31, 1
  s_cbranch_scc0 per_A_x24l
  s_branch per_A_x24r
per_A_poll2s:
  s_mov_b32 s31, 0x100000
  v_mov_b32 v248, 0
per_A_poll2l:
  buffer_load_dword v249, v248, s[8:11], s39 offen offset:128 sc1
  s_waitcnt vmcnt(0)
  v_cmp_ne_u32 vcc, s96, v249
  s_cbranch_vccz per_A_poll2r
  s_sleep 1
  s_sub_u32 s31, s31, 1
  s_cbranch_scc0 per_A_poll2l
  s_branch per_A_poll2r
per_A_x25s:
  s_mov_b32 s31, 0x100000
per_A_x25l:
  s_sleep 1
  ds_read_b32 v250, v254 offset:1024
  s_waitcnt lgkmcnt(0)
  v_cmp_gt_u32 vcc, 23, v250
  s_cbranch_vccz per_A_x25r
  s_sub_u32 s31, s31, 1
  s_cbranch_scc0 per_A_x25l
  s_branch per_A_x25r
per_A_x26s:
  s_mov_b32 s31, 0x100000
per_A_x26l:
  s_sleep 1
  ds_read_b32 v250, v254 offset:0
  s_waitcnt lgkmcnt(0)
  v_cmp_gt_u32 vcc, 6, v250
  s_cbranch_vccz per_A_x26r
  s_sub_u32 s31, s31, 1
  s_cbranch_scc0 per_A_x26l
  s_branch per_A_x26r
per_A_poll3s:
  s_mov_b32 s31, 0x100000
  v_mov_b32 v248, 0
per_A_poll3l:
  buffer_load_dword v249, v248, s[8:11], s39 offen offset:132 sc1
  s_waitcnt vmcnt(0)
  v_cmp_ne_u32 vcc, s96, v249
  s_cbranch_vccz per_A_poll3r
  s_sleep 1
  s_sub_u32 s31, s31, 1
  s_cbranch_scc0 per_A_poll3l
  s_branch per_A_poll3r
per_A_x27s:
  s_mov_b32 s31, 0x100000
per_A_x27l:
  s_sleep 1
  ds_read_b32 v250, v254 offset:0
  s_waitcnt lgkmcnt(0)
  v_cmp_gt_u32 vcc, 7, v250
  s_cbranch_vccz per_A_x27r
  s_sub_u32 s31, s31, 1
  s_cbranch_scc0 per_A_x27l
  s_branch per_A_x27r
.p2align 6
per_B:
  s_add_u32 s29, s20, 0
  buffer_load_dwordx4 v[28:31], v0, s[8:11], s29 offen offset:0
  buffer_load_dwordx4 v[32:35], v0, s[8:11], s29 offen offset:1024
  buffer_load_dwordx4 v[36:39], v0, s[8:11], s29 offen offset:2048
  buffer_load_dwordx4 v[40:43], v0, s[8:11], s29 offen offset:3072
  s_cmp_lg_u32 s3, 4
  s_cbranch_scc1 per_B_h_np
  v_lshlrev_b32 v248, 3, v0
  s_mov_b64 exec, 0xffff
  s_mov_b32 s31, 0x40000
per_B_h_pl:
  buffer_load_dword v249, v248, s[8:11], s44 offen sc1
  s_waitcnt vmcnt(0)
  v_cmp_ne_u32 vcc, s96, v249
  s_cbranch_vccz per_B_h_pe
  s_sleep 1
  s_sub_u32 s31, s31, 1
  s_cbranch_scc0 per_B_h_pl
per_B_h_pe:
  s_mov_b64 exec, -1
per_B_h_np:
  s_barrier
  s_add_u32 m0, s25, 8192
  s_add_u32 s30, s24, 8192
  buffer_load_dwordx4 v0, s[8:11], s30 offen sc1 lds
  buffer_load_dwordx4 v0, s[8:11], s30 offen offset:1024 sc1 lds
  s_setprio 3
  s_add_u32 m0, s25, 16384
  s_add_u32 s30, s24, 16384
  buffer_load_dwordx4 v0, s[8:11], s30 offen sc1 lds
  buffer_load_dwordx4 v0, s[8:11], s30 offen offset:1024 sc1 lds
  s_add_u32 m0, s25, 24576
  s_add_u32 s30, s24, 24576
  buffer_load_dwordx4 v0, s[8:11], s30 offen sc1 lds
  buffer_load_dwordx4 v0, s[8:11], s30 offen offset:1024 sc1 lds
  s_waitcnt vmcnt(4)
  v_mov_b32 v248, 2
  ds_write_b32 v251, v248
  s_waitcnt vmcnt(2)
  v_mov_b32 v248, 3
  ds_write_b32 v251, v248
  s_waitcnt vmcnt(0)
  v_mov_b32 v248, 4
  ds_write_b32 v251, v248
  s_add_u32 m0, s25, 32768
  s_add_u32 s30, s24, 32768
  buffer_load_dwordx4 v0, s[8:11], s30 offen sc1 lds
  buffer_load_dwordx4 v0, s[8:11], s30 offen offset:1024 sc1 lds
  s_waitcnt vmcnt(0)
  v_mov_b32 v248, 5
  ds_write_b32 v251, v248
  s_add_u32 m0, s25, 40960
  s_add_u32 s30, s24, 40960
  buffer_load_dwordx4 v0, s[8:11], s30 offen sc1 lds
  buffer_load_dwordx4 v0, s[8:11], s30 offen offset:1024 sc1 lds
  s_waitcnt vmcnt(0)
  v_mov_b32 v248, 6
  ds_write_b32 v251, v248
  s_add_u32 m0, s25, 49152
  s_add_u32 s30, s24, 49152
  buffer_load_dwordx4 v0, s[8:11], s30 offen sc1 lds
  buffer_load_dwordx4 v0, s[8:11], s30 offen offset:1024 sc1 lds
  s_waitcnt vmcnt(0)
  v_mov_b32 v248, 7
  ds_write_b32 v251, v248
  s_add_u32 m0, s25, 57344
  s_add_u32 s30, s24, 57344
  buffer_load_dwordx4 v0, s[8:11], s30 offen sc1 lds
  buffer_load_dwordx4 v0, s[8:11], s30 offen offset:1024 sc1 lds
  s_waitcnt vmcnt(0)
  v_mov_b32 v248, 8
  ds_write_b32 v251, v248
  s_add_u32 m0, s25, 65536
  s_add_u32 s30, s24, 65536
  buffer_load_dwordx4 v0, s[8:11], s30 offen sc1 lds
  buffer_load_dwordx4 v0, s[8:11], s30 offen offset:1024 sc1 lds
  s_waitcnt vmcnt(0)
  v_min_u32 v88, 272, v0
  v_lshlrev_b32 v88, 6, v88
  s_lshl_b32 s6, s4, 7
  s_add_u32 s6, s6, 70156288
  buffer_load_dword v89, v88, s[8:11], s6 offen sc1
  v_mov_b32 v248, 9
  ds_write_b32 v251, v248
  s_add_u32 m0, s25, 73728
  s_add_u32 s30, s24, 73728
  buffer_load_dwordx4 v0, s[8:11], s30 offen sc1 lds
  buffer_load_dwordx4 v0, s[8:11], s30 offen offset:1024 sc1 lds
  s_waitcnt vmcnt(0)
  v_mov_b32 v248, 10
  ds_write_b32 v251, v248
  s_add_u32 m0, s25, 81920
  s_add_u32 s30, s24, 81920
  buffer_load_dwordx4 v0, s[8:11], s30 offen sc1 lds
  buffer_load_dwordx4 v0, s[8:11], s30 offen offset:1024 sc1 lds
  s_waitcnt vmcnt(0)
  v_cmp_ne_u32 vcc, s96, v89
  s_cbranch_vccnz per_wds
per_wdr:
  v_mov_b32 v248, 11
  ds_write_b32 v251, v248
  s_add_u32 m0, s25, 90112
  s_add_u32 s30, s24, 90112
  buffer_load_dwordx4 v0, s[8:11], s30 offen sc1 lds
  buffer_load_dwordx4 v0, s[8:11], s30 offen offset:1024 sc1 lds
  s_waitcnt vmcnt(0)
  v_mov_b32 v248, 12
  ds_write_b32 v251, v248
  s_add_u32 m0, s25, 98304
  s_add_u32 s30, s24, 98304
  buffer_load_dwordx4 v0, s[8:11], s30 offen sc1 lds
  buffer_load_dwordx4 v0, s[8:11], s30 offen offset:1024 sc1 lds
  s_waitcnt vmcnt(0)
  v_mov_b32 v248, 13
  ds_write_b32 v251, v248
  s_add_u32 m0, s25, 106496
  s_add_u32 s30, s24, 106496
  buffer_load_dwordx4 v0, s[8:11], s30 offen sc1 lds
  buffer_load_dwordx4 v0, s[8:11], s30 offen offset:1024 sc1 lds
  s_waitcnt vmcnt(0)
  v_mov_b32 v248, 14
  ds_write_b32 v251, v248
  s_add_u32 m0, s25, 114688
  s_add_u32 s30, s24, 114688
  buffer_load_dwordx4 v0, s[8:11], s30 offen sc1 lds
  buffer_load_dwordx4 v0, s[8:11], s30 offen offset:1024 sc1 lds
  s_waitcnt vmcnt(0)
  v_mov_b32 v248, 15
  ds_write_b32 v251, v248
  s_add_u32 m0, s25, 122880
  s_add_u32 s30, s24, 122880
  buffer_load_dwordx4 v0, s[8:11], s30 offen sc1 lds
  buffer_load_dwordx4 v0, s[8:11], s30 offen offset:1024 sc1 lds
  s_add_u32 s28, s20, 4096
  buffer_load_dwordx4 v[44:47], v0, s[8:11], s28 offen offset:0
  s_waitcnt vmcnt(1)
  v_mov_b32 v248, 16
  ds_write_b32 v251, v248
  s_add_u32 m0, s25, 131072
  s_add_u32 s30, s24, 131072
  buffer_load_dwordx4 v0, s[8:11], s30 offen sc1 lds
  buffer_load_dwordx4 v0, s[8:11], s30 offen offset:1024 sc1 lds
  buffer_load_dwordx4 v[48:51], v0, s[8:11], s28 offen offset:1024
  s_waitcnt vmcnt(1)
  v_mov_b32 v248, 17
  ds_write_b32 v251, v248
  s_add_u32 m0, s25, 139264
  s_add_u32 s30, s24, 139264
  buffer_load_dwordx4 v0, s[8:11], s30 offen sc1 lds
  buffer_load_dwordx4 v0, s[8:11], s30 offen offset:1024 sc1 lds
  buffer_load_dwordx4 v[52:55], v0, s[8:11], s28 offen offset:2048
  s_waitcnt vmcnt(1)
  v_mov_b32 v248, 18
  ds_write_b32 v251, v248
  buffer_load_dwordx4 v[56:59], v0, s[8:11], s28 offen offset:3072
  s_setprio 1
  ds_read_b32 v250, v254 offset:0
  s_waitcnt lgkmcnt(0)
  v_cmp_gt_u32 vcc, 1, v250
  s_cbranch_vccnz per_B_x0s
per_B_x0r:
  ds_read_b128 v[4:7], v0 offset:0
  ds_read_b128 v[8:11], v0 offset:1024
  ds_read_b128 v[12:15], v0 offset:2048
  ds_read_b128 v[16:19], v0 offset:3072
  ds_read_b128 v[20:23], v0 offset:4096
  ds_read_b128 v[24:27], v0 offset:5120
  s_waitcnt lgkmcnt(5)
  v_mfma_f32_16x16x32_bf16 v[88:91], v[28:31], v[4:7], 0
  v_mfma_f32_16x16x32_bf16 v[120:123], v[32:35], v[4:7], 0
  s_add_u32 s29, s20, 8192
  buffer_load_dwordx4 v[60:63], v0, s[8:11], s29 offen offset:0
  v_mfma_f32_16x16x32_bf16 v[152:155], v[36:39], v[4:7], 0
  buffer_load_dwordx4 v[64:67], v0, s[8:11], s29 offen offset:1024
  v_mfma_f32_16x16x32_bf16 v[184:187], v[40:43], v[4:7], 0
  s_waitcnt lgkmcnt(4)
  v_mfma_f32_16x16x32_bf16 v[92:95], v[28:31], v[8:11], 0
  ds_read_b128 v[4:7], v0 offset:6144
  v_mfma_f32_16x16x32_bf16 v[124:127], v[32:35], v[8:11], 0
  buffer_load_dwordx4 v[68:71], v0, s[8:11], s29 offen offset:2048
  v_mfma_f32_16x16x32_bf16 v[156:159], v[36:39], v[8:11], 0
  buffer_load_dwordx4 v[72:75], v0, s[8:11], s29 offen offset:3072
  v_mfma_f32_16x16x32_bf16 v[188:191], v[40:43], v[8:11], 0
  s_waitcnt lgkmcnt(4)
  v_mfma_f32_16x16x32_bf16 v[96:99], v[28:31], v[12:15], 0
  ds_read_b128 v[8:11], v0 offset:7168
  ds_read_b32 v250, v254 offset:1024
  v_mfma_f32_16x16x32_bf16 v[128:131], v[32:35], v[12:15], 0
  s_add_u32 s28, s20, 12288
  buffer_load_dwordx4 v[76:79], v0, s[8:11], s28 offen offset:0
  v_mfma_f32_16x16x32_bf16 v[160:163], v[36:39], v[12:15], 0
  buffer_load_dwordx4 v[80:83], v0, s[8:11], s28 offen offset:1024
  v_mfma_f32_16x16x32_bf16 v[192:195], v[40:43], v[12:15], 0
  s_waitcnt lgkmcnt(5)
  v_mfma_f32_16x16x32_bf16 v[100:103], v[28:31], v[16:19], 0
  s_waitcnt lgkmcnt(0)
  v_cmp_gt_u32 vcc, 4, v250
  s_cbranch_vccnz per_B_x1s
per_B_x1r:
  ds_read_b128 v[12:15], v0 offset:8192
  v_mfma_f32_16x16x32_bf16 v[132:135], v[32:35], v[16:19], 0
  buffer_load_dwordx4 v[84:87], v0, s[8:11], s28 offen offset:2048
  v_mfma_f32_16x16x32_bf16 v[164:167], v[36:39], v[16:19], 0
  buffer_load_dwordx4 v[216:219], v0, s[8:11], s28 offen offset:3072
  v_mfma_f32_16x16x32_bf16 v[196:199], v[40:43], v[16:19], 0
  v_mfma_f32_16x16x32_bf16 v[104:107], v[28:31], v[20:23], 0
  ds_read_b128 v[16:19], v0 offset:9216
  v_mfma_f32_16x16x32_bf16 v[136:139], v[32:35], v[20:23], 0
  s_add_u32 s29, s20, 16384
  buffer_load_dwordx4 v[220:223], v0, s[8:11], s29 offen offset:0
  v_mfma_f32_16x16x32_bf16 v[168:171], v[36:39], v[20:23], 0
  v_mfma_f32_16x16x32_bf16 v[200:203], v[40:43], v[20:23], 0
  v_mfma_f32_16x16x32_bf16 v[108:111], v[28:31], v[24:27], 0
  ds_read_b128 v[20:23], v0 offset:10240
  v_mfma_f32_16x16x32_bf16 v[140:143], v[32:35], v[24:27], 0
  buffer_load_dwordx4 v[224:227], v0, s[8:11], s29 offen offset:1024
  v_mfma_f32_16x16x32_bf16 v[172:175], v[36:39], v[24:27], 0
  v_mfma_f32_16x16x32_bf16 v[204:207], v[40:43], v[24:27], 0
  v_mfma_f32_16x16x32_bf16 v[112:115], v[28:31], v[4:7], 0
  ds_read_b128 v[24:27], v0 offset:11264
  v_mfma_f32_16x16x32_bf16 v[144:147], v[32:35], v[4:7], 0
  buffer_load_dwordx4 v[228:231], v0, s[8:11], s29 offen offset:2048
  v_mfma_f32_16x16x32_bf16 v[176:179], v[36:39], v[4:7], 0
  v_mfma_f32_16x16x32_bf16 v[208:211], v[40:43], v[4:7], 0
  v_mfma_f32_16x16x32_bf16 v[116:119], v[28:31], v[8:11], 0
  ds_read_b128 v[4:7], v0 offset:12288
  v_mfma_f32_16x16x32_bf16 v[148:151], v[32:35], v[8:11], 0
  buffer_load_dwordx4 v[232:235], v0, s[8:11], s29 offen offset:3072
  v_mfma_f32_16x16x32_bf16 v[180:183], v[36:39], v[8:11], 0
  v_mfma_f32_16x16x32_bf16 v[212:215], v[40:43], v[8:11], 0
  s_waitcnt vmcnt(12) lgkmcnt(4)
  v_mfma_f32_16x16x32_bf16 v[88:91], v[44:47], v[12:15], v[88:91]
  ds_read_b128 v[8:11], v0 offset:13312
  v_mfma_f32_16x16x32_bf16 v[120:123], v[48:51], v[12:15], v[120:123]
  s_add_u32 s28, s20, 20480
  buffer_load_dwordx4 v[236:239], v0, s[8:11], s28 offen offset:0
  v_mfma_f32_16x16x32_bf16 v[152:155], v[52:55], v[12:15], v[152:155]
  v_mfma_f32_16x16x32_bf16 v[184:187], v[56:59], v[12:15], v[184:187]
  s_waitcnt lgkmcnt(4)
  v_mfma_f32_16x16x32_bf16 v[92:95], v[44:47], v[16:19], v[92:95]
  ds_read_b128 v[12:15], v0 offset:14336
  v_mfma_f32_16x16x32_bf16 v[124:127], v[48:51], v[16:19], v[124:127]
  buffer_load_dwordx4 v[240:243], v0, s[8:11], s28 offen offset:1024
  v_mfma_f32_16x16x32_bf16 v[156:159], v[52:55], v[16:19], v[156:159]
  v_mfma_f32_16x16x32_bf16 v[188:191], v[56:59], v[16:19], v[188:191]
  s_waitcnt lgkmcnt(4)
  v_mfma_f32_16x16x32_bf16 v[96:99], v[44:47], v[20:23], v[96:99]
  ds_read_b128 v[16:19], v0 offset:15360
  v_mfma_f32_16x16x32_bf16 v[128:131], v[48:51], v[20:23], v[128:131]
  buffer_load_dwordx4 v[28:31], v0, s[8:11], s28 offen offset:2048
  v_mfma_f32_16x16x32_bf16 v[160:163], v[52:55], v[20:23], v[160:163]
  v_mfma_f32_16x16x32_bf16 v[192:195], v[56:59], v[20:23], v[192:195]
  s_waitcnt lgkmcnt(4)
  v_mfma_f32_16x16x32_bf16 v[100:103], v[44:47], v[24:27], v[100:103]
  ds_read_b128 v[20:23], v0 offset:16384
  v_mfma_f32_16x16x32_bf16 v[132:135], v[48:51], v[24:27], v[132:135]
  buffer_load_dwordx4 v[32:35], v0, s[8:11], s28 offen offset:3072
  v_mfma_f32_16x16x32_bf16 v[164:167], v[52:55], v[24:27], v[164:167]
  v_mfma_f32_16x16x32_bf16 v[196:199], v[56:59], v[24:27], v[196:199]
  s_waitcnt lgkmcnt(4)
  v_mfma_f32_16x16x32_bf16 v[104:107], v[44:47], v[4:7], v[104:107]
  ds_read_b128 v[24:27], v0 offset:17408
  v_mfma_f32_16x16x32_bf16 v[136:139], v[48:51], v[4:7], v[136:139]
  s_add_u32 s29, s20, 24576
  buffer_load_dwordx4 v[36:39], v0, s[8:11], s29 offen offset:0
  v_mfma_f32_16x16x32_bf16 v[168:171], v[52:55], v[4:7], v[168:171]
  v_mfma_f32_16x16x32_bf16 v[200:203], v[56:59], v[4:7], v[200:203]
  s_waitcnt lgkmcnt(4)
  v_mfma_f32_16x16x32_bf16 v[108:111], v[44:47], v[8:11], v[108:111]
  ds_read_b128 v[4:7], v0 offset:18432
  v_mfma_f32_16x16x32_bf16 v[140:143], v[48:51], v[8:11], v[140:143]
  buffer_load_dwordx4 v[40:43], v0, s[8:11], s29 offen offset:1024
  v_mfma_f32_16x16x32_bf16 v[172:175], v[52:55], v[8:11], v[172:175]
  v_mfma_f32_16x16x32_bf16 v[204:207], v[56:59], v[8:11], v[204:207]
  s_waitcnt lgkmcnt(4)
  v_mfma_f32_16x16x32_bf16 v[112:115], v[44:47], v[12:15], v[112:115]
  ds_read_b128 v[8:11], v0 offset:19456
  v_mfma_f32_16x16x32_bf16 v[144:147], v[48:51], v[12:15], v[144:147]
  v_mfma_f32_16x16x32_bf16 v[176:179], v[52:55], v[12:15], v[176:179]
  v_mfma_f32_16x16x32_bf16 v[208:211], v[56:59], v[12:15], v[208:211]
  s_waitcnt lgkmcnt(4)
  v_mfma_f32_16x16x32_bf16 v[116:119], v[44:47], v[16:19], v[116:119]
  ds_read_b128 v[12:15], v0 offset:20480
  v_mfma_f32_16x16x32_bf16 v[148:151], v[48:51], v[16:19], v[148:151]
  buffer_load_dwordx4 v[44:47], v0, s[8:11], s29 offen offset:2048
  v_mfma_f32_16x16x32_bf16 v[180:183], v[52:55], v[16:19], v[180:183]
  v_mfma_f32_16x16x32_bf16 v[212:215], v[56:59], v[16:19], v[212:215]
  s_waitcnt vmcnt(15) lgkmcnt(4)
  v_mfma_f32_16x16x32_bf16 v[88:91], v[60:63], v[20:23], v[88:91]
  ds_read_b128 v[16:19], v0 offset:21504
  v_mfma_f32_16x16x32_bf16 v[120:123], v[64:67], v[20:23], v[120:123]
  buffer_load_dwordx4 v[48:51], v0, s[8:11], s29 offen offset:3072
  v_mfma_f32_16x16x32_bf16 v[152:155], v[68:71], v[20:23], v[152:155]
  v_mfma_f32_16x16x32_bf16 v[184:187], v[72:75], v[20:23], v[184:187]
  s_waitcnt lgkmcnt(4)
  v_mfma_f32_16x16x32_bf16 v[92:95], v[60:63], v[24:27], v[92:95]
  ds_read_b128 v[20:23], v0 offset:22528
  v_mfma_f32_16x16x32_bf16 v[124:127], v[64:67], v[24:27], v[124:127]
  s_add_u32 s28, s20, 28672
  buffer_load_dwordx4 v[52:55], v0, s[8:11], s28 offen offset:0
  v_mfma_f32_16x16x32_bf16 v[156:159], v[68:71], v[24:27], v[156:159]
  v_mfma_f32_16x16x32_bf16 v[188:191], v[72:75], v[24:27], v[188:191]
  s_waitcnt lgkmcnt(4)
  v_mfma_f32_16x16x32_bf16 v[96:99], v[60:63], v[4:7], v[96:99]
  ds_read_b128 v[24:27], v0 offset:23552
  v_mfma_f32_16x16x32_bf16 v[128:131], v[64:67], v[4:7], v[128:131]
  buffer_load_dwordx4 v[56:59], v0, s[8:11], s28 offen offset:1024
  v_mfma_f32_16x16x32_bf16 v[160:163], v[68:71], v[4:7], v[160:163]
  v_mfma_f32_16x16x32_bf16 v[192:195], v[72:75], v[4:7], v[192:195]
  s_waitcnt lgkmcnt(4)
  v_mfma_f32_16x16x32_bf16 v[100:103], v[60:63], v[8:11], v[100:103]
  ds_read_b128 v[4:7], v0 offset:24576
  v_mfma_f32_16x16x32_bf16 v[132:135], v[64:67], v[8:11], v[132:135]
  v_mfma_f32_16x16x32_bf16 v[164:167], v[68:71], v[8:11], v[164:167]
  v_mfma_f32_16x16x32_bf16 v[196:199], v[72:75], v[8:11], v[196:199]
  s_waitcnt lgkmcnt(4)
  v_mfma_f32_16x16x32_bf16 v[104:107], v[60:63], v[12:15], v[104:107]
  ds_read_b128 v[8:11], v0 offset:25600
  v_mfma_f32_16x16x32_bf16 v[136:139], v[64:67], v[12:15], v[136:139]
  v_mfma_f32_16x16x32_bf16 v[168:171], v[68:71], v[12:15], v[168:171]
  v_mfma_f32_16x16x32_bf16 v[200:203], v[72:75], v[12:15], v[200:203]
  s_waitcnt lgkmcnt(4)
  v_mfma_f32_16x16x32_bf16 v[108:111], v[60:63], v[16:19], v[108:111]
  ds_read_b128 v[12:15], v0 offset:26624
  v_mfma_f32_16x16x32_bf16 v[140:143], v[64:67], v[16:19], v[140:143]
  v_mfma_f32_16x16x32_bf16 v[172:175], v[68:71], v[16:19], v[172:175]
  v_mfma_f32_16x16x32_bf16 v[204:207], v[72:75], v[16:19], v[204:207]
  s_waitcnt lgkmcnt(4)
  v_mfma_f32_16x16x32_bf16 v[112:115], v[60:63], v[20:23], v[112:115]
  ds_read_b128 v[16:19], v0 offset:27648
  v_mfma_f32_16x16x32_bf16 v[144:147], v[64:67], v[20:23], v[144:147]
  v_mfma_f32_16x16x32_bf16 v[176:179], v[68:71], v[20:23], v[176:179]
  v_mfma_f32_16x16x32_bf16 v[208:211], v[72:75], v[20:23], v[208:211]
  s_waitcnt lgkmcnt(4)
  v_mfma_f32_16x16x32_bf16 v[116:119], v[60:63], v[24:27], v[116:119]
  ds_read_b128 v[20:23], v0 offset:28672
  v_mfma_f32_16x16x32_bf16 v[148:151], v[64:67], v[24:27], v[148:151]
  buffer_load_dwordx4 v[60:63], v0, s[8:11], s28 offen offset:2048
  v_mfma_f32_16x16x32_bf16 v[180:183], v[68:71], v[24:27], v[180:183]
  v_mfma_f32_16x16x32_bf16 v[212:215], v[72:75], v[24:27], v[212:215]
  s_waitcnt vmcnt(15) lgkmcnt(4)
  v_mfma_f32_16x16x32_bf16 v[88:91], v[76:79], v[4:7], v[88:91]
  ds_read_b128 v[24:27], v0 offset:29696
  v_mfma_f32_16x16x32_bf16 v[120:123], v[80:83], v[4:7], v[120:123]
  buffer_load_dwordx4 v[64:67], v0, s[8:11], s28 offen offset:3072
  v_mfma_f32_16x16x32_bf16 v[152:155], v[84:87], v[4:7], v[152:155]
  v_mfma_f32_16x16x32_bf16 v[184:187], v[216:219], v[4:7], v[184:187]
  s_waitcnt lgkmcnt(4)
  v_mfma_f32_16x16x32_bf16 v[92:95], v[76:79], v[8:11], v[92:95]
  ds_read_b128 v[4:7], v0 offset:30720
  v_mfma_f32_16x16x32_bf16 v[124:127], v[80:83], v[8:11], v[124:127]
  s_add_u32 s29, s20, 32768
  buffer_load_dwordx4 v[68:71], v0, s[8:11], s29 offen offset:0
  v_mfma_f32_16x16x32_bf16 v[156:159], v[84:87], v[8:11], v[156:159]
  v_mfma_f32_16x16x32_bf16 v[188:191], v[216:219], v[8:11], v[188:191]
  s_waitcnt lgkmcnt(4)
  v_mfma_f32_16x16x32_bf16 v[96:99], v[76:79], v[12:15], v[96:99]
  ds_read_b128 v[8:11], v0 offset:31744
  ds_read_b32 v250, v254 offset:1024
  v_mfma_f32_16x16x32_bf16 v[128:131], v[80:83], v[12:15], v[128:131]
  buffer_load_dwordx4 v[72:75], v0, s[8:11], s29 offen offset:1024
  v_mfma_f32_16x16x32_bf16 v[160:163], v[84:87], v[12:15], v[160:163]
  v_mfma_f32_16x16x32_bf16 v[192:195], v[216:219], v[12:15], v[192:195]
  s_waitcnt lgkmcnt(5)
  v_mfma_f32_16x16x32_bf16 v[100:103], v[76:79], v[16:19], v[100:103]
  s_waitcnt lgkmcnt(0)
  v_cmp_gt_u32 vcc, 18, v250
  s_cbranch_vccnz per_B_x2s
per_B_x2r:
  ds_read_b128 v[12:15], v0 offset:32768
  v_mfma_f32_16x16x32_bf16 v[132:135], v[80:83], v[16:19], v[132:135]
  v_mfma_f32_16x16x32_bf16 v[164:167], v[84:87], v[16:19], v[164:167]
  v_mfma_f32_16x16x32_bf16 v[196:199], v[216:219], v[16:19], v[196:199]
  v_mfma_f32_16x16x32_bf16 v[104:107], v[76:79], v[20:23], v[104:107]
  ds_read_b128 v[16:19], v0 offset:33792
  v_mfma_f32_16x16x32_bf16 v[136:139], v[80:83], v[20:23], v[136:139]
  v_mfma_f32_16x16x32_bf16 v[168:171], v[84:87], v[20:23], v[168:171]
  v_mfma_f32_16x16x32_bf16 v[200:203], v[216:219], v[20:23], v[200:203]
  v_mfma_f32_16x16x32_bf16 v[108:111], v[76:79], v[24:27], v[108:111]
  ds_read_b128 v[20:23], v0 offset:34816
  v_mfma_f32_16x16x32_bf16 v[140:143], v[80:83], v[24:27], v[140:143]
  v_mfma_f32_16x16x32_bf16 v[172:175], v[84:87], v[24:27], v[172:175]
  v_mfma_f32_16x16x32_bf16 v[204:207], v[216:219], v[24:27], v[204:207]
  v_mfma_f32_16x16x32_bf16 v[112:115], v[76:79], v[4:7], v[112:115]
  ds_read_b128 v[24:27], v0 offset:35840
  v_mfma_f32_16x16x32_bf16 v[144:147], v[80:83], v[4:7], v[144:147]
  v_mfma_f32_16x16x32_bf16 v[176:179], v[84:87], v[4:7], v[176:179]
  v_mfma_f32_16x16x32_bf16 v[208:211], v[216:219], v[4:7], v[208:211]
  v_mfma_f32_16x16x32_bf16 v[116:119], v[76:79], v[8:11], v[116:119]
  ds_read_b128 v[4:7], v0 offset:36864
  v_mfma_f32_16x16x32_bf16 v[148:151], v[80:83], v[8:11], v[148:151]
  buffer_load_dwordx4 v[76:79], v0, s[8:11], s29 offen offset:2048
  v_mfma_f32_16x16x32_bf16 v[180:183], v[84:87], v[8:11], v[180:183]
  v_mfma_f32_16x16x32_bf16 v[212:215], v[216:219], v[8:11], v[212:215]
  s_waitcnt vmcnt(15) lgkmcnt(4)
  v_mfma_f32_16x16x32_bf16 v[88:91], v[220:223], v[12:15], v[88:91]
  ds_read_b128 v[8:11], v0 offset:37888
  v_mfma_f32_16x16x32_bf16 v[120:123], v[224:227], v[12:15], v[120:123]
  buffer_load_dwordx4 v[80:83], v0, s[8:11], s29 offen offset:3072
  v_mfma_f32_16x16x32_bf16 v[152:155], v[228:231], v[12:15], v[152:155]
  v_mfma_f32_16x16x32_bf16 v[184:187], v[232:235], v[12:15], v[184:187]
  s_waitcnt lgkmcnt(4)
  v_mfma_f32_16x16x32_bf16 v[92:95], v[220:223], v[16:19], v[92:95]
  ds_read_b128 v[12:15], v0 offset:38912
  v_mfma_f32_16x16x32_bf16 v[124:127], v[224:227], v[16:19], v[124:127]
  s_add_u32 s28, s20, 36864
  buffer_load_dwordx4 v[84:87], v0, s[8:11], s28 offen offset:0
  v_mfma_f32_16x16x32_bf16 v[156:159], v[228:231], v[16:19], v[156:159]
  v_mfma_f32_16x16x32_bf16 v[188:191], v[232:235], v[16:19], v[188:191]
  s_waitcnt lgkmcnt(4)
  v_mfma_f32_16x16x32_bf16 v[96:99], v[220:223], v[20:23], v[96:99]
  ds_read_b128 v[16:19], v0 offset:39936
  v_mfma_f32_16x16x32_bf16 v[128:131], v[224:227], v[20:23], v[128:131]
  buffer_load_dwordx4 v[216:219], v0, s[8:11], s28 offen offset:1024
  v_mfma_f32_16x16x32_bf16 v[160:163], v[228:231], v[20:23], v[160:163]
  v_mfma_f32_16x16x32_bf16 v[192:195], v[232:235], v[20:23], v[192:195]
  s_waitcnt lgkmcnt(4)
  v_mfma_f32_16x16x32_bf16 v[100:103], v[220:223], v[24:27], v[100:103]
  ds_read_b128 v[20:23], v0 offset:40960
  v_mfma_f32_16x16x32_bf16 v[132:135], v[224:227], v[24:27], v[132:135]
  v_mfma_f32_16x16x32_bf16 v[164:167], v[228:231], v[24:27], v[164:167]
  v_mfma_f32_16x16x32_bf16 v[196:199], v[232:235], v[24:27], v[196:199]
  s_waitcnt lgkmcnt(4)
  v_mfma_f32_16x16x32_bf16 v[104:107], v[220:223], v[4:7], v[104:107]
  ds_read_b128 v[24:27], v0 offset:41984
  v_mfma_f32_16x16x32_bf16 v[136:139], v[224:227], v[4:7], v[136:139]
  v_mfma_f32_16x16x32_bf16 v[168:171], v[228:231], v[4:7], v[168:171]
  v_mfma_f32_16x16x32_bf16 v[200:203], v[232:235], v[4:7], v[200:203]
  s_waitcnt lgkmcnt(4)
  v_mfma_f32_16x16x32_bf16 v[108:111], v[220:223], v[8:11], v[108:111]
  ds_read_b128 v[4:7], v0 offset:43008
  v_mfma_f32_16x16x32_bf16 v[140:143], v[224:227], v[8:11], v[140:143]
  v_mfma_f32_16x16x32_bf16 v[172:175], v[228:231], v[8:11], v[172:175]
  v_mfma_f32_16x16x32_bf16 v[204:207], v[232:235], v[8:11], v[204:207]
  s_waitcnt lgkmcnt(4)
  v_mfma_f32_16x16x32_bf16 v[112:115], v[220:223], v[12:15], v[112:115]
  ds_read_b128 v[8:11], v0 offset:44032
  v_mfma_f32_16x16x32_bf16 v[144:147], v[224:227], v[12:15], v[144:147]
  v_mfma_f32_16x16x32_bf16 v[176:179], v[228:231], v[12:15], v[176:179]
  v_mfma_f32_16x16x32_bf16 v[208:211], v[232:235], v[12:15], v[208:211]
  s_waitcnt lgkmcnt(4)
  v_mfma_f32_16x16x32_bf16 v[116:119], v[220:223], v[16:19], v[116:119]
  ds_read_b128 v[12:15], v0 offset:45056
  v_mfma_f32_16x16x32_bf16 v[148:151], v[224:227], v[16:19], v[148:151]
  buffer_load_dwordx4 v[220:223], v0, s[8:11], s28 offen offset:2048
  v_mfma_f32_16x16x32_bf16 v[180:183], v[228:231], v[16:19], v[180:183]
  v_mfma_f32_16x16x32_bf16 v[212:215], v[232:235], v[16:19], v[212:215]
  v_mov_b32 v248, 19
  ds_write_b32 v251, v248
  s_waitcnt vmcnt(15) lgkmcnt(5)
  v_mfma_f32_16x16x32_bf16 v[88:91], v[236:239], v[20:23], v[88:91]
  ds_read_b128 v[16:19], v0 offset:46080
  v_mfma_f32_16x16x32_bf16 v[120:123], v[240:243], v[20:23], v[120:123]
  buffer_load_dwordx4 v[224:227], v0, s[8:11], s28 offen offset:3072
  v_mfma_f32_16x16x32_bf16 v[152:155], v[28:31], v[20:23], v[152:155]
  v_mfma_f32_16x16x32_bf16 v[184:187], v[32:35], v[20:23], v[184:187]
  s_waitcnt lgkmcnt(5)
  v_mfma_f32_16x16x32_bf16 v[92:95], v[236:239], v[24:27], v[92:95]
  ds_read_b128 v[20:23], v0 offset:47104
  v_mfma_f32_16x16x32_bf16 v[124:127], v[240:243], v[24:27], v[124:127]
  s_add_u32 s29, s20, 40960
  buffer_load_dwordx4 v[228:231], v0, s[8:11], s29 offen offset:0
  v_mfma_f32_16x16x32_bf16 v[156:159], v[28:31], v[24:27], v[156:159]
  v_mfma_f32_16x16x32_bf16 v[188:191], v[32:35], v[24:27], v[188:191]
  s_waitcnt lgkmcnt(5)
  v_mfma_f32_16x16x32_bf16 v[96:99], v[236:239], v[4:7], v[96:99]
  ds_read_b128 v[24:27], v0 offset:48128
  v_mfma_f32_16x16x32_bf16 v[128:131], v[240:243], v[4:7], v[128:131]
  buffer_load_dwordx4 v[232:235], v0, s[8:11], s29 offen offset:1024
  v_mfma_f32_16x16x32_bf16 v[160:163], v[28:31], v[4:7], v[160:163]
  v_mfma_f32_16x16x32_bf16 v[192:195], v[32:35], v[4:7], v[192:195]
  s_waitcnt lgkmcnt(5)
  v_mfma_f32_16x16x32_bf16 v[100:103], v[236:239], v[8:11], v[100:103]
  ds_read_b128 v[4:7], v0 offset:49152
  v_mfma_f32_16x16x32_bf16 v[132:135], v[240:243], v[8:11], v[132:135]
  v_mfma_f32_16x16x32_bf16 v[164:167], v[28:31], v[8:11], v[164:167]
  v_mfma_f32_16x16x32_bf16 v[196:199], v[32:35], v[8:11], v[196:199]
  s_waitcnt lgkmcnt(5)
  v_mfma_f32_16x16x32_bf16 v[104:107], v[236:239], v[12:15], v[104:107]
  ds_read_b128 v[8:11], v0 offset:50176
  v_mfma_f32_16x16x32_bf16 v[136:139], v[240:243], v[12:15], v[136:139]
  v_mfma_f32_16x16x32_bf16 v[168:171], v[28:31], v[12:15], v[168:171]
  v_mfma_f32_16x16x32_bf16 v[200:203], v[32:35], v[12:15], v[200:203]
  s_waitcnt lgkmcnt(4)
  v_mfma_f32_16x16x32_bf16 v[108:111], v[236:239], v[16:19], v[108:111]
  ds_read_b128 v[12:15], v0 offset:51200
  v_mfma_f32_16x16x32_bf16 v[140:143], v[240:243], v[16:19], v[140:143]
  v_mfma_f32_16x16x32_bf16 v[172:175], v[28:31], v[16:19], v[172:175]
  v_mfma_f32_16x16x32_bf16 v[204:207], v[32:35], v[16:19], v[204:207]
  s_waitcnt lgkmcnt(4)
  v_mfma_f32_16x16x32_bf16 v[112:115], v[236:239], v[20:23], v[112:115]
  ds_read_b128 v[16:19], v0 offset:52224
  v_mfma_f32_16x16x32_bf16 v[144:147], v[240:243], v[20:23], v[144:147]
  v_mfma_f32_16x16x32_bf16 v[176:179], v[28:31], v[20:23], v[176:179]
  v_mfma_f32_16x16x32_bf16 v[208:211], v[32:35], v[20:23], v[208:211]
  s_waitcnt lgkmcnt(4)
  v_mfma_f32_16x16x32_bf16 v[116:119], v[236:239], v[24:27], v[116:119]
  ds_read_b128 v[20:23], v0 offset:53248
  v_mfma_f32_16x16x32_bf16 v[148:151], v[240:243], v[24:27], v[148:151]
  buffer_load_dwordx4 v[236:239], v0, s[8:11], s29 offen offset:2048
  v_mfma_f32_16x16x32_bf16 v[180:183], v[28:31], v[24:27], v[180:183]
  v_mfma_f32_16x16x32_bf16 v[212:215], v[32:35], v[24:27], v[212:215]
  s_waitcnt vmcnt(15) lgkmcnt(4)
  v_mfma_f32_16x16x32_bf16 v[88:91], v[36:39], v[4:7], v[88:91]
  ds_read_b128 v[24:27], v0 offset:54272
  v_mfma_f32_16x16x32_bf16 v[120:123], v[40:43], v[4:7], v[120:123]
  buffer_load_dwordx4 v[240:243], v0, s[8:11], s29 offen offset:3072
  v_mfma_f32_16x16x32_bf16 v[152:155], v[44:47], v[4:7], v[152:155]
  v_mfma_f32_16x16x32_bf16 v[184:187], v[48:51], v[4:7], v[184:187]
  s_waitcnt lgkmcnt(4)
  v_mfma_f32_16x16x32_bf16 v[92:95], v[36:39], v[8:11], v[92:95]
  ds_read_b128 v[4:7], v0 offset:55296
  v_mfma_f32_16x16x32_bf16 v[124:127], v[40:43], v[8:11], v[124:127]
  s_add_u32 s28, s20, 45056
  buffer_load_dwordx4 v[28:31], v0, s[8:11], s28 offen offset:0
  v_mfma_f32_16x16x32_bf16 v[156:159], v[44:47], v[8:11], v[156:159]
  v_mfma_f32_16x16x32_bf16 v[188:191], v[48:51], v[8:11], v[188:191]
  s_waitcnt lgkmcnt(4)
  v_mfma_f32_16x16x32_bf16 v[96:99], v[36:39], v[12:15], v[96:99]
  ds_read_b128 v[8:11], v0 offset:56320
  v_mfma_f32_16x16x32_bf16 v[128:131], v[40:43], v[12:15], v[128:131]
  buffer_load_dwordx4 v[32:35], v0, s[8:11], s28 offen offset:1024
  v_mfma_f32_16x16x32_bf16 v[160:163], v[44:47], v[12:15], v[160:163]
  v_mfma_f32_16x16x32_bf16 v[192:195], v[48:51], v[12:15], v[192:195]
  s_waitcnt lgkmcnt(4)
  v_mfma_f32_16x16x32_bf16 v[100:103], v[36:39], v[16:19], v[100:103]
  ds_read_b128 v[12:15], v0 offset:57344
  v_mfma_f32_16x16x32_bf16 v[132:135], v[40:43], v[16:19], v[132:135]
  v_mfma_f32_16x16x32_bf16 v[164:167], v[44:47], v[16:19], v[164:167]
  v_mfma_f32_16x16x32_bf16 v[196:199], v[48:51], v[16:19], v[196:199]
  s_waitcnt lgkmcnt(4)
  v_mfma_f32_16x16x32_bf16 v[104:107], v[36:39], v[20:23], v[104:107]
  ds_read_b128 v[16:19], v0 offset:58368
  v_mfma_f32_16x16x32_bf16 v[136:139], v[40:43], v[20:23], v[136:139]
  v_mfma_f32_16x16x32_bf16 v[168:171], v[44:47], v[20:23], v[168:171]
  v_mfma_f32_16x16x32_bf16 v[200:203], v[48:51], v[20:23], v[200:203]
  s_waitcnt lgkmcnt(4)
  v_mfma_f32_16x16x32_bf16 v[108:111], v[36:39], v[24:27], v[108:111]
  ds_read_b128 v[20:23], v0 offset:59392
  v_mfma_f32_16x16x32_bf16 v[140:143], v[40:43], v[24:27], v[140:143]
  v_mfma_f32_16x16x32_bf16 v[172:175], v[44:47], v[24:27], v[172:175]
  v_mfma_f32_16x16x32_bf16 v[204:207], v[48:51], v[24:27], v[204:207]
  s_waitcnt lgkmcnt(4)
  v_mfma_f32_16x16x32_bf16 v[112:115], v[36:39], v[4:7], v[112:115]
  ds_read_b128 v[24:27], v0 offset:60416
  v_mfma_f32_16x16x32_bf16 v[144:147], v[40:43], v[4:7], v[144:147]
  v_mfma_f32_16x16x32_bf16 v[176:179], v[44:47], v[4:7], v[176:179]
  v_mfma_f32_16x16x32_bf16 v[208:211], v[48:51], v[4:7], v[208:211]
  s_waitcnt lgkmcnt(4)
  v_mfma_f32_16x16x32_bf16 v[116:119], v[36:39], v[8:11], v[116:119]
  ds_read_b128 v[4:7], v0 offset:61440
  v_mfma_f32_16x16x32_bf16 v[148:151], v[40:43], v[8:11], v[148:151]
  buffer_load_dwordx4 v[36:39], v0, s[8:11], s28 offen offset:2048
  v_mfma_f32_16x16x32_bf16 v[180:183], v[44:47], v[8:11], v[180:183]
  v_mfma_f32_16x16x32_bf16 v[212:215], v[48:51], v[8:11], v[212:215]
  s_waitcnt vmcnt(15) lgkmcnt(4)
  v_mfma_f32_16x16x32_bf16 v[88:91], v[52:55], v[12:15], v[88:91]
  ds_read_b128 v[8:11], v0 offset:62464
  v_mfma_f32_16x16x32_bf16 v[120:123], v[56:59], v[12:15], v[120:123]
  buffer_load_dwordx4 v[40:43], v0, s[8:11], s28 offen offset:3072
  v_mfma_f32_16x16x32_bf16 v[152:155], v[60:63], v[12:15], v[152:155]
  v_mfma_f32_16x16x32_bf16 v[184:187], v[64:67], v[12:15], v[184:187]
  s_waitcnt lgkmcnt(4)
  v_mfma_f32_16x16x32_bf16 v[92:95], v[52:55], v[16:19], v[92:95]
  ds_read_b128 v[12:15], v0 offset:63488
  v_mfma_f32_16x16x32_bf16 v[124:127], v[56:59], v[16:19], v[124:127]
  s_add_u32 s29, s20, 49152
  buffer_load_dwordx4 v[44:47], v0, s[8:11], s29 offen offset:0
  v_mfma_f32_16x16x32_bf16 v[156:159], v[60:63], v[16:19], v[156:159]
  v_mfma_f32_16x16x32_bf16 v[188:191], v[64:67], v[16:19], v[188:191]
  s_waitcnt lgkmcnt(4)
  v_mfma_f32_16x16x32_bf16 v[96:99], v[52:55], v[20:23], v[96:99]
  ds_read_b128 v[16:19], v0 offset:64512
  v_mfma_f32_16x16x32_bf16 v[128:131], v[56:59], v[20:23], v[128:131]
  buffer_load_dwordx4 v[48:51], v0, s[8:11], s29 offen offset:1024
  v_mfma_f32_16x16x32_bf16 v[160:163], v[60:63], v[20:23], v[160:163]
  v_mfma_f32_16x16x32_bf16 v[192:195], v[64:67], v[20:23], v[192:195]
  s_waitcnt lgkmcnt(4)
  v_mfma_f32_16x16x32_bf16 v[100:103], v[52:55], v[24:27], v[100:103]
  ds_read_b128 v[20:23], v1 offset:0
  v_mfma_f32_16x16x32_bf16 v[132:135], v[56:59], v[24:27], v[132:135]
  v_mfma_f32_16x16x32_bf16 v[164:167], v[60:63], v[24:27], v[164:167]
  v_mfma_f32_16x16x32_bf16 v[196:199], v[64:67], v[24:27], v[196:199]
  s_waitcnt lgkmcnt(4)
  v_mfma_f32_16x16x32_bf16 v[104:107], v[52:55], v[4:7], v[104:107]
  ds_read_b128 v[24:27], v1 offset:1024
  v_mfma_f32_16x16x32_bf16 v[136:139], v[56:59], v[4:7], v[136:139]
  v_mfma_f32_16x16x32_bf16 v[168:171], v[60:63], v[4:7], v[168:171]
  v_mfma_f32_16x16x32_bf16 v[200:203], v[64:67], v[4:7], v[200:203]
  s_waitcnt lgkmcnt(4)
  v_mfma_f32_16x16x32_bf16 v[108:111], v[52:55], v[8:11], v[108:111]
  ds_read_b128 v[4:7], v1 offset:2048
  v_mfma_f32_16x16x32_bf16 v[140:143], v[56:59], v[8:11], v[140:143]
  v_mfma_f32_16x16x32_bf16 v[172:175], v[60:63], v[8:11], v[172:175]
  v_mfma_f32_16x16x32_bf16 v[204:207], v[64:67], v[8:11], v[204:207]
  s_waitcnt lgkmcnt(4)
  v_mfma_f32_16x16x32_bf16 v[112:115], v[52:55], v[12:15], v[112:115]
  ds_read_b128 v[8:11], v1 offset:3072
  v_mfma_f32_16x16x32_bf16 v[144:147], v[56:59], v[12:15], v[144:147]
  v_mfma_f32_16x16x32_bf16 v[176:179], v[60:63], v[12:15], v[176:179]
  v_mfma_f32_16x16x32_bf16 v[208:211], v[64:67], v[12:15], v[208:211]
  s_waitcnt lgkmcnt(4)
  v_mfma_f32_16x16x32_bf16 v[116:119], v[52:55], v[16:19], v[116:119]
  ds_read_b128 v[12:15], v1 offset:4096
  v_mfma_f32_16x16x32_bf16 v[148:151], v[56:59], v[16:19], v[148:151]
  buffer_load_dwordx4 v[52:55], v0, s[8:11], s29 offen offset:2048
  v_mfma_f32_16x16x32_bf16 v[180:183], v[60:63], v[16:19], v[180:183]
  v_mfma_f32_16x16x32_bf16 v[212:215], v[64:67], v[16:19], v[212:215]
  s_waitcnt vmcnt(15) lgkmcnt(4)
  v_mfma_f32_16x16x32_bf16 v[88:91], v[68:71], v[20:23], v[88:91]
  ds_read_b128 v[16:19], v1 offset:5120
  v_mfma_f32_16x16x32_bf16 v[120:123], v[72:75], v[20:23], v[120:123]
  buffer_load_dwordx4 v[56:59], v0, s[8:11], s29 offen offset:3072
  v_mfma_f32_16x16x32_bf16 v[152:155], v[76:79], v[20:23], v[152:155]
  v_mfma_f32_16x16x32_bf16 v[184:187], v[80:83], v[20:23], v[184:187]
  s_waitcnt lgkmcnt(4)
  v_mfma_f32_16x16x32_bf16 v[92:95], v[68:71], v[24:27], v[92:95]
  ds_read_b128 v[20:23], v1 offset:6144
  v_mfma_f32_16x16x32_bf16 v[124:127], v[72:75], v[24:27], v[124:127]
  s_add_u32 s28, s20, 53248
  buffer_load_dwordx4 v[60:63], v0, s[8:11], s28 offen offset:0
  v_mfma_f32_16x16x32_bf16 v[156:159], v[76:79], v[24:27], v[156:159]
  v_mfma_f32_16x16x32_bf16 v[188:191], v[80:83], v[24:27], v[188:191]
  s_waitcnt lgkmcnt(4)
  v_mfma_f32_16x16x32_bf16 v[96:99], v[68:71], v[4:7], v[96:99]
  ds_read_b128 v[24:27], v1 offset:7168
  v_mfma_f32_16x16x32_bf16 v[128:131], v[72:75], v[4:7], v[128:131]
  buffer_load_dwordx4 v[64:67], v0, s[8:11], s28 offen offset:1024
  v_mfma_f32_16x16x32_bf16 v[160:163], v[76:79], v[4:7], v[160:163]
  v_mfma_f32_16x16x32_bf16 v[192:195], v[80:83], v[4:7], v[192:195]
  s_waitcnt lgkmcnt(4)
  v_mfma_f32_16x16x32_bf16 v[100:103], v[68:71], v[8:11], v[100:103]
  ds_read_b128 v[4:7], v1 offset:8192
  v_mfma_f32_16x16x32_bf16 v[132:135], v[72:75], v[8:11], v[132:135]
  v_mfma_f32_16x16x32_bf16 v[164:167], v[76:79], v[8:11], v[164:167]
  v_mfma_f32_16x16x32_bf16 v[196:199], v[80:83], v[8:11], v[196:199]
  s_waitcnt lgkmcnt(4)
  v_mfma_f32_16x16x32_bf16 v[104:107], v[68:71], v[12:15], v[104:107]
  ds_read_b128 v[8:11], v1 offset:9216
  v_mfma_f32_16x16x32_bf16 v[136:139], v[72:75], v[12:15], v[136:139]
  v_mfma_f32_16x16x32_bf16 v[168:171], v[76:79], v[12:15], v[168:171]
  v_mfma_f32_16x16x32_bf16 v[200:203], v[80:83], v[12:15], v[200:203]
  s_waitcnt lgkmcnt(4)
  v_mfma_f32_16x16x32_bf16 v[108:111], v[68:71], v[16:19], v[108:111]
  ds_read_b128 v[12:15], v1 offset:10240
  v_mfma_f32_16x16x32_bf16 v[140:143], v[72:75], v[16:19], v[140:143]
  v_mfma_f32_16x16x32_bf16 v[172:175], v[76:79], v[16:19], v[172:175]
  v_mfma_f32_16x16x32_bf16 v[204:207], v[80:83], v[16:19], v[204:207]
  s_waitcnt lgkmcnt(4)
  v_mfma_f32_16x16x32_bf16 v[112:115], v[68:71], v[20:23], v[112:115]
  ds_read_b128 v[16:19], v1 offset:11264
  v_mfma_f32_16x16x32_bf16 v[144:147], v[72:75], v[20:23], v[144:147]
  v_mfma_f32_16x16x32_bf16 v[176:179], v[76:79], v[20:23], v[176:179]
  v_mfma_f32_16x16x32_bf16 v[208:211], v[80:83], v[20:23], v[208:211]
  s_waitcnt lgkmcnt(4)
  v_mfma_f32_16x16x32_bf16 v[116:119], v[68:71], v[24:27], v[116:119]
  ds_read_b128 v[20:23], v1 offset:12288
  v_mfma_f32_16x16x32_bf16 v[148:151], v[72:75], v[24:27], v[148:151]
  buffer_load_dwordx4 v[68:71], v0, s[8:11], s28 offen offset:2048
  v_mfma_f32_16x16x32_bf16 v[180:183], v[76:79], v[24:27], v[180:183]
  v_mfma_f32_16x16x32_bf16 v[212:215], v[80:83], v[24:27], v[212:215]
  s_waitcnt vmcnt(15) lgkmcnt(4)
  v_mfma_f32_16x16x32_bf16 v[88:91], v[84:87], v[4:7], v[88:91]
  ds_read_b128 v[24:27], v1 offset:13312
  v_mfma_f32_16x16x32_bf16 v[120:123], v[216:219], v[4:7], v[120:123]
  buffer_load_dwordx4 v[72:75], v0, s[8:11], s28 offen offset:3072
  v_mfma_f32_16x16x32_bf16 v[152:155], v[220:223], v[4:7], v[152:155]
  v_mfma_f32_16x16x32_bf16 v[184:187], v[224:227], v[4:7], v[184:187]
  s_waitcnt lgkmcnt(4)
  v_mfma_f32_16x16x32_bf16 v[92:95], v[84:87], v[8:11], v[92:95]
  ds_read_b128 v[4:7], v1 offset:14336
  v_mfma_f32_16x16x32_bf16 v[124:127], v[216:219], v[8:11], v[124:127]
  s_add_u32 s29, s20, 57344
  buffer_load_dwordx4 v[76:79], v0, s[8:11], s29 offen offset:0
  v_mfma_f32_16x16x32_bf16 v[156:159], v[220:223], v[8:11], v[156:159]
  v_mfma_f32_16x16x32_bf16 v[188:191], v[224:227], v[8:11], v[188:191]
  s_waitcnt lgkmcnt(4)
  v_mfma_f32_16x16x32_bf16 v[96:99], v[84:87], v[12:15], v[96:99]
  ds_read_b128 v[8:11], v1 offset:15360
  v_mfma_f32_16x16x32_bf16 v[128:131], v[216:219], v[12:15], v[128:131]
  buffer_load_dwordx4 v[80:83], v0, s[8:11], s29 offen offset:1024
  v_mfma_f32_16x16x32_bf16 v[160:163], v[220:223], v[12:15], v[160:163]
  v_mfma_f32_16x16x32_bf16 v[192:195], v[224:227], v[12:15], v[192:195]
  s_waitcnt lgkmcnt(4)
  v_mfma_f32_16x16x32_bf16 v[100:103], v[84:87], v[16:19], v[100:103]
  ds_read_b128 v[12:15], v1 offset:16384
  v_mfma_f32_16x16x32_bf16 v[132:135], v[216:219], v[16:19], v[132:135]
  v_mfma_f32_16x16x32_bf16 v[164:167], v[220:223], v[16:19], v[164:167]
  v_mfma_f32_16x16x32_bf16 v[196:199], v[224:227], v[16:19], v[196:199]
  s_waitcnt lgkmcnt(4)
  v_mfma_f32_16x16x32_bf16 v[104:107], v[84:87], v[20:23], v[104:107]
  ds_read_b128 v[16:19], v1 offset:17408
  v_mfma_f32_16x16x32_bf16 v[136:139], v[216:219], v[20:23], v[136:139]
  v_mfma_f32_16x16x32_bf16 v[168:171], v[220:223], v[20:23], v[168:171]
  v_mfma_f32_16x16x32_bf16 v[200:203], v[224:227], v[20:23], v[200:203]
  s_waitcnt lgkmcnt(4)
  v_mfma_f32_16x16x32_bf16 v[108:111], v[84:87], v[24:27], v[108:111]
  ds_read_b128 v[20:23], v1 offset:18432
  v_mfma_f32_16x16x32_bf16 v[140:143], v[216:219], v[24:27], v[140:143]
  v_mfma_f32_16x16x32_bf16 v[172:175], v[220:223], v[24:27], v[172:175]
  v_mfma_f32_16x16x32_bf16 v[204:207], v[224:227], v[24:27], v[204:207]
  s_waitcnt lgkmcnt(4)
  v_mfma_f32_16x16x32_bf16 v[112:115], v[84:87], v[4:7], v[112:115]
  ds_read_b128 v[24:27], v1 offset:19456
  v_mfma_f32_16x16x32_bf16 v[144:147], v[216:219], v[4:7], v[144:147]
  v_mfma_f32_16x16x32_bf16 v[176:179], v[220:223], v[4:7], v[176:179]
  v_mfma_f32_16x16x32_bf16 v[208:211], v[224:227], v[4:7], v[208:211]
  s_waitcnt lgkmcnt(4)
  v_mfma_f32_16x16x32_bf16 v[116:119], v[84:87], v[8:11], v[116:119]
  ds_read_b128 v[4:7], v1 offset:20480
  v_mfma_f32_16x16x32_bf16 v[148:151], v[216:219], v[8:11], v[148:151]
  buffer_load_dwordx4 v[84:87], v0, s[8:11], s29 offen offset:2048
  v_mfma_f32_16x16x32_bf16 v[180:183], v[220:223], v[8:11], v[180:183]
  v_mfma_f32_16x16x32_bf16 v[212:215], v[224:227], v[8:11], v[212:215]
  v_mov_b32 v248, 20
  ds_write_b32 v251, v248
  s_waitcnt vmcnt(15) lgkmcnt(5)
  v_mfma_f32_16x16x32_bf16 v[88:91], v[228:231], v[12:15], v[88:91]
  ds_read_b128 v[8:11], v1 offset:21504
  v_mfma_f32_16x16x32_bf16 v[120:123], v[232:235], v[12:15], v[120:123]
  buffer_load_dwordx4 v[216:219], v0, s[8:11], s29 offen offset:3072
  v_mfma_f32_16x16x32_bf16 v[152:155], v[236:239], v[12:15], v[152:155]
  v_mfma_f32_16x16x32_bf16 v[184:187], v[240:243], v[12:15], v[184:187]
  s_waitcnt lgkmcnt(5)
  v_mfma_f32_16x16x32_bf16 v[92:95], v[228:231], v[16:19], v[92:95]
  ds_read_b128 v[12:15], v1 offset:22528
  v_mfma_f32_16x16x32_bf16 v[124:127], v[232:235], v[16:19], v[124:127]
  s_add_u32 s28, s20, 61440
  buffer_load_dwordx4 v[220:223], v0, s[8:11], s28 offen offset:0
  v_mfma_f32_16x16x32_bf16 v[156:159], v[236:239], v[16:19], v[156:159]
  v_mfma_f32_16x16x32_bf16 v[188:191], v[240:243], v[16:19], v[188:191]
  s_waitcnt lgkmcnt(5)
  v_mfma_f32_16x16x32_bf16 v[96:99], v[228:231], v[20:23], v[96:99]
  ds_read_b128 v[16:19], v1 offset:23552
  v_mfma_f32_16x16x32_bf16 v[128:131], v[232:235], v[20:23], v[128:131]
  buffer_load_dwordx4 v[224:227], v0, s[8:11], s28 offen offset:1024
  v_mfma_f32_16x16x32_bf16 v[160:163], v[236:239], v[20:23], v[160:163]
  v_mfma_f32_16x16x32_bf16 v[192:195], v[240:243], v[20:23], v[192:195]
  s_waitcnt lgkmcnt(5)
  v_mfma_f32_16x16x32_bf16 v[100:103], v[228:231], v[24:27], v[100:103]
  ds_read_b128 v[20:23], v1 offset:24576
  v_mfma_f32_16x16x32_bf16 v[132:135], v[232:235], v[24:27], v[132:135]
  v_mfma_f32_16x16x32_bf16 v[164:167], v[236:239], v[24:27], v[164:167]
  v_mfma_f32_16x16x32_bf16 v[196:199], v[240:243], v[24:27], v[196:199]
  s_waitcnt lgkmcnt(5)
  v_mfma_f32_16x16x32_bf16 v[104:107], v[228:231], v[4:7], v[104:107]
  ds_read_b128 v[24:27], v1 offset:25600
  v_mfma_f32_16x16x32_bf16 v[136:139], v[232:235], v[4:7], v[136:139]
  v_mfma_f32_16x16x32_bf16 v[168:171], v[236:239], v[4:7], v[168:171]
  v_mfma_f32_16x16x32_bf16 v[200:203], v[240:243], v[4:7], v[200:203]
  s_waitcnt lgkmcnt(4)
  v_mfma_f32_16x16x32_bf16 v[108:111], v[228:231], v[8:11], v[108:111]
  ds_read_b128 v[4:7], v1 offset:26624
  v_mfma_f32_16x16x32_bf16 v[140:143], v[232:235], v[8:11], v[140:143]
  v_mfma_f32_16x16x32_bf16 v[172:175], v[236:239], v[8:11], v[172:175]
  v_mfma_f32_16x16x32_bf16 v[204:207], v[240:243], v[8:11], v[204:207]
  s_waitcnt lgkmcnt(4)
  v_mfma_f32_16x16x32_bf16 v[112:115], v[228:231], v[12:15], v[112:115]
  ds_read_b128 v[8:11], v1 offset:27648
  v_mfma_f32_16x16x32_bf16 v[144:147], v[232:235], v[12:15], v[144:147]
  v_mfma_f32_16x16x32_bf16 v[176:179], v[236:239], v[12:15], v[176:179]
  v_mfma_f32_16x16x32_bf16 v[208:211], v[240:243], v[12:15], v[208:211]
  s_waitcnt lgkmcnt(4)
  v_mfma_f32_16x16x32_bf16 v[116:119], v[228:231], v[16:19], v[116:119]
  ds_read_b128 v[12:15], v1 offset:28672
  v_mfma_f32_16x16x32_bf16 v[148:151], v[232:235], v[16:19], v[148:151]
  buffer_load_dwordx4 v[228:231], v0, s[8:11], s28 offen offset:2048
  v_mfma_f32_16x16x32_bf16 v[180:183], v[236:239], v[16:19], v[180:183]
  v_mfma_f32_16x16x32_bf16 v[212:215], v[240:243], v[16:19], v[212:215]
  s_waitcnt vmcnt(15) lgkmcnt(4)
  v_mfma_f32_16x16x32_bf16 v[88:91], v[28:31], v[20:23], v[88:91]
  ds_read_b128 v[16:19], v1 offset:29696
  v_mfma_f32_16x16x32_bf16 v[120:123], v[32:35], v[20:23], v[120:123]
  buffer_load_dwordx4 v[232:235], v0, s[8:11], s28 offen offset:3072
  v_mfma_f32_16x16x32_bf16 v[152:155], v[36:39], v[20:23], v[152:155]
  v_mfma_f32_16x16x32_bf16 v[184:187], v[40:43], v[20:23], v[184:187]
  s_waitcnt lgkmcnt(4)
  v_mfma_f32_16x16x32_bf16 v[92:95], v[28:31], v[24:27], v[92:95]
  ds_read_b128 v[20:23], v1 offset:30720
  v_mfma_f32_16x16x32_bf16 v[124:127], v[32:35], v[24:27], v[124:127]
  s_add_u32 s29, s20, 65536
  buffer_load_dwordx4 v[236:239], v0, s[8:11], s29 offen offset:0
  v_mfma_f32_16x16x32_bf16 v[156:159], v[36:39], v[24:27], v[156:159]
  v_mfma_f32_16x16x32_bf16 v[188:191], v[40:43], v[24:27], v[188:191]
  s_waitcnt lgkmcnt(4)
  v_mfma_f32_16x16x32_bf16 v[96:99], v[28:31], v[4:7], v[96:99]
  ds_read_b128 v[24:27], v1 offset:31744
  v_mfma_f32_16x16x32_bf16 v[128:131], v[32:35], v[4:7], v[128:131]
  buffer_load_dwordx4 v[240:243], v0, s[8:11], s29 offen offset:1024
  v_mfma_f32_16x16x32_bf16 v[160:163], v[36:39], v[4:7], v[160:163]
  v_mfma_f32_16x16x32_bf16 v[192:195], v[40:43], v[4:7], v[192:195]
  s_waitcnt lgkmcnt(4)
  v_mfma_f32_16x16x32_bf16 v[100:103], v[28:31], v[8:11], v[100:103]
  ds_read_b128 v[4:7], v1 offset:32768
  v_mfma_f32_16x16x32_bf16 v[132:135], v[32:35], v[8:11], v[132:135]
  v_mfma_f32_16x16x32_bf16 v[164:167], v[36:39], v[8:11], v[164:167]
  v_mfma_f32_16x16x32_bf16 v[196:199], v[40:43], v[8:11], v[196:199]
  s_waitcnt lgkmcnt(4)
  v_mfma_f32_16x16x32_bf16 v[104:107], v[28:31], v[12:15], v[104:107]
  ds_read_b128 v[8:11], v1 offset:33792
  v_mfma_f32_16x16x32_bf16 v[136:139], v[32:35], v[12:15], v[136:139]
  v_mfma_f32_16x16x32_bf16 v[168:171], v[36:39], v[12:15], v[168:171]
  v_mfma_f32_16x16x32_bf16 v[200:203], v[40:43], v[12:15], v[200:203]
  s_waitcnt lgkmcnt(4)
  v_mfma_f32_16x16x32_bf16 v[108:111], v[28:31], v[16:19], v[108:111]
  ds_read_b128 v[12:15], v1 offset:34816
  v_mfma_f32_16x16x32_bf16 v[140:143], v[32:35], v[16:19], v[140:143]
  v_mfma_f32_16x16x32_bf16 v[172:175], v[36:39], v[16:19], v[172:175]
  v_mfma_f32_16x16x32_bf16 v[204:207], v[40:43], v[16:19], v[204:207]
  s_waitcnt lgkmcnt(4)
  v_mfma_f32_16x16x32_bf16 v[112:115], v[28:31], v[20:23], v[112:115]
  ds_read_b128 v[16:19], v1 offset:35840
  v_mfma_f32_16x16x32_bf16 v[144:147], v[32:35], v[20:23], v[144:147]
  v_mfma_f32_16x16x32_bf16 v[176:179], v[36:39], v[20:23], v[176:179]
  v_mfma_f32_16x16x32_bf16 v[208:211], v[40:43], v[20:23], v[208:211]
  s_waitcnt lgkmcnt(4)
  v_mfma_f32_16x16x32_bf16 v[116:119], v[28:31], v[24:27], v[116:119]
  ds_read_b128 v[20:23], v1 offset:36864
  v_mfma_f32_16x16x32_bf16 v[148:151], v[32:35], v[24:27], v[148:151]
  buffer_load_dwordx4 v[28:31], v0, s[8:11], s29 offen offset:2048
  v_mfma_f32_16x16x32_bf16 v[180:183], v[36:39], v[24:27], v[180:183]
  v_mfma_f32_16x16x32_bf16 v[212:215], v[40:43], v[24:27], v[212:215]
  s_waitcnt vmcnt(15) lgkmcnt(4)
  v_mfma_f32_16x16x32_bf16 v[88:91], v[44:47], v[4:7], v[88:91]
  ds_read_b128 v[24:27], v1 offset:37888
  v_mfma_f32_16x16x32_bf16 v[120:123], v[48:51], v[4:7], v[120:123]
  buffer_load_dwordx4 v[32:35], v0, s[8:11], s29 offen offset:3072
  v_mfma_f32_16x16x32_bf16 v[152:155], v[52:55], v[4:7], v[152:155]
  v_mfma_f32_16x16x32_bf16 v[184:187], v[56:59], v[4:7], v[184:187]
  s_waitcnt lgkmcnt(4)
  v_mfma_f32_16x16x32_bf16 v[92:95], v[44:47], v[8:11], v[92:95]
  ds_read_b128 v[4:7], v1 offset:38912
  v_mfma_f32_16x16x32_bf16 v[124:127], v[48:51], v[8:11], v[124:127]
  s_add_u32 s28, s20, 69632
  buffer_load_dwordx4 v[36:39], v0, s[8:11], s28 offen offset:0
  v_mfma_f32_16x16x32_bf16 v[156:159], v[52:55], v[8:11], v[156:159]
  v_mfma_f32_16x16x32_bf16 v[188:191], v[56:59], v[8:11], v[188:191]
  s_waitcnt lgkmcnt(4)
  v_mfma_f32_16x16x32_bf16 v[96:99], v[44:47], v[12:15], v[96:99]
  ds_read_b128 v[8:11], v1 offset:39936
  v_mfma_f32_16x16x32_bf16 v[128:131], v[48:51], v[12:15], v[128:131]
  buffer_load_dwordx4 v[40:43], v0, s[8:11], s28 offen offset:1024
  v_mfma_f32_16x16x32_bf16 v[160:163], v[52:55], v[12:15], v[160:163]
  v_mfma_f32_16x16x32_bf16 v[192:195], v[56:59], v[12:15], v[192:195]
  s_waitcnt lgkmcnt(4)
  v_mfma_f32_16x16x32_bf16 v[100:103], v[44:47], v[16:19], v[100:103]
  ds_read_b128 v[12:15], v1 offset:40960
  v_mfma_f32_16x16x32_bf16 v[132:135], v[48:51], v[16:19], v[132:135]
  v_mfma_f32_16x16x32_bf16 v[164:167], v[52:55], v[16:19], v[164:167]
  v_mfma_f32_16x16x32_bf16 v[196:199], v[56:59], v[16:19], v[196:199]
  s_waitcnt lgkmcnt(4)
  v_mfma_f32_16x16x32_bf16 v[104:107], v[44:47], v[20:23], v[104:107]
  ds_read_b128 v[16:19], v1 offset:41984
  v_mfma_f32_16x16x32_bf16 v[136:139], v[48:51], v[20:23], v[136:139]
  v_mfma_f32_16x16x32_bf16 v[168:171], v[52:55], v[20:23], v[168:171]
  v_mfma_f32_16x16x32_bf16 v[200:203], v[56:59], v[20:23], v[200:203]
  s_waitcnt lgkmcnt(4)
  v_mfma_f32_16x16x32_bf16 v[108:111], v[44:47], v[24:27], v[108:111]
  ds_read_b128 v[20:23], v1 offset:43008
  v_mfma_f32_16x16x32_bf16 v[140:143], v[48:51], v[24:27], v[140:143]
  v_mfma_f32_16x16x32_bf16 v[172:175], v[52:55], v[24:27], v[172:175]
  v_mfma_f32_16x16x32_bf16 v[204:207], v[56:59], v[24:27], v[204:207]
  s_waitcnt lgkmcnt(4)
  v_mfma_f32_16x16x32_bf16 v[112:115], v[44:47], v[4:7], v[112:115]
  ds_read_b128 v[24:27], v1 offset:44032
  v_mfma_f32_16x16x32_bf16 v[144:147], v[48:51], v[4:7], v[144:147]
  v_mfma_f32_16x16x32_bf16 v[176:179], v[52:55], v[4:7], v[176:179]
  v_mfma_f32_16x16x32_bf16 v[208:211], v[56:59], v[4:7], v[208:211]
  s_waitcnt lgkmcnt(4)
  v_mfma_f32_16x16x32_bf16 v[116:119], v[44:47], v[8:11], v[116:119]
  ds_read_b128 v[4:7], v1 offset:45056
  v_mfma_f32_16x16x32_bf16 v[148:151], v[48:51], v[8:11], v[148:151]
  buffer_load_dwordx4 v[44:47], v0, s[8:11], s28 offen offset:2048
  v_mfma_f32_16x16x32_bf16 v[180:183], v[52:55], v[8:11], v[180:183]
  v_mfma_f32_16x16x32_bf16 v[212:215], v[56:59], v[8:11], v[212:215]
  s_waitcnt vmcnt(15) lgkmcnt(4)
  v_mfma_f32_16x16x32_bf16 v[88:91], v[60:63], v[12:15], v[88:91]
  ds_read_b128 v[8:11], v1 offset:46080
  v_mfma_f32_16x16x32_bf16 v[120:123], v[64:67], v[12:15], v[120:123]
  buffer_load_dwordx4 v[48:51], v0, s[8:11], s28 offen offset:3072
  v_mfma_f32_16x16x32_bf16 v[152:155], v[68:71], v[12:15], v[152:155]
  v_mfma_f32_16x16x32_bf16 v[184:187], v[72:75], v[12:15], v[184:187]
  s_waitcnt lgkmcnt(4)
  v_mfma_f32_16x16x32_bf16 v[92:95], v[60:63], v[16:19], v[92:95]
  ds_read_b128 v[12:15], v1 offset:47104
  v_mfma_f32_16x16x32_bf16 v[124:127], v[64:67], v[16:19], v[124:127]
  s_add_u32 s29, s22, 0
  buffer_load_dwordx4 v[52:55], v0, s[8:11], s29 offen offset:0
  v_mfma_f32_16x16x32_bf16 v[156:159], v[68:71], v[16:19], v[156:159]
  v_mfma_f32_16x16x32_bf16 v[188:191], v[72:75], v[16:19], v[188:191]
  s_waitcnt lgkmcnt(4)
  v_mfma_f32_16x16x32_bf16 v[96:99], v[60:63], v[20:23], v[96:99]
  ds_read_b128 v[16:19], v1 offset:48128
  v_mfma_f32_16x16x32_bf16 v[128:131], v[64:67], v[20:23], v[128:131]
  buffer_load_dwordx4 v[56:59], v0, s[8:11], s29 offen offset:1024
  v_mfma_f32_16x16x32_bf16 v[160:163], v[68:71], v[20:23], v[160:163]
  v_mfma_f32_16x16x32_bf16 v[192:195], v[72:75], v[20:23], v[192:195]
  s_waitcnt lgkmcnt(4)
  v_mfma_f32_16x16x32_bf16 v[100:103], v[60:63], v[24:27], v[100:103]
  ds_read_b128 v[20:23], v1 offset:49152
  v_mfma_f32_16x16x32_bf16 v[132:135], v[64:67], v[24:27], v[132:135]
  v_mfma_f32_16x16x32_bf16 v[164:167], v[68:71], v[24:27], v[164:167]
  v_mfma_f32_16x16x32_bf16 v[196:199], v[72:75], v[24:27], v[196:199]
  s_waitcnt lgkmcnt(4)
  v_mfma_f32_16x16x32_bf16 v[104:107], v[60:63], v[4:7], v[104:107]
  ds_read_b128 v[24:27], v1 offset:57344
  v_mfma_f32_16x16x32_bf16 v[136:139], v[64:67], v[4:7], v[136:139]
  v_mfma_f32_16x16x32_bf16 v[168:171], v[68:71], v[4:7], v[168:171]
  v_mfma_f32_16x16x32_bf16 v[200:203], v[72:75], v[4:7], v[200:203]
  s_waitcnt lgkmcnt(4)
  v_mfma_f32_16x16x32_bf16 v[108:111], v[60:63], v[8:11], v[108:111]
  ds_read_b128 v[4:7], v2 offset:0
  v_mfma_f32_16x16x32_bf16 v[140:143], v[64:67], v[8:11], v[140:143]
  v_mfma_f32_16x16x32_bf16 v[172:175], v[68:71], v[8:11], v[172:175]
  v_mfma_f32_16x16x32_bf16 v[204:207], v[72:75], v[8:11], v[204:207]
  s_waitcnt lgkmcnt(4)
  v_mfma_f32_16x16x32_bf16 v[112:115], v[60:63], v[12:15], v[112:115]
  ds_read_b128 v[8:11], v2 offset:8192
  v_mfma_f32_16x16x32_bf16 v[144:147], v[64:67], v[12:15], v[144:147]
  v_mfma_f32_16x16x32_bf16 v[176:179], v[68:71], v[12:15], v[176:179]
  v_mfma_f32_16x16x32_bf16 v[208:211], v[72:75], v[12:15], v[208:211]
  s_waitcnt lgkmcnt(4)
  v_mfma_f32_16x16x32_bf16 v[116:119], v[60:63], v[16:19], v[116:119]
  ds_read_b128 v[12:15], v1 offset:50176
  v_mfma_f32_16x16x32_bf16 v[148:151], v[64:67], v[16:19], v[148:151]
  s_add_u32 s28, s22, 36864
  buffer_load_dwordx4 v[60:63], v0, s[8:11], s28 offen offset:0
  v_mfma_f32_16x16x32_bf16 v[180:183], v[68:71], v[16:19], v[180:183]
  v_mfma_f32_16x16x32_bf16 v[212:215], v[72:75], v[16:19], v[212:215]
  v_mov_b32 v248, 21
  ds_write_b32 v251, v248
  s_setprio 1
  s_waitcnt vmcnt(15) lgkmcnt(5)
  v_mfma_f32_16x16x32_bf16 v[88:91], v[76:79], v[20:23], v[88:91]
  ds_read_b128 v[16:19], v1 offset:58368
  v_mfma_f32_16x16x32_bf16 v[120:123], v[80:83], v[20:23], v[120:123]
  buffer_load_dwordx4 v[64:67], v0, s[8:11], s28 offen offset:1024
  v_mfma_f32_16x16x32_bf16 v[152:155], v[84:87], v[20:23], v[152:155]
  v_mfma_f32_16x16x32_bf16 v[184:187], v[216:219], v[20:23], v[184:187]
  s_waitcnt vmcnt(12) lgkmcnt(5)
  v_mfma_f32_16x16x32_bf16 v[88:91], v[220:223], v[24:27], v[88:91]
  ds_read_b128 v[20:23], v2 offset:1024
  v_mfma_f32_16x16x32_bf16 v[120:123], v[224:227], v[24:27], v[120:123]
  s_add_u32 s29, s22, 73728
  buffer_load_dwordx4 v[68:71], v0, s[8:11], s29 offen offset:0
  v_mfma_f32_16x16x32_bf16 v[152:155], v[228:231], v[24:27], v[152:155]
  v_mfma_f32_16x16x32_bf16 v[184:187], v[232:235], v[24:27], v[184:187]
  s_waitcnt vmcnt(9) lgkmcnt(5)
  v_mfma_f32_16x16x32_bf16 v[88:91], v[236:239], v[4:7], v[88:91]
  ds_read_b128 v[24:27], v2 offset:9216
  v_mfma_f32_16x16x32_bf16 v[120:123], v[240:243], v[4:7], v[120:123]
  buffer_load_dwordx4 v[72:75], v0, s[8:11], s29 offen offset:1024
  v_mfma_f32_16x16x32_bf16 v[152:155], v[28:31], v[4:7], v[152:155]
  v_mfma_f32_16x16x32_bf16 v[184:187], v[32:35], v[4:7], v[184:187]
  s_waitcnt vmcnt(6) lgkmcnt(5)
  v_mfma_f32_16x16x32_bf16 v[88:91], v[36:39], v[8:11], v[88:91]
  ds_read_b128 v[4:7], v1 offset:51200
  v_mfma_f32_16x16x32_bf16 v[120:123], v[40:43], v[8:11], v[120:123]
  v_mfma_f32_16x16x32_bf16 v[152:155], v[44:47], v[8:11], v[152:155]
  v_mfma_f32_16x16x32_bf16 v[184:187], v[48:51], v[8:11], v[184:187]
  s_waitcnt lgkmcnt(5)
  v_mfma_f32_16x16x32_bf16 v[92:95], v[76:79], v[12:15], v[92:95]
  ds_read_b128 v[8:11], v1 offset:59392
  v_mfma_f32_16x16x32_bf16 v[124:127], v[80:83], v[12:15], v[124:127]
  v_fmaak_f32 v244, v88, v88, 0x409d30fc
  v_fmaak_f32 v245, v89, v89, 0x409d30fc
  v_fmaak_f32 v246, v120, v120, 0x409d30fc
  v_fmaak_f32 v247, v121, v121, 0x409d30fc
  v_mfma_f32_16x16x32_bf16 v[156:159], v[84:87], v[12:15], v[156:159]
  v_mul_f32 v90, v88, v90
  v_mul_f32 v91, v89, v91
  v_mul_f32 v122, v120, v122
  v_mul_f32 v123, v121, v123
  v_mfma_f32_16x16x32_bf16 v[188:191], v[216:219], v[12:15], v[188:191]
  v_mul_f32 v88, v244, v88
  v_mul_f32 v89, v245, v89
  v_mul_f32 v120, v246, v120
  v_mul_f32 v121, v247, v121
  s_waitcnt lgkmcnt(4)
  v_mfma_f32_16x16x32_bf16 v[92:95], v[220:223], v[16:19], v[92:95]
  ds_read_b128 v[12:15], v2 offset:2048
  v_exp_f32_e64 v88, -v88
  v_exp_f32_e64 v89, -v89
  v_exp_f32_e64 v120, -v120
  v_exp_f32_e64 v121, -v121
  v_mfma_f32_16x16x32_bf16 v[124:127], v[224:227], v[16:19], v[124:127]
  v_add_f32 v88, 1.0, v88
  v_add_f32 v89, 1.0, v89
  v_add_f32 v120, 1.0, v120
  v_add_f32 v121, 1.0, v121
  v_mfma_f32_16x16x32_bf16 v[156:159], v[228:231], v[16:19], v[156:159]
  v_rcp_f32 v88, v88
  v_rcp_f32 v89, v89
  v_rcp_f32 v120, v120
  v_rcp_f32 v121, v121
  v_mfma_f32_16x16x32_bf16 v[188:191], v[232:235], v[16:19], v[188:191]
  v_mul_f32 v90, v90, v88
  v_mul_f32 v91, v91, v89
  v_mul_f32 v122, v122, v120
  v_mul_f32 v123, v123, v121
  s_waitcnt lgkmcnt(4)
  v_mfma_f32_16x16x32_bf16 v[92:95], v[236:239], v[20:23], v[92:95]
  ds_read_b128 v[16:19], v2 offset:10240
  v_cvt_pk_bf16_f32 v88, v90, v91
  v_cvt_pk_bf16_f32 v89, v122, v123
  v_fmaak_f32 v244, v152, v152, 0x409d30fc
  v_fmaak_f32 v245, v153, v153, 0x409d30fc
  v_mfma_f32_16x16x32_bf16 v[124:127], v[240:243], v[20:23], v[124:127]
  v_fmaak_f32 v246, v184, v184, 0x409d30fc
  v_fmaak_f32 v247, v185, v185, 0x409d30fc
  v_mul_f32 v154, v152, v154
  v_mul_f32 v155, v153, v155
  v_mfma_f32_16x16x32_bf16 v[156:159], v[28:31], v[20:23], v[156:159]
  v_mul_f32 v186, v184, v186
  v_mul_f32 v187, v185, v187
  v_mul_f32 v152, v244, v152
  v_mul_f32 v153, v245, v153
  v_mfma_f32_16x16x32_bf16 v[188:191], v[32:35], v[20:23], v[188:191]
  v_mul_f32 v184, v246, v184
  v_mul_f32 v185, v247, v185
  v_exp_f32_e64 v152, -v152
  v_exp_f32_e64 v153, -v153
  s_waitcnt lgkmcnt(4)
  v_mfma_f32_16x16x32_bf16 v[92:95], v[36:39], v[24:27], v[92:95]
  ds_read_b128 v[20:23], v1 offset:52224
  v_exp_f32_e64 v184, -v184
  v_exp_f32_e64 v185, -v185
  v_add_f32 v152, 1.0, v152
  v_add_f32 v153, 1.0, v153
  v_mfma_f32_16x16x32_bf16 v[124:127], v[40:43], v[24:27], v[124:127]
  v_add_f32 v184, 1.0, v184
  v_add_f32 v185, 1.0, v185
  v_rcp_f32 v152, v152
  v_rcp_f32 v153, v153
  v_mfma_f32_16x16x32_bf16 v[156:159], v[44:47], v[24:27], v[156:159]
  v_rcp_f32 v184, v184
  v_rcp_f32 v185, v185
  v_mul_f32 v154, v154, v152
  v_mul_f32 v155, v155, v153
  v_mfma_f32_16x16x32_bf16 v[188:191], v[48:51], v[24:27], v[188:191]
  v_mul_f32 v186, v186, v184
  v_mul_f32 v187, v187, v185
  v_cvt_pk_bf16_f32 v90, v154, v155
  v_cvt_pk_bf16_f32 v91, v186, v187
  s_waitcnt lgkmcnt(4)
  v_mfma_f32_16x16x32_bf16 v[96:99], v[76:79], v[4:7], v[96:99]
  ds_read_b128 v[24:27], v1 offset:60416
  s_add_u32 s30, s34, 0
  buffer_store_dwordx4 v[88:91], v0, s[8:11], s30 offen offset:0 sc1
  ds_read_b32 v250, v254 offset:0
  s_waitcnt lgkmcnt(0)
  v_cmp_gt_u32 vcc, 2, v250
  s_cbranch_vccnz per_B_x3s
per_B_x3r:
  ds_read_b32 v250, v254 offset:1024
  s_waitcnt lgkmcnt(0)
  v_cmp_gt_u32 vcc, 21, v250
  s_cbranch_vccnz per_B_x4s
per_B_x4r:
  ds_write_b128 v252, v[88:91] offset:0
  v_mfma_f32_16x16x32_bf16 v[128:131], v[80:83], v[4:7], v[128:131]
  s_add_u32 s28, s22, 110592
  buffer_load_dwordx4 v[152:155], v0, s[8:11], s28 offen offset:0
  v_fmaak_f32 v244, v92, v92, 0x409d30fc
  v_fmaak_f32 v245, v93, v93, 0x409d30fc
  v_fmaak_f32 v246, v124, v124, 0x409d30fc
  v_fmaak_f32 v247, v125, v125, 0x409d30fc
  v_mfma_f32_16x16x32_bf16 v[160:163], v[84:87], v[4:7], v[160:163]
  v_mul_f32 v94, v92, v94
  v_mul_f32 v95, v93, v95
  v_mul_f32 v126, v124, v126
  v_mul_f32 v127, v125, v127
  v_mfma_f32_16x16x32_bf16 v[192:195], v[216:219], v[4:7], v[192:195]
  v_mul_f32 v92, v244, v92
  v_mul_f32 v93, v245, v93
  v_mul_f32 v124, v246, v124
  v_mul_f32 v125, v247, v125
  v_mfma_f32_16x16x32_bf16 v[96:99], v[220:223], v[8:11], v[96:99]
  ds_read_b128 v[4:7], v2 offset:3072
  v_exp_f32_e64 v92, -v92
  v_exp_f32_e64 v93, -v93
  v_exp_f32_e64 v124, -v124
  v_exp_f32_e64 v125, -v125
  v_mfma_f32_16x16x32_bf16 v[128:131], v[224:227], v[8:11], v[128:131]
  buffer_load_dwordx4 v[184:187], v0, s[8:11], s28 offen offset:1024
  v_add_f32 v92, 1.0, v92
  v_add_f32 v93, 1.0, v93
  v_add_f32 v124, 1.0, v124
  v_add_f32 v125, 1.0, v125
  v_mfma_f32_16x16x32_bf16 v[160:163], v[228:231], v[8:11], v[160:163]
  v_rcp_f32 v92, v92
  v_rcp_f32 v93, v93
  v_rcp_f32 v124, v124
  v_rcp_f32 v125, v125
  v_mfma_f32_16x16x32_bf16 v[192:195], v[232:235], v[8:11], v[192:195]
  v_mul_f32 v94, v94, v92
  v_mul_f32 v95, v95, v93
  v_mul_f32 v126, v126, v124
  v_mul_f32 v127, v127, v125
  v_mfma_f32_16x16x32_bf16 v[96:99], v[236:239], v[12:15], v[96:99]
  ds_read_b128 v[8:11], v2 offset:11264
  v_cvt_pk_bf16_f32 v92, v94, v95
  v_cvt_pk_bf16_f32 v93, v126, v127
  v_fmaak_f32 v244, v156, v156, 0x409d30fc
  v_fmaak_f32 v245, v157, v157, 0x409d30fc
  v_mfma_f32_16x16x32_bf16 v[128:131], v[240:243], v[12:15], v[128:131]
  v_fmaak_f32 v246, v188, v188, 0x409d30fc
  v_fmaak_f32 v247, v189, v189, 0x409d30fc
  v_mul_f32 v158, v156, v158
  v_mul_f32 v159, v157, v159
  v_mfma_f32_16x16x32_bf16 v[160:163], v[28:31], v[12:15], v[160:163]
  v_mul_f32 v190, v188, v190
  v_mul_f32 v191, v189, v191
  v_mul_f32 v156, v244, v156
  v_mul_f32 v157, v245, v157
  v_mfma_f32_16x16x32_bf16 v[192:195], v[32:35], v[12:15], v[192:195]
  v_mul_f32 v188, v246, v188
  v_mul_f32 v189, v247, v189
  v_exp_f32_e64 v156, -v156
  v_exp_f32_e64 v157, -v157
  v_mfma_f32_16x16x32_bf16 v[96:99], v[36:39], v[16:19], v[96:99]
  ds_read_b128 v[12:15], v1 offset:53248
  v_exp_f32_e64 v188, -v188
  v_exp_f32_e64 v189, -v189
  v_add_f32 v156, 1.0, v156
  v_add_f32 v157, 1.0, v157
  v_mfma_f32_16x16x32_bf16 v[128:131], v[40:43], v[16:19], v[128:131]
  v_add_f32 v188, 1.0, v188
  v_add_f32 v189, 1.0, v189
  v_rcp_f32 v156, v156
  v_rcp_f32 v157, v157
  v_mfma_f32_16x16x32_bf16 v[160:163], v[44:47], v[16:19], v[160:163]
  v_rcp_f32 v188, v188
  v_rcp_f32 v189, v189
  v_mul_f32 v158, v158, v156
  v_mul_f32 v159, v159, v157
  v_mfma_f32_16x16x32_bf16 v[192:195], v[48:51], v[16:19], v[192:195]
  v_mul_f32 v190, v190, v188
  v_mul_f32 v191, v191, v189
  v_cvt_pk_bf16_f32 v94, v158, v159
  v_cvt_pk_bf16_f32 v95, v190, v191
  v_mfma_f32_16x16x32_bf16 v[100:103], v[76:79], v[20:23], v[100:103]
  ds_read_b128 v[16:19], v1 offset:61440
  s_add_u32 s30, s34, 0
  buffer_store_dwordx4 v[92:95], v0, s[8:11], s30 offen offset:1024 sc1
  ds_write_b128 v252, v[92:95] offset:1024
  v_mfma_f32_16x16x32_bf16 v[132:135], v[80:83], v[20:23], v[132:135]
  s_add_u32 s29, s22, 294912
  buffer_load_dwordx4 v[156:159], v0, s[8:11], s29 offen offset:0
  v_fmaak_f32 v244, v96, v96, 0x409d30fc
  v_fmaak_f32 v245, v97, v97, 0x409d30fc
  v_fmaak_f32 v246, v128, v128, 0x409d30fc
  v_fmaak_f32 v247, v129, v129, 0x409d30fc
  v_mfma_f32_16x16x32_bf16 v[164:167], v[84:87], v[20:23], v[164:167]
  v_mul_f32 v98, v96, v98
  v_mul_f32 v99, v97, v99
  v_mul_f32 v130, v128, v130
  v_mul_f32 v131, v129, v131
  v_mfma_f32_16x16x32_bf16 v[196:199], v[216:219], v[20:23], v[196:199]
  v_mul_f32 v96, v244, v96
  v_mul_f32 v97, v245, v97
  v_mul_f32 v128, v246, v128
  v_mul_f32 v129, v247, v129
  v_mfma_f32_16x16x32_bf16 v[100:103], v[220:223], v[24:27], v[100:103]
  ds_read_b128 v[20:23], v2 offset:4096
  v_exp_f32_e64 v96, -v96
  v_exp_f32_e64 v97, -v97
  v_exp_f32_e64 v128, -v128
  v_exp_f32_e64 v129, -v129
  v_mfma_f32_16x16x32_bf16 v[132:135], v[224:227], v[24:27], v[132:135]
  buffer_load_dwordx4 v[188:191], v0, s[8:11], s29 offen offset:1024
  v_add_f32 v96, 1.0, v96
  v_add_f32 v97, 1.0, v97
  v_add_f32 v128, 1.0, v128
  v_add_f32 v129, 1.0, v129
  v_mfma_f32_16x16x32_bf16 v[164:167], v[228:231], v[24:27], v[164:167]
  v_rcp_f32 v96, v96
  v_rcp_f32 v97, v97
  v_rcp_f32 v128, v128
  v_rcp_f32 v129, v129
  v_mfma_f32_16x16x32_bf16 v[196:199], v[232:235], v[24:27], v[196:199]
  v_mul_f32 v98, v98, v96
  v_mul_f32 v99, v99, v97
  v_mul_f32 v130, v130, v128
  v_mul_f32 v131, v131, v129
  s_waitcnt lgkmcnt(5)
  v_mfma_f32_16x16x32_bf16 v[100:103], v[236:239], v[4:7], v[100:103]
  ds_read_b128 v[24:27], v2 offset:12288
  v_cvt_pk_bf16_f32 v96, v98, v99
  v_cvt_pk_bf16_f32 v97, v130, v131
  v_fmaak_f32 v244, v160, v160, 0x409d30fc
  v_fmaak_f32 v245, v161, v161, 0x409d30fc
  v_mfma_f32_16x16x32_bf16 v[132:135], v[240:243], v[4:7], v[132:135]
  v_fmaak_f32 v246, v192, v192, 0x409d30fc
  v_fmaak_f32 v247, v193, v193, 0x409d30fc
  v_mul_f32 v162, v160, v162
  v_mul_f32 v163, v161, v163
  v_mfma_f32_16x16x32_bf16 v[164:167], v[28:31], v[4:7], v[164:167]
  v_mul_f32 v194, v192, v194
  v_mul_f32 v195, v193, v195
  v_mul_f32 v160, v244, v160
  v_mul_f32 v161, v245, v161
  v_mfma_f32_16x16x32_bf16 v[196:199], v[32:35], v[4:7], v[196:199]
  v_mul_f32 v192, v246, v192
  v_mul_f32 v193, v247, v193
  v_exp_f32_e64 v160, -v160
  v_exp_f32_e64 v161, -v161
  s_waitcnt lgkmcnt(5)
  v_mfma_f32_16x16x32_bf16 v[100:103], v[36:39], v[8:11], v[100:103]
  ds_read_b128 v[4:7], v1 offset:54272
  v_exp_f32_e64 v192, -v192
  v_exp_f32_e64 v193, -v193
  v_add_f32 v160, 1.0, v160
  v_add_f32 v161, 1.0, v161
  v_mfma_f32_16x16x32_bf16 v[132:135], v[40:43], v[8:11], v[132:135]
  v_add_f32 v192, 1.0, v192
  v_add_f32 v193, 1.0, v193
  v_rcp_f32 v160, v160
  v_rcp_f32 v161, v161
  v_mfma_f32_16x16x32_bf16 v[164:167], v[44:47], v[8:11], v[164:167]
  v_rcp_f32 v192, v192
  v_rcp_f32 v193, v193
  v_mul_f32 v162, v162, v160
  v_mul_f32 v163, v163, v161
  v_mfma_f32_16x16x32_bf16 v[196:199], v[48:51], v[8:11], v[196:199]
  v_mul_f32 v194, v194, v192
  v_mul_f32 v195, v195, v193
  v_cvt_pk_bf16_f32 v98, v162, v163
  v_cvt_pk_bf16_f32 v99, v194, v195
  s_waitcnt lgkmcnt(5)
  v_mfma_f32_16x16x32_bf16 v[104:107], v[76:79], v[12:15], v[104:107]
  ds_read_b128 v[8:11], v1 offset:62464
  s_add_u32 s30, s34, 0
  buffer_store_dwordx4 v[96:99], v0, s[8:11], s30 offen offset:2048 sc1
  ds_write_b128 v252, v[96:99] offset:2048
  v_mfma_f32_16x16x32_bf16 v[136:139], v[80:83], v[12:15], v[136:139]
  s_add_u32 s28, s32, 0
  buffer_load_dwordx4 v[160:163], v0, s[8:11], s28 offen offset:0
  v_fmaak_f32 v244, v100, v100, 0x409d30fc
  v_fmaak_f32 v245, v101, v101, 0x409d30fc
  v_fmaak_f32 v246, v132, v132, 0x409d30fc
  v_fmaak_f32 v247, v133, v133, 0x409d30fc
  v_mfma_f32_16x16x32_bf16 v[168:171], v[84:87], v[12:15], v[168:171]
  v_mul_f32 v102, v100, v102
  v_mul_f32 v103, v101, v103
  v_mul_f32 v134, v132, v134
  v_mul_f32 v135, v133, v135
  v_mfma_f32_16x16x32_bf16 v[200:203], v[216:219], v[12:15], v[200:203]
  v_mul_f32 v100, v244, v100
  v_mul_f32 v101, v245, v101
  v_mul_f32 v132, v246, v132
  v_mul_f32 v133, v247, v133
  s_waitcnt lgkmcnt(6)
  v_mfma_f32_16x16x32_bf16 v[104:107], v[220:223], v[16:19], v[104:107]
  ds_read_b128 v[12:15], v2 offset:5120
  v_exp_f32_e64 v100, -v100
  v_exp_f32_e64 v101, -v101
  v_exp_f32_e64 v132, -v132
  v_exp_f32_e64 v133, -v133
  v_mfma_f32_16x16x32_bf16 v[136:139], v[224:227], v[16:19], v[136:139]
  buffer_load_dwordx4 v[192:195], v0, s[8:11], s28 offen offset:1024
  v_add_f32 v100, 1.0, v100
  v_add_f32 v101, 1.0, v101
  v_add_f32 v132, 1.0, v132
  v_add_f32 v133, 1.0, v133
  v_mfma_f32_16x16x32_bf16 v[168:171], v[228:231], v[16:19], v[168:171]
  v_rcp_f32 v100, v100
  v_rcp_f32 v101, v101
  v_rcp_f32 v132, v132
  v_rcp_f32 v133, v133
  v_mfma_f32_16x16x32_bf16 v[200:203], v[232:235], v[16:19], v[200:203]
  v_mul_f32 v102, v102, v100
  v_mul_f32 v103, v103, v101
  v_mul_f32 v134, v134, v132
  v_mul_f32 v135, v135, v133
  s_waitcnt lgkmcnt(5)
  v_mfma_f32_16x16x32_bf16 v[104:107], v[236:239], v[20:23], v[104:107]
  ds_read_b128 v[16:19], v2 offset:13312
  v_cvt_pk_bf16_f32 v100, v102, v103
  v_cvt_pk_bf16_f32 v101, v134, v135
  v_fmaak_f32 v244, v164, v164, 0x409d30fc
  v_fmaak_f32 v245, v165, v165, 0x409d30fc
  v_mfma_f32_16x16x32_bf16 v[136:139], v[240:243], v[20:23], v[136:139]
  v_fmaak_f32 v246, v196, v196, 0x409d30fc
  v_fmaak_f32 v247, v197, v197, 0x409d30fc
  v_mul_f32 v166, v164, v166
  v_mul_f32 v167, v165, v167
  v_mfma_f32_16x16x32_bf16 v[168:171], v[28:31], v[20:23], v[168:171]
  v_mul_f32 v198, v196, v198
  v_mul_f32 v199, v197, v199
  v_mul_f32 v164, v244, v164
  v_mul_f32 v165, v245, v165
  v_mfma_f32_16x16x32_bf16 v[200:203], v[32:35], v[20:23], v[200:203]
  v_mul_f32 v196, v246, v196
  v_mul_f32 v197, v247, v197
  v_exp_f32_e64 v164, -v164
  v_exp_f32_e64 v165, -v165
  s_waitcnt lgkmcnt(5)
  v_mfma_f32_16x16x32_bf16 v[104:107], v[36:39], v[24:27], v[104:107]
  ds_read_b128 v[20:23], v1 offset:55296
  v_exp_f32_e64 v196, -v196
  v_exp_f32_e64 v197, -v197
  v_add_f32 v164, 1.0, v164
  v_add_f32 v165, 1.0, v165
  v_mfma_f32_16x16x32_bf16 v[136:139], v[40:43], v[24:27], v[136:139]
  v_add_f32 v196, 1.0, v196
  v_add_f32 v197, 1.0, v197
  v_rcp_f32 v164, v164
  v_rcp_f32 v165, v165
  v_mfma_f32_16x16x32_bf16 v[168:171], v[44:47], v[24:27], v[168:171]
  v_rcp_f32 v196, v196
  v_rcp_f32 v197, v197
  v_mul_f32 v166, v166, v164
  v_mul_f32 v167, v167, v165
  v_mfma_f32_16x16x32_bf16 v[200:203], v[48:51], v[24:27], v[200:203]
  v_mul_f32 v198, v198, v196
  v_mul_f32 v199, v199, v197
  v_cvt_pk_bf16_f32 v102, v166, v167
  v_cvt_pk_bf16_f32 v103, v198, v199
  s_waitcnt lgkmcnt(5)
  v_mfma_f32_16x16x32_bf16 v[108:111], v[76:79], v[4:7], v[108:111]
  ds_read_b128 v[24:27], v1 offset:63488
  s_add_u32 s30, s34, 0
  buffer_store_dwordx4 v[100:103], v0, s[8:11], s30 offen offset:3072 sc1
  ds_write_b128 v252, v[100:103] offset:3072
  v_mov_b32 v248, 22
  ds_write_b32 v251, v248
  v_mfma_f32_16x16x32_bf16 v[140:143], v[80:83], v[4:7], v[140:143]
  s_add_u32 s29, s32, 36864
  buffer_load_dwordx4 v[164:167], v0, s[8:11], s29 offen offset:0
  v_fmaak_f32 v244, v104, v104, 0x409d30fc
  v_fmaak_f32 v245, v105, v105, 0x409d30fc
  v_fmaak_f32 v246, v136, v136, 0x409d30fc
  v_fmaak_f32 v247, v137, v137, 0x409d30fc
  v_mfma_f32_16x16x32_bf16 v[172:175], v[84:87], v[4:7], v[172:175]
  v_mul_f32 v106, v104, v106
  v_mul_f32 v107, v105, v107
  v_mul_f32 v138, v136, v138
  v_mul_f32 v139, v137, v139
  v_mfma_f32_16x16x32_bf16 v[204:207], v[216:219], v[4:7], v[204:207]
  v_mul_f32 v104, v244, v104
  v_mul_f32 v105, v245, v105
  v_mul_f32 v136, v246, v136
  v_mul_f32 v137, v247, v137
  s_waitcnt lgkmcnt(7)
  v_mfma_f32_16x16x32_bf16 v[108:111], v[220:223], v[8:11], v[108:111]
  ds_read_b128 v[4:7], v2 offset:6144
  v_exp_f32_e64 v104, -v104
  v_exp_f32_e64 v105, -v105
  v_exp_f32_e64 v136, -v136
  v_exp_f32_e64 v137, -v137
  v_mfma_f32_16x16x32_bf16 v[140:143], v[224:227], v[8:11], v[140:143]
  buffer_load_dwordx4 v[196:199], v0, s[8:11], s29 offen offset:1024
  v_add_f32 v104, 1.0, v104
  v_add_f32 v105, 1.0, v105
  v_add_f32 v136, 1.0, v136
  v_add_f32 v137, 1.0, v137
  v_mfma_f32_16x16x32_bf16 v[172:175], v[228:231], v[8:11], v[172:175]
  v_rcp_f32 v104, v104
  v_rcp_f32 v105, v105
  v_rcp_f32 v136, v136
  v_rcp_f32 v137, v137
  v_mfma_f32_16x16x32_bf16 v[204:207], v[232:235], v[8:11], v[204:207]
  v_mul_f32 v106, v106, v104
  v_mul_f32 v107, v107, v105
  v_mul_f32 v138, v138, v136
  v_mul_f32 v139, v139, v137
  s_waitcnt lgkmcnt(6)
  v_mfma_f32_16x16x32_bf16 v[108:111], v[236:239], v[12:15], v[108:111]
  ds_read_b128 v[8:11], v2 offset:14336
  v_cvt_pk_bf16_f32 v104, v106, v107
  v_cvt_pk_bf16_f32 v105, v138, v139
  v_fmaak_f32 v244, v168, v168, 0x409d30fc
  v_fmaak_f32 v245, v169, v169, 0x409d30fc
  v_mfma_f32_16x16x32_bf16 v[140:143], v[240:243], v[12:15], v[140:143]
  v_fmaak_f32 v246, v200, v200, 0x409d30fc
  v_fmaak_f32 v247, v201, v201, 0x409d30fc
  v_mul_f32 v170, v168, v170
  v_mul_f32 v171, v169, v171
  v_mfma_f32_16x16x32_bf16 v[172:175], v[28:31], v[12:15], v[172:175]
  v_mul_f32 v202, v200, v202
  v_mul_f32 v203, v201, v203
  v_mul_f32 v168, v244, v168
  v_mul_f32 v169, v245, v169
  v_mfma_f32_16x16x32_bf16 v[204:207], v[32:35], v[12:15], v[204:207]
  v_mul_f32 v200, v246, v200
  v_mul_f32 v201, v247, v201
  v_exp_f32_e64 v168, -v168
  v_exp_f32_e64 v169, -v169
  s_waitcnt lgkmcnt(6)
  v_mfma_f32_16x16x32_bf16 v[108:111], v[36:39], v[16:19], v[108:111]
  ds_read_b128 v[12:15], v1 offset:56320
  v_exp_f32_e64 v200, -v200
  v_exp_f32_e64 v201, -v201
  v_add_f32 v168, 1.0, v168
  v_add_f32 v169, 1.0, v169
  v_mfma_f32_16x16x32_bf16 v[140:143], v[40:43], v[16:19], v[140:143]
  v_add_f32 v200, 1.0, v200
  v_add_f32 v201, 1.0, v201
  v_rcp_f32 v168, v168
  v_rcp_f32 v169, v169
  v_mfma_f32_16x16x32_bf16 v[172:175], v[44:47], v[16:19], v[172:175]
  v_rcp_f32 v200, v200
  v_rcp_f32 v201, v201
  v_mul_f32 v170, v170, v168
  v_mul_f32 v171, v171, v169
  v_mfma_f32_16x16x32_bf16 v[204:207], v[48:51], v[16:19], v[204:207]
  v_mul_f32 v202, v202, v200
  v_mul_f32 v203, v203, v201
  v_cvt_pk_bf16_f32 v106, v170, v171
  v_cvt_pk_bf16_f32 v107, v202, v203
  s_waitcnt lgkmcnt(6)
  v_mfma_f32_16x16x32_bf16 v[112:115], v[76:79], v[20:23], v[112:115]
  ds_read_b128 v[16:19], v1 offset:64512
  s_add_u32 s30, s34, 4096
  buffer_store_dwordx4 v[104:107], v0, s[8:11], s30 offen offset:0 sc1
  ds_write_b128 v252, v[104:107] offset:4096
  v_mfma_f32_16x16x32_bf16 v[144:147], v[80:83], v[20:23], v[144:147]
  s_add_u32 s28, s32, 73728
  buffer_load_dwordx4 v[168:171], v0, s[8:11], s28 offen offset:0
  v_fmaak_f32 v244, v108, v108, 0x409d30fc
  v_fmaak_f32 v245, v109, v109, 0x409d30fc
  v_fmaak_f32 v246, v140, v140, 0x409d30fc
  v_fmaak_f32 v247, v141, v141, 0x409d30fc
  v_mfma_f32_16x16x32_bf16 v[176:179], v[84:87], v[20:23], v[176:179]
  v_mul_f32 v110, v108, v110
  v_mul_f32 v111, v109, v111
  v_mul_f32 v142, v140, v142
  v_mul_f32 v143, v141, v143
  v_mfma_f32_16x16x32_bf16 v[208:211], v[216:219], v[20:23], v[208:211]
  v_mul_f32 v108, v244, v108
  v_mul_f32 v109, v245, v109
  v_mul_f32 v140, v246, v140
  v_mul_f32 v141, v247, v141
  s_waitcnt lgkmcnt(7)
  v_mfma_f32_16x16x32_bf16 v[112:115], v[220:223], v[24:27], v[112:115]
  ds_read_b128 v[20:23], v2 offset:7168
  v_exp_f32_e64 v108, -v108
  v_exp_f32_e64 v109, -v109
  v_exp_f32_e64 v140, -v140
  v_exp_f32_e64 v141, -v141
  v_mfma_f32_16x16x32_bf16 v[144:147], v[224:227], v[24:27], v[144:147]
  buffer_load_dwordx4 v[200:203], v0, s[8:11], s28 offen offset:1024
  v_add_f32 v108, 1.0, v108
  v_add_f32 v109, 1.0, v109
  v_add_f32 v140, 1.0, v140
  v_add_f32 v141, 1.0, v141
  v_mfma_f32_16x16x32_bf16 v[176:179], v[228:231], v[24:27], v[176:179]
  v_rcp_f32 v108, v108
  v_rcp_f32 v109, v109
  v_rcp_f32 v140, v140
  v_rcp_f32 v141, v141
  v_mfma_f32_16x16x32_bf16 v[208:211], v[232:235], v[24:27], v[208:211]
  v_mul_f32 v110, v110, v108
  v_mul_f32 v111, v111, v109
  v_mul_f32 v142, v142, v140
  v_mul_f32 v143, v143, v141
  s_waitcnt lgkmcnt(5)
  v_mfma_f32_16x16x32_bf16 v[112:115], v[236:239], v[4:7], v[112:115]
  ds_read_b128 v[24:27], v2 offset:15360
  v_cvt_pk_bf16_f32 v108, v110, v111
  v_cvt_pk_bf16_f32 v109, v142, v143
  v_fmaak_f32 v244, v172, v172, 0x409d30fc
  v_fmaak_f32 v245, v173, v173, 0x409d30fc
  v_mfma_f32_16x16x32_bf16 v[144:147], v[240:243], v[4:7], v[144:147]
  v_fmaak_f32 v246, v204, v204, 0x409d30fc
  v_fmaak_f32 v247, v205, v205, 0x409d30fc
  v_mul_f32 v174, v172, v174
  v_mul_f32 v175, v173, v175
  v_mfma_f32_16x16x32_bf16 v[176:179], v[28:31], v[4:7], v[176:179]
  v_mul_f32 v206, v204, v206
  v_mul_f32 v207, v205, v207
  v_mul_f32 v172, v244, v172
  v_mul_f32 v173, v245, v173
  v_mfma_f32_16x16x32_bf16 v[208:211], v[32:35], v[4:7], v[208:211]
  v_mul_f32 v204, v246, v204
  v_mul_f32 v205, v247, v205
  v_exp_f32_e64 v172, -v172
  v_exp_f32_e64 v173, -v173
  s_waitcnt lgkmcnt(5)
  v_mfma_f32_16x16x32_bf16 v[112:115], v[36:39], v[8:11], v[112:115]
  v_exp_f32_e64 v204, -v204
  v_exp_f32_e64 v205, -v205
  v_add_f32 v172, 1.0, v172
  v_add_f32 v173, 1.0, v173
  v_mfma_f32_16x16x32_bf16 v[144:147], v[40:43], v[8:11], v[144:147]
  v_add_f32 v204, 1.0, v204
  v_add_f32 v205, 1.0, v205
  v_rcp_f32 v172, v172
  v_rcp_f32 v173, v173
  v_mfma_f32_16x16x32_bf16 v[176:179], v[44:47], v[8:11], v[176:179]
  v_rcp_f32 v204, v204
  v_rcp_f32 v205, v205
  v_mul_f32 v174, v174, v172
  v_mul_f32 v175, v175, v173
  v_mfma_f32_16x16x32_bf16 v[208:211], v[48:51], v[8:11], v[208:211]
  v_mul_f32 v206, v206, v204
  v_mul_f32 v207, v207, v205
  v_cvt_pk_bf16_f32 v110, v174, v175
  v_cvt_pk_bf16_f32 v111, v206, v207
  s_waitcnt lgkmcnt(4)
  v_mfma_f32_16x16x32_bf16 v[116:119], v[76:79], v[12:15], v[116:119]
  s_add_u32 s30, s34, 4096
  buffer_store_dwordx4 v[108:111], v0, s[8:11], s30 offen offset:1024 sc1
  ds_write_b128 v252, v[108:111] offset:5120
  v_mfma_f32_16x16x32_bf16 v[148:151], v[80:83], v[12:15], v[148:151]
  s_add_u32 s29, s32, 110592
  buffer_load_dwordx4 v[76:79], v0, s[8:11], s29 offen offset:0
  v_fmaak_f32 v244, v112, v112, 0x409d30fc
  v_fmaak_f32 v245, v113, v113, 0x409d30fc
  v_fmaak_f32 v246, v144, v144, 0x409d30fc
  v_fmaak_f32 v247, v145, v145, 0x409d30fc
  v_mfma_f32_16x16x32_bf16 v[180:183], v[84:87], v[12:15], v[180:183]
  v_mul_f32 v114, v112, v114
  v_mul_f32 v115, v113, v115
  v_mul_f32 v146, v144, v146
  v_mul_f32 v147, v145, v147
  v_mfma_f32_16x16x32_bf16 v[212:215], v[216:219], v[12:15], v[212:215]
  v_mul_f32 v112, v244, v112
  v_mul_f32 v113, v245, v113
  v_mul_f32 v144, v246, v144
  v_mul_f32 v145, v247, v145
  s_waitcnt lgkmcnt(4)
  v_mfma_f32_16x16x32_bf16 v[116:119], v[220:223], v[16:19], v[116:119]
  v_exp_f32_e64 v112, -v112
  v_exp_f32_e64 v113, -v113
  v_exp_f32_e64 v144, -v144
  v_exp_f32_e64 v145, -v145
  v_mfma_f32_16x16x32_bf16 v[148:151], v[224:227], v[16:19], v[148:151]
  buffer_load_dwordx4 v[172:175], v0, s[8:11], s29 offen offset:1024
  v_add_f32 v112, 1.0, v112
  v_add_f32 v113, 1.0, v113
  v_add_f32 v144, 1.0, v144
  v_add_f32 v145, 1.0, v145
  v_mfma_f32_16x16x32_bf16 v[180:183], v[228:231], v[16:19], v[180:183]
  v_rcp_f32 v112, v112
  v_rcp_f32 v113, v113
  v_rcp_f32 v144, v144
  v_rcp_f32 v145, v145
  v_mfma_f32_16x16x32_bf16 v[212:215], v[232:235], v[16:19], v[212:215]
  v_mul_f32 v114, v114, v112
  v_mul_f32 v115, v115, v113
  v_mul_f32 v146, v146, v144
  v_mul_f32 v147, v147, v145
  s_waitcnt lgkmcnt(2)
  v_mfma_f32_16x16x32_bf16 v[116:119], v[236:239], v[20:23], v[116:119]
  v_cvt_pk_bf16_f32 v112, v114, v115
  v_cvt_pk_bf16_f32 v113, v146, v147
  v_fmaak_f32 v244, v176, v176, 0x409d30fc
  v_fmaak_f32 v245, v177, v177, 0x409d30fc
  v_mfma_f32_16x16x32_bf16 v[148:151], v[240:243], v[20:23], v[148:151]
  s_add_u32 s28, s32, 294912
  buffer_load_dwordx4 v[204:207], v0, s[8:11], s28 offen offset:0
  v_fmaak_f32 v246, v208, v208, 0x409d30fc
  v_fmaak_f32 v247, v209, v209, 0x409d30fc
  v_mul_f32 v178, v176, v178
  v_mul_f32 v179, v177, v179
  v_mfma_f32_16x16x32_bf16 v[180:183], v[28:31], v[20:23], v[180:183]
  v_mul_f32 v210, v208, v210
  v_mul_f32 v211, v209, v211
  v_mul_f32 v176, v244, v176
  v_mul_f32 v177, v245, v177
  v_mfma_f32_16x16x32_bf16 v[212:215], v[32:35], v[20:23], v[212:215]
  v_mul_f32 v208, v246, v208
  v_mul_f32 v209, v247, v209
  v_exp_f32_e64 v176, -v176
  v_exp_f32_e64 v177, -v177
  s_waitcnt lgkmcnt(1)
  v_mfma_f32_16x16x32_bf16 v[116:119], v[36:39], v[24:27], v[116:119]
  v_exp_f32_e64 v208, -v208
  v_exp_f32_e64 v209, -v209
  v_add_f32 v176, 1.0, v176
  v_add_f32 v177, 1.0, v177
  v_mfma_f32_16x16x32_bf16 v[148:151], v[40:43], v[24:27], v[148:151]
  buffer_load_dwordx4 v[80:83], v0, s[8:11], s28 offen offset:1024
  v_add_f32 v208, 1.0, v208
  v_add_f32 v209, 1.0, v209
  v_rcp_f32 v176, v176
  v_rcp_f32 v177, v177
  v_mfma_f32_16x16x32_bf16 v[180:183], v[44:47], v[24:27], v[180:183]
  v_rcp_f32 v208, v208
  v_rcp_f32 v209, v209
  v_mul_f32 v178, v178, v176
  v_mul_f32 v179, v179, v177
  v_mfma_f32_16x16x32_bf16 v[212:215], v[48:51], v[24:27], v[212:215]
  v_mul_f32 v210, v210, v208
  v_mul_f32 v211, v211, v209
  v_cvt_pk_bf16_f32 v114, v178, v179
  v_cvt_pk_bf16_f32 v115, v210, v211
  s_add_u32 s30, s34, 4096
  buffer_store_dwordx4 v[112:115], v0, s[8:11], s30 offen offset:2048 sc1
  ds_write_b128 v252, v[112:115] offset:6144
  s_waitcnt vmcnt(11)
  v_mov_b32 v248, 0
  v_mov_b32 v249, s96
  buffer_store_dword v249, v248, s[8:11], s38 offen offset:0 sc1
  v_fmaak_f32 v244, v116, v116, 0x409d30fc
  v_fmaak_f32 v245, v117, v117, 0x409d30fc
  v_fmaak_f32 v246, v148, v148, 0x409d30fc
  v_fmaak_f32 v247, v149, v149, 0x409d30fc
  v_mul_f32 v118, v116, v118
  v_mul_f32 v119, v117, v119
  v_mul_f32 v150, v148, v150
  v_mul_f32 v151, v149, v151
  v_mul_f32 v116, v244, v116
  v_mul_f32 v117, v245, v117
  v_mul_f32 v148, v246, v148
  v_mul_f32 v149, v247, v149
  v_exp_f32_e64 v116, -v116
  v_exp_f32_e64 v117, -v117
  v_exp_f32_e64 v148, -v148
  v_exp_f32_e64 v149, -v149
  v_add_f32 v116, 1.0, v116
  v_add_f32 v117, 1.0, v117
  v_add_f32 v148, 1.0, v148
  v_add_f32 v149, 1.0, v149
  v_rcp_f32 v116, v116
  v_rcp_f32 v117, v117
  v_rcp_f32 v148, v148
  v_rcp_f32 v149, v149
  v_mul_f32 v118, v118, v116
  v_mul_f32 v119, v119, v117
  v_mul_f32 v150, v150, v148
  v_mul_f32 v151, v151, v149
  v_cvt_pk_bf16_f32 v116, v118, v119
  v_cvt_pk_bf16_f32 v117, v150, v151
  v_fmaak_f32 v244, v180, v180, 0x409d30fc
  v_fmaak_f32 v245, v181, v181, 0x409d30fc
  v_fmaak_f32 v246, v212, v212, 0x409d30fc
  v_fmaak_f32 v247, v213, v213, 0x409d30fc
  v_mul_f32 v182, v180, v182
  v_mul_f32 v183, v181, v183
  v_mul_f32 v214, v212, v214
  v_mul_f32 v215, v213, v215
  v_mul_f32 v180, v244, v180
  v_mul_f32 v181, v245, v181
  v_mul_f32 v212, v246, v212
  v_mul_f32 v213, v247, v213
  v_exp_f32_e64 v180, -v180
  v_exp_f32_e64 v181, -v181
  v_exp_f32_e64 v212, -v212
  v_exp_f32_e64 v213, -v213
  v_add_f32 v180, 1.0, v180
  v_add_f32 v181, 1.0, v181
  v_add_f32 v212, 1.0, v212
  v_add_f32 v213, 1.0, v213
  v_rcp_f32 v180, v180
  v_rcp_f32 v181, v181
  v_rcp_f32 v212, v212
  v_rcp_f32 v213, v213
  v_mul_f32 v182, v182, v180
  v_mul_f32 v183, v183, v181
  v_mul_f32 v214, v214, v212
  v_mul_f32 v215, v215, v213
  v_cvt_pk_bf16_f32 v118, v182, v183
  v_cvt_pk_bf16_f32 v119, v214, v215
  s_add_u32 s30, s34, 4096
  buffer_store_dwordx4 v[116:119], v0, s[8:11], s30 offen offset:3072 sc1
  ds_write_b128 v252, v[116:119] offset:7168
  v_mov_b32 v248, 23
  ds_write_b32 v251, v248
  s_setprio 0
  ds_read_b32 v250, v254 offset:0
  s_waitcnt lgkmcnt(0)
  v_cmp_gt_u32 vcc, 3, v250
  s_cbranch_vccnz per_B_x5s
per_B_x5r:
  ds_read_b128 v[4:7], v0 offset:0
  ds_read_b128 v[8:11], v0 offset:1024
  ds_read_b128 v[12:15], v0 offset:2048
  ds_read_b128 v[16:19], v0 offset:3072
  ds_read_b128 v[20:23], v0 offset:4096
  ds_read_b128 v[24:27], v0 offset:5120
  ds_read_b128 v[176:179], v0 offset:6144
  ds_read_b128 v[208:211], v0 offset:7168
  ds_read_b128 v[180:183], v0 offset:8192
  ds_read_b128 v[212:215], v0 offset:9216
  ds_read_b128 v[244:247], v0 offset:10240
  s_waitcnt lgkmcnt(10)
  v_mfma_f32_16x16x32_bf16 v[88:91], v[52:55], v[4:7], 0
  v_mfma_f32_16x16x32_bf16 v[120:123], v[56:59], v[4:7], 0
  s_add_u32 s29, s22, 147456
  buffer_load_dwordx4 v[84:87], v0, s[8:11], s29 offen offset:0
  s_waitcnt lgkmcnt(9)
  v_mfma_f32_16x16x32_bf16 v[92:95], v[52:55], v[8:11], 0
  ds_read_b128 v[4:7], v0 offset:11264
  v_mfma_f32_16x16x32_bf16 v[124:127], v[56:59], v[8:11], 0
  buffer_load_dwordx4 v[216:219], v0, s[8:11], s29 offen offset:1024
  s_waitcnt lgkmcnt(9)
  v_mfma_f32_16x16x32_bf16 v[96:99], v[52:55], v[12:15], 0
  ds_read_b128 v[8:11], v0 offset:12288
  v_mfma_f32_16x16x32_bf16 v[128:131], v[56:59], v[12:15], 0
  s_add_u32 s28, s22, 184320
  buffer_load_dwordx4 v[220:223], v0, s[8:11], s28 offen offset:0
  s_waitcnt lgkmcnt(9)
  v_mfma_f32_16x16x32_bf16 v[100:103], v[52:55], v[16:19], 0
  ds_read_b128 v[12:15], v0 offset:13312
  v_mfma_f32_16x16x32_bf16 v[132:135], v[56:59], v[16:19], 0
  buffer_load_dwordx4 v[224:227], v0, s[8:11], s28 offen offset:1024
  s_waitcnt lgkmcnt(9)
  v_mfma_f32_16x16x32_bf16 v[104:107], v[52:55], v[20:23], 0
  ds_read_b128 v[16:19], v0 offset:14336
  v_mfma_f32_16x16x32_bf16 v[136:139], v[56:59], v[20:23], 0
  s_add_u32 s29, s22, 221184
  buffer_load_dwordx4 v[228:231], v0, s[8:11], s29 offen offset:0
  s_waitcnt lgkmcnt(9)
  v_mfma_f32_16x16x32_bf16 v[108:111], v[52:55], v[24:27], 0
  ds_read_b128 v[20:23], v0 offset:15360
  v_mfma_f32_16x16x32_bf16 v[140:143], v[56:59], v[24:27], 0
  buffer_load_dwordx4 v[232:235], v0, s[8:11], s29 offen offset:1024
  s_waitcnt lgkmcnt(9)
  v_mfma_f32_16x16x32_bf16 v[112:115], v[52:55], v[176:179], 0
  ds_read_b128 v[24:27], v0 offset:16384
  v_mfma_f32_16x16x32_bf16 v[144:147], v[56:59], v[176:179], 0
  s_add_u32 s28, s22, 258048
  buffer_load_dwordx4 v[236:239], v0, s[8:11], s28 offen offset:0
  s_waitcnt lgkmcnt(9)
  v_mfma_f32_16x16x32_bf16 v[116:119], v[52:55], v[208:211], 0
  ds_read_b128 v[176:179], v0 offset:17408
  v_mfma_f32_16x16x32_bf16 v[148:151], v[56:59], v[208:211], 0
  buffer_load_dwordx4 v[240:243], v0, s[8:11], s28 offen offset:1024
  s_waitcnt lgkmcnt(9)
  v_mfma_f32_16x16x32_bf16 v[88:91], v[60:63], v[180:183], v[88:91]
  ds_read_b128 v[208:211], v0 offset:18432
  v_mfma_f32_16x16x32_bf16 v[120:123], v[64:67], v[180:183], v[120:123]
  s_add_u32 s29, s32, 147456
  buffer_load_dwordx4 v[28:31], v0, s[8:11], s29 offen offset:0
  s_waitcnt lgkmcnt(9)
  v_mfma_f32_16x16x32_bf16 v[92:95], v[60:63], v[212:215], v[92:95]
  ds_read_b128 v[180:183], v0 offset:19456
  v_mfma_f32_16x16x32_bf16 v[124:127], v[64:67], v[212:215], v[124:127]
  buffer_load_dwordx4 v[32:35], v0, s[8:11], s29 offen offset:1024
  s_waitcnt lgkmcnt(9)
  v_mfma_f32_16x16x32_bf16 v[96:99], v[60:63], v[244:247], v[96:99]
  ds_read_b128 v[212:215], v0 offset:20480
  v_mfma_f32_16x16x32_bf16 v[128:131], v[64:67], v[244:247], v[128:131]
  s_waitcnt lgkmcnt(9)
  v_mfma_f32_16x16x32_bf16 v[100:103], v[60:63], v[4:7], v[100:103]
  ds_read_b128 v[244:247], v0 offset:21504
  v_mfma_f32_16x16x32_bf16 v[132:135], v[64:67], v[4:7], v[132:135]
  s_waitcnt lgkmcnt(9)
  v_mfma_f32_16x16x32_bf16 v[104:107], v[60:63], v[8:11], v[104:107]
  ds_read_b128 v[4:7], v0 offset:22528
  v_mfma_f32_16x16x32_bf16 v[136:139], v[64:67], v[8:11], v[136:139]
  s_waitcnt lgkmcnt(9)
  v_mfma_f32_16x16x32_bf16 v[108:111], v[60:63], v[12:15], v[108:111]
  ds_read_b128 v[8:11], v0 offset:23552
  v_mfma_f32_16x16x32_bf16 v[140:143], v[64:67], v[12:15], v[140:143]
  s_waitcnt vmcnt(10)
  v_mov_b32 v248, 0
  v_mov_b32 v249, s96
  buffer_store_dword v249, v248, s[8:11], s38 offen offset:4 sc1
  s_waitcnt lgkmcnt(9)
  v_mfma_f32_16x16x32_bf16 v[112:115], v[60:63], v[16:19], v[112:115]
  ds_read_b128 v[12:15], v0 offset:24576
  v_mfma_f32_16x16x32_bf16 v[144:147], v[64:67], v[16:19], v[144:147]
  s_waitcnt lgkmcnt(9)
  v_mfma_f32_16x16x32_bf16 v[116:119], v[60:63], v[20:23], v[116:119]
  ds_read_b128 v[16:19], v0 offset:25600
  v_mfma_f32_16x16x32_bf16 v[148:151], v[64:67], v[20:23], v[148:151]
  s_waitcnt lgkmcnt(9)
  v_mfma_f32_16x16x32_bf16 v[88:91], v[68:71], v[24:27], v[88:91]
  ds_read_b128 v[20:23], v0 offset:26624
  v_mfma_f32_16x16x32_bf16 v[120:123], v[72:75], v[24:27], v[120:123]
  s_add_u32 s28, s32, 184320
  buffer_load_dwordx4 v[36:39], v0, s[8:11], s28 offen offset:0
  s_waitcnt lgkmcnt(9)
  v_mfma_f32_16x16x32_bf16 v[92:95], v[68:71], v[176:179], v[92:95]
  ds_read_b128 v[24:27], v0 offset:27648
  v_mfma_f32_16x16x32_bf16 v[124:127], v[72:75], v[176:179], v[124:127]
  buffer_load_dwordx4 v[40:43], v0, s[8:11], s28 offen offset:1024
  s_waitcnt lgkmcnt(9)
  v_mfma_f32_16x16x32_bf16 v[96:99], v[68:71], v[208:211], v[96:99]
  ds_read_b128 v[176:179], v0 offset:28672
  v_mfma_f32_16x16x32_bf16 v[128:131], v[72:75], v[208:211], v[128:131]
  s_waitcnt lgkmcnt(9)
  v_mfma_f32_16x16x32_bf16 v[100:103], v[68:71], v[180:183], v[100:103]
  ds_read_b128 v[208:211], v0 offset:29696
  v_mfma_f32_16x16x32_bf16 v[132:135], v[72:75], v[180:183], v[132:135]
  s_waitcnt lgkmcnt(9)
  v_mfma_f32_16x16x32_bf16 v[104:107], v[68:71], v[212:215], v[104:107]
  ds_read_b128 v[180:183], v0 offset:30720
  v_mfma_f32_16x16x32_bf16 v[136:139], v[72:75], v[212:215], v[136:139]
  s_waitcnt lgkmcnt(9)
  v_mfma_f32_16x16x32_bf16 v[108:111], v[68:71], v[244:247], v[108:111]
  ds_read_b128 v[212:215], v0 offset:31744
  v_mfma_f32_16x16x32_bf16 v[140:143], v[72:75], v[244:247], v[140:143]
  s_waitcnt lgkmcnt(9)
  v_mfma_f32_16x16x32_bf16 v[112:115], v[68:71], v[4:7], v[112:115]
  ds_read_b128 v[244:247], v0 offset:32768
  v_mfma_f32_16x16x32_bf16 v[144:147], v[72:75], v[4:7], v[144:147]
  s_waitcnt lgkmcnt(9)
  v_mfma_f32_16x16x32_bf16 v[116:119], v[68:71], v[8:11], v[116:119]
  ds_read_b128 v[4:7], v0 offset:33792
  v_mfma_f32_16x16x32_bf16 v[148:151], v[72:75], v[8:11], v[148:151]
  s_waitcnt lgkmcnt(9)
  v_mfma_f32_16x16x32_bf16 v[88:91], v[152:155], v[12:15], v[88:91]
  ds_read_b128 v[8:11], v0 offset:34816
  v_mfma_f32_16x16x32_bf16 v[120:123], v[184:187], v[12:15], v[120:123]
  s_add_u32 s29, s32, 221184
  buffer_load_dwordx4 v[44:47], v0, s[8:11], s29 offen offset:0
  s_waitcnt lgkmcnt(9)
  v_mfma_f32_16x16x32_bf16 v[92:95], v[152:155], v[16:19], v[92:95]
  ds_read_b128 v[12:15], v0 offset:35840
  v_mfma_f32_16x16x32_bf16 v[124:127], v[184:187], v[16:19], v[124:127]
  buffer_load_dwordx4 v[48:51], v0, s[8:11], s29 offen offset:1024
  s_waitcnt lgkmcnt(9)
  v_mfma_f32_16x16x32_bf16 v[96:99], v[152:155], v[20:23], v[96:99]
  ds_read_b128 v[16:19], v0 offset:36864
  v_mfma_f32_16x16x32_bf16 v[128:131], v[184:187], v[20:23], v[128:131]
  s_waitcnt lgkmcnt(9)
  v_mfma_f32_16x16x32_bf16 v[100:103], v[152:155], v[24:27], v[100:103]
  ds_read_b128 v[20:23], v0 offset:37888
  v_mfma_f32_16x16x32_bf16 v[132:135], v[184:187], v[24:27], v[132:135]
  s_waitcnt lgkmcnt(9)
  v_mfma_f32_16x16x32_bf16 v[104:107], v[152:155], v[176:179], v[104:107]
  ds_read_b128 v[24:27], v0 offset:38912
  v_mfma_f32_16x16x32_bf16 v[136:139], v[184:187], v[176:179], v[136:139]
  s_waitcnt lgkmcnt(9)
  v_mfma_f32_16x16x32_bf16 v[108:111], v[152:155], v[208:211], v[108:111]
  ds_read_b128 v[176:179], v0 offset:39936
  ds_read_b32 v250, v254 offset:0
  v_mfma_f32_16x16x32_bf16 v[140:143], v[184:187], v[208:211], v[140:143]
  s_waitcnt lgkmcnt(10)
  v_mfma_f32_16x16x32_bf16 v[112:115], v[152:155], v[180:183], v[112:115]
  s_waitcnt lgkmcnt(0)
  v_cmp_gt_u32 vcc, 4, v250
  s_cbranch_vccnz per_B_x6s
per_B_x6r:
  ds_read_b128 v[208:211], v0 offset:40960
  v_mfma_f32_16x16x32_bf16 v[144:147], v[184:187], v[180:183], v[144:147]
  v_mfma_f32_16x16x32_bf16 v[116:119], v[152:155], v[212:215], v[116:119]
  ds_read_b128 v[180:183], v0 offset:49152
  v_mfma_f32_16x16x32_bf16 v[148:151], v[184:187], v[212:215], v[148:151]
  v_mfma_f32_16x16x32_bf16 v[88:91], v[156:159], v[244:247], v[88:91]
  ds_read_b128 v[212:215], v0 offset:57344
  v_mfma_f32_16x16x32_bf16 v[120:123], v[188:191], v[244:247], v[120:123]
  s_add_u32 s28, s32, 258048
  buffer_load_dwordx4 v[52:55], v0, s[8:11], s28 offen offset:0
  v_mfma_f32_16x16x32_bf16 v[92:95], v[156:159], v[4:7], v[92:95]
  ds_read_b128 v[244:247], v1 offset:0
  ds_read_b32 v250, v254 offset:0
  v_mfma_f32_16x16x32_bf16 v[124:127], v[188:191], v[4:7], v[124:127]
  buffer_load_dwordx4 v[56:59], v0, s[8:11], s28 offen offset:1024
  v_mfma_f32_16x16x32_bf16 v[96:99], v[156:159], v[8:11], v[96:99]
  s_waitcnt lgkmcnt(0)
  v_cmp_gt_u32 vcc, 5, v250
  s_cbranch_vccnz per_B_x7s
per_B_x7r:
  ds_read_b128 v[4:7], v1 offset:8192
  ds_read_b32 v250, v254 offset:1024
  v_mfma_f32_16x16x32_bf16 v[128:131], v[188:191], v[8:11], v[128:131]
  v_mfma_f32_16x16x32_bf16 v[100:103], v[156:159], v[12:15], v[100:103]
  s_waitcnt lgkmcnt(0)
  v_cmp_gt_u32 vcc, 22, v250
  s_cbranch_vccnz per_B_x8s
per_B_x8r:
  ds_read_b128 v[8:11], v1 offset:16384
  v_mfma_f32_16x16x32_bf16 v[132:135], v[188:191], v[12:15], v[132:135]
  v_mfma_f32_16x16x32_bf16 v[104:107], v[156:159], v[16:19], v[104:107]
  ds_read_b128 v[12:15], v1 offset:24576
  v_mfma_f32_16x16x32_bf16 v[136:139], v[188:191], v[16:19], v[136:139]
  v_mfma_f32_16x16x32_bf16 v[108:111], v[156:159], v[20:23], v[108:111]
  ds_read_b128 v[16:19], v1 offset:32768
  v_mfma_f32_16x16x32_bf16 v[140:143], v[188:191], v[20:23], v[140:143]
  v_mfma_f32_16x16x32_bf16 v[112:115], v[156:159], v[24:27], v[112:115]
  ds_read_b128 v[20:23], v1 offset:40960
  ds_read_b32 v250, v254 offset:0
  v_mfma_f32_16x16x32_bf16 v[144:147], v[188:191], v[24:27], v[144:147]
  v_mfma_f32_16x16x32_bf16 v[116:119], v[156:159], v[176:179], v[116:119]
  s_waitcnt lgkmcnt(0)
  v_cmp_gt_u32 vcc, 6, v250
  s_cbranch_vccnz per_B_x9s
per_B_x9r:
  ds_read_b128 v[24:27], v1 offset:49152
  v_mfma_f32_16x16x32_bf16 v[148:151], v[188:191], v[176:179], v[148:151]
  v_mfma_f32_16x16x32_bf16 v[88:91], v[160:163], v[208:211], v[88:91]
  ds_read_b128 v[176:179], v1 offset:57344
  v_mfma_f32_16x16x32_bf16 v[120:123], v[192:195], v[208:211], v[120:123]
  v_mfma_f32_16x16x32_bf16 v[88:91], v[164:167], v[180:183], v[88:91]
  ds_read_b128 v[208:211], v2 offset:0
  v_mfma_f32_16x16x32_bf16 v[120:123], v[196:199], v[180:183], v[120:123]
  v_mfma_f32_16x16x32_bf16 v[88:91], v[168:171], v[212:215], v[88:91]
  ds_read_b128 v[180:183], v2 offset:8192
  v_mfma_f32_16x16x32_bf16 v[120:123], v[200:203], v[212:215], v[120:123]
  v_mfma_f32_16x16x32_bf16 v[88:91], v[76:79], v[244:247], v[88:91]
  ds_read_b128 v[212:215], v0 offset:41984
  v_mfma_f32_16x16x32_bf16 v[120:123], v[172:175], v[244:247], v[120:123]
  v_mfma_f32_16x16x32_bf16 v[88:91], v[204:207], v[4:7], v[88:91]
  ds_read_b128 v[244:247], v0 offset:50176
  v_mfma_f32_16x16x32_bf16 v[120:123], v[80:83], v[4:7], v[120:123]
  s_waitcnt vmcnt(15)
  v_mfma_f32_16x16x32_bf16 v[88:91], v[84:87], v[8:11], v[88:91]
  ds_read_b128 v[4:7], v0 offset:58368
  v_mfma_f32_16x16x32_bf16 v[120:123], v[216:219], v[8:11], v[120:123]
  s_waitcnt vmcnt(13)
  v_mfma_f32_16x16x32_bf16 v[88:91], v[220:223], v[12:15], v[88:91]
  ds_read_b128 v[8:11], v1 offset:1024
  v_mfma_f32_16x16x32_bf16 v[120:123], v[224:227], v[12:15], v[120:123]
  s_waitcnt vmcnt(11)
  v_mfma_f32_16x16x32_bf16 v[88:91], v[228:231], v[16:19], v[88:91]
  ds_read_b128 v[12:15], v1 offset:9216
  v_mfma_f32_16x16x32_bf16 v[120:123], v[232:235], v[16:19], v[120:123]
  s_waitcnt vmcnt(9)
  v_mfma_f32_16x16x32_bf16 v[88:91], v[236:239], v[20:23], v[88:91]
  ds_read_b128 v[16:19], v1 offset:17408
  v_mfma_f32_16x16x32_bf16 v[120:123], v[240:243], v[20:23], v[120:123]
  s_waitcnt vmcnt(7) lgkmcnt(9)
  v_mfma_f32_16x16x32_bf16 v[88:91], v[28:31], v[24:27], v[88:91]
  ds_read_b128 v[20:23], v1 offset:25600
  v_mfma_f32_16x16x32_bf16 v[120:123], v[32:35], v[24:27], v[120:123]
  s_waitcnt vmcnt(4) lgkmcnt(9)
  v_mfma_f32_16x16x32_bf16 v[88:91], v[36:39], v[176:179], v[88:91]
  ds_read_b128 v[24:27], v1 offset:33792
  v_mfma_f32_16x16x32_bf16 v[120:123], v[40:43], v[176:179], v[120:123]
  s_waitcnt vmcnt(2) lgkmcnt(9)
  v_mfma_f32_16x16x32_bf16 v[88:91], v[44:47], v[208:211], v[88:91]
  ds_read_b128 v[176:179], v1 offset:41984
  v_mfma_f32_16x16x32_bf16 v[120:123], v[48:51], v[208:211], v[120:123]
  s_waitcnt vmcnt(0) lgkmcnt(9)
  v_mfma_f32_16x16x32_bf16 v[88:91], v[52:55], v[180:183], v[88:91]
  ds_read_b128 v[208:211], v1 offset:50176
  v_mfma_f32_16x16x32_bf16 v[120:123], v[56:59], v[180:183], v[120:123]
  s_waitcnt lgkmcnt(9)
  v_mfma_f32_16x16x32_bf16 v[92:95], v[160:163], v[212:215], v[92:95]
  ds_read_b128 v[180:183], v1 offset:58368
  v_mfma_f32_16x16x32_bf16 v[124:127], v[192:195], v[212:215], v[124:127]
  s_waitcnt lgkmcnt(9)
  v_mfma_f32_16x16x32_bf16 v[92:95], v[164:167], v[244:247], v[92:95]
  ds_read_b128 v[212:215], v2 offset:1024
  s_add_u32 s30, s26, 0
  v_cvt_pk_bf16_f32 v88, v88, v89
  v_cvt_pk_bf16_f32 v89, v90, v91
  v_cvt_pk_bf16_f32 v90, v120, v121
  v_cvt_pk_bf16_f32 v91, v122, v123
  buffer_store_dwordx4 v[88:91], v3, s[8:11], s30 offen sc1
  v_mfma_f32_16x16x32_bf16 v[124:127], v[196:199], v[244:247], v[124:127]
  s_waitcnt lgkmcnt(9)
  v_mfma_f32_16x16x32_bf16 v[92:95], v[168:171], v[4:7], v[92:95]
  ds_read_b128 v[244:247], v2 offset:9216
  v_mfma_f32_16x16x32_bf16 v[124:127], v[200:203], v[4:7], v[124:127]
  s_waitcnt lgkmcnt(9)
  v_mfma_f32_16x16x32_bf16 v[92:95], v[76:79], v[8:11], v[92:95]
  ds_read_b128 v[4:7], v0 offset:43008
  v_mfma_f32_16x16x32_bf16 v[124:127], v[172:175], v[8:11], v[124:127]
  s_waitcnt lgkmcnt(9)
  v_mfma_f32_16x16x32_bf16 v[92:95], v[204:207], v[12:15], v[92:95]
  ds_read_b128 v[8:11], v0 offset:51200
  v_mfma_f32_16x16x32_bf16 v[124:127], v[80:83], v[12:15], v[124:127]
  s_waitcnt lgkmcnt(9)
  v_mfma_f32_16x16x32_bf16 v[92:95], v[84:87], v[16:19], v[92:95]
  ds_read_b128 v[12:15], v0 offset:59392
  v_mfma_f32_16x16x32_bf16 v[124:127], v[216:219], v[16:19], v[124:127]
  s_waitcnt lgkmcnt(9)
  v_mfma_f32_16x16x32_bf16 v[92:95], v[220:223], v[20:23], v[92:95]
  ds_read_b128 v[16:19], v1 offset:2048
  v_mfma_f32_16x16x32_bf16 v[124:127], v[224:227], v[20:23], v[124:127]
  s_waitcnt lgkmcnt(9)
  v_mfma_f32_16x16x32_bf16 v[92:95], v[228:231], v[24:27], v[92:95]
  ds_read_b128 v[20:23], v1 offset:10240
  v_mfma_f32_16x16x32_bf16 v[124:127], v[232:235], v[24:27], v[124:127]
  s_waitcnt lgkmcnt(9)
  v_mfma_f32_16x16x32_bf16 v[92:95], v[236:239], v[176:179], v[92:95]
  ds_read_b128 v[24:27], v1 offset:18432
  v_mfma_f32_16x16x32_bf16 v[124:127], v[240:243], v[176:179], v[124:127]
  s_waitcnt lgkmcnt(9)
  v_mfma_f32_16x16x32_bf16 v[92:95], v[28:31], v[208:211], v[92:95]
  ds_read_b128 v[176:179], v1 offset:26624
  v_mfma_f32_16x16x32_bf16 v[124:127], v[32:35], v[208:211], v[124:127]
  s_waitcnt lgkmcnt(9)
  v_mfma_f32_16x16x32_bf16 v[92:95], v[36:39], v[180:183], v[92:95]
  ds_read_b128 v[208:211], v1 offset:34816
  v_mfma_f32_16x16x32_bf16 v[124:127], v[40:43], v[180:183], v[124:127]
  s_waitcnt lgkmcnt(9)
  v_mfma_f32_16x16x32_bf16 v[92:95], v[44:47], v[212:215], v[92:95]
  ds_read_b128 v[180:183], v1 offset:43008
  v_mfma_f32_16x16x32_bf16 v[124:127], v[48:51], v[212:215], v[124:127]
  s_waitcnt lgkmcnt(9)
  v_mfma_f32_16x16x32_bf16 v[92:95], v[52:55], v[244:247], v[92:95]
  ds_read_b128 v[212:215], v1 offset:51200
  v_mfma_f32_16x16x32_bf16 v[124:127], v[56:59], v[244:247], v[124:127]
  s_waitcnt lgkmcnt(9)
  v_mfma_f32_16x16x32_bf16 v[96:99], v[160:163], v[4:7], v[96:99]
  ds_read_b128 v[244:247], v1 offset:59392
  v_mfma_f32_16x16x32_bf16 v[128:131], v[192:195], v[4:7], v[128:131]
  s_waitcnt lgkmcnt(9)
  v_mfma_f32_16x16x32_bf16 v[96:99], v[164:167], v[8:11], v[96:99]
  ds_read_b128 v[4:7], v2 offset:2048
  s_add_u32 s30, s16, 18432
  v_cvt_pk_bf16_f32 v92, v92, v93
  v_cvt_pk_bf16_f32 v93, v94, v95
  v_cvt_pk_bf16_f32 v94, v124, v125
  v_cvt_pk_bf16_f32 v95, v126, v127
  buffer_store_dwordx4 v[92:95], v3, s[8:11], s30 offen sc1
  v_mfma_f32_16x16x32_bf16 v[128:131], v[196:199], v[8:11], v[128:131]
  s_waitcnt lgkmcnt(9)
  v_mfma_f32_16x16x32_bf16 v[96:99], v[168:171], v[12:15], v[96:99]
  ds_read_b128 v[8:11], v2 offset:10240
  v_mfma_f32_16x16x32_bf16 v[128:131], v[200:203], v[12:15], v[128:131]
  s_waitcnt lgkmcnt(9)
  v_mfma_f32_16x16x32_bf16 v[96:99], v[76:79], v[16:19], v[96:99]
  ds_read_b128 v[12:15], v0 offset:44032
  v_mfma_f32_16x16x32_bf16 v[128:131], v[172:175], v[16:19], v[128:131]
  s_waitcnt lgkmcnt(9)
  v_mfma_f32_16x16x32_bf16 v[96:99], v[204:207], v[20:23], v[96:99]
  ds_read_b128 v[16:19], v0 offset:52224
  v_mfma_f32_16x16x32_bf16 v[128:131], v[80:83], v[20:23], v[128:131]
  s_waitcnt lgkmcnt(9)
  v_mfma_f32_16x16x32_bf16 v[96:99], v[84:87], v[24:27], v[96:99]
  ds_read_b128 v[20:23], v0 offset:60416
  v_mfma_f32_16x16x32_bf16 v[128:131], v[216:219], v[24:27], v[128:131]
  s_waitcnt lgkmcnt(9)
  v_mfma_f32_16x16x32_bf16 v[96:99], v[220:223], v[176:179], v[96:99]
  ds_read_b128 v[24:27], v1 offset:3072
  v_mfma_f32_16x16x32_bf16 v[128:131], v[224:227], v[176:179], v[128:131]
  s_waitcnt lgkmcnt(9)
  v_mfma_f32_16x16x32_bf16 v[96:99], v[228:231], v[208:211], v[96:99]
  ds_read_b128 v[176:179], v1 offset:11264
  v_mfma_f32_16x16x32_bf16 v[128:131], v[232:235], v[208:211], v[128:131]
  s_waitcnt lgkmcnt(9)
  v_mfma_f32_16x16x32_bf16 v[96:99], v[236:239], v[180:183], v[96:99]
  ds_read_b128 v[208:211], v1 offset:19456
  v_mfma_f32_16x16x32_bf16 v[128:131], v[240:243], v[180:183], v[128:131]
  s_waitcnt lgkmcnt(9)
  v_mfma_f32_16x16x32_bf16 v[96:99], v[28:31], v[212:215], v[96:99]
  ds_read_b128 v[180:183], v1 offset:27648
  v_mfma_f32_16x16x32_bf16 v[128:131], v[32:35], v[212:215], v[128:131]
  s_waitcnt lgkmcnt(9)
  v_mfma_f32_16x16x32_bf16 v[96:99], v[36:39], v[244:247], v[96:99]
  ds_read_b128 v[212:215], v1 offset:35840
  v_mfma_f32_16x16x32_bf16 v[128:131], v[40:43], v[244:247], v[128:131]
  s_waitcnt lgkmcnt(9)
  v_mfma_f32_16x16x32_bf16 v[96:99], v[44:47], v[4:7], v[96:99]
  ds_read_b128 v[244:247], v1 offset:44032
  v_mfma_f32_16x16x32_bf16 v[128:131], v[48:51], v[4:7], v[128:131]
  s_waitcnt lgkmcnt(9)
  v_mfma_f32_16x16x32_bf16 v[96:99], v[52:55], v[8:11], v[96:99]
  ds_read_b128 v[4:7], v1 offset:52224
  v_mfma_f32_16x16x32_bf16 v[128:131], v[56:59], v[8:11], v[128:131]
  s_waitcnt lgkmcnt(9)
  v_mfma_f32_16x16x32_bf16 v[100:103], v[160:163], v[12:15], v[100:103]
  ds_read_b128 v[8:11], v1 offset:60416
  v_mfma_f32_16x16x32_bf16 v[132:135], v[192:195], v[12:15], v[132:135]
  s_waitcnt lgkmcnt(9)
  v_mfma_f32_16x16x32_bf16 v[100:103], v[164:167], v[16:19], v[100:103]
  ds_read_b128 v[12:15], v2 offset:3072
  s_add_u32 s30, s26, 36864
  v_cvt_pk_bf16_f32 v96, v96, v97
  v_cvt_pk_bf16_f32 v97, v98, v99
  v_cvt_pk_bf16_f32 v98, v128, v129
  v_cvt_pk_bf16_f32 v99, v130, v131
  buffer_store_dwordx4 v[96:99], v3, s[8:11], s30 offen sc1
  v_mfma_f32_16x16x32_bf16 v[132:135], v[196:199], v[16:19], v[132:135]
  s_waitcnt lgkmcnt(9)
  v_mfma_f32_16x16x32_bf16 v[100:103], v[168:171], v[20:23], v[100:103]
  ds_read_b128 v[16:19], v2 offset:11264
  v_mfma_f32_16x16x32_bf16 v[132:135], v[200:203], v[20:23], v[132:135]
  s_waitcnt lgkmcnt(9)
  v_mfma_f32_16x16x32_bf16 v[100:103], v[76:79], v[24:27], v[100:103]
  ds_read_b128 v[20:23], v0 offset:45056
  v_mfma_f32_16x16x32_bf16 v[132:135], v[172:175], v[24:27], v[132:135]
  s_waitcnt lgkmcnt(9)
  v_mfma_f32_16x16x32_bf16 v[100:103], v[204:207], v[176:179], v[100:103]
  ds_read_b128 v[24:27], v0 offset:53248
  v_mfma_f32_16x16x32_bf16 v[132:135], v[80:83], v[176:179], v[132:135]
  s_waitcnt lgkmcnt(9)
  v_mfma_f32_16x16x32_bf16 v[100:103], v[84:87], v[208:211], v[100:103]
  ds_read_b128 v[176:179], v0 offset:61440
  v_mfma_f32_16x16x32_bf16 v[132:135], v[216:219], v[208:211], v[132:135]
  s_waitcnt lgkmcnt(9)
  v_mfma_f32_16x16x32_bf16 v[100:103], v[220:223], v[180:183], v[100:103]
  ds_read_b128 v[208:211], v1 offset:4096
  v_mfma_f32_16x16x32_bf16 v[132:135], v[224:227], v[180:183], v[132:135]
  s_waitcnt lgkmcnt(9)
  v_mfma_f32_16x16x32_bf16 v[100:103], v[228:231], v[212:215], v[100:103]
  ds_read_b128 v[180:183], v1 offset:12288
  ds_read_b32 v250, v254 offset:1024
  v_mfma_f32_16x16x32_bf16 v[132:135], v[232:235], v[212:215], v[132:135]
  s_waitcnt lgkmcnt(10)
  v_mfma_f32_16x16x32_bf16 v[100:103], v[236:239], v[244:247], v[100:103]
  s_waitcnt lgkmcnt(0)
  v_cmp_gt_u32 vcc, 23, v250
  s_cbranch_vccnz per_B_x10s
per_B_x10r:
  ds_read_b128 v[212:215], v1 offset:20480
  v_mfma_f32_16x16x32_bf16 v[132:135], v[240:243], v[244:247], v[132:135]
  v_mfma_f32_16x16x32_bf16 v[100:103], v[28:31], v[4:7], v[100:103]
  ds_read_b128 v[244:247], v1 offset:28672
  v_mfma_f32_16x16x32_bf16 v[132:135], v[32:35], v[4:7], v[132:135]
  v_mfma_f32_16x16x32_bf16 v[100:103], v[36:39], v[8:11], v[100:103]
  ds_read_b128 v[4:7], v1 offset:36864
  v_mfma_f32_16x16x32_bf16 v[132:135], v[40:43], v[8:11], v[132:135]
  v_mfma_f32_16x16x32_bf16 v[100:103], v[44:47], v[12:15], v[100:103]
  ds_read_b128 v[8:11], v1 offset:45056
  ds_read_b32 v250, v254 offset:0
  v_mfma_f32_16x16x32_bf16 v[132:135], v[48:51], v[12:15], v[132:135]
  v_mfma_f32_16x16x32_bf16 v[100:103], v[52:55], v[16:19], v[100:103]
  s_waitcnt lgkmcnt(0)
  v_cmp_gt_u32 vcc, 7, v250
  s_cbranch_vccnz per_B_x11s
per_B_x11r:
  ds_read_b128 v[12:15], v1 offset:53248
  v_mfma_f32_16x16x32_bf16 v[132:135], v[56:59], v[16:19], v[132:135]
  v_mfma_f32_16x16x32_bf16 v[104:107], v[160:163], v[20:23], v[104:107]
  ds_read_b128 v[16:19], v1 offset:61440
  v_mfma_f32_16x16x32_bf16 v[136:139], v[192:195], v[20:23], v[136:139]
  v_mfma_f32_16x16x32_bf16 v[104:107], v[164:167], v[24:27], v[104:107]
  ds_read_b128 v[20:23], v2 offset:4096
  s_waitcnt vmcnt(2)
  v_mov_b32 v248, 24
  ds_write_b32 v251, v248
  s_add_u32 s30, s16, 55296
  v_cvt_pk_bf16_f32 v100, v100, v101
  v_cvt_pk_bf16_f32 v101, v102, v103
  v_cvt_pk_bf16_f32 v102, v132, v133
  v_cvt_pk_bf16_f32 v103, v134, v135
  buffer_store_dwordx4 v[100:103], v3, s[8:11], s30 offen sc1
  v_mfma_f32_16x16x32_bf16 v[136:139], v[196:199], v[24:27], v[136:139]
  v_mfma_f32_16x16x32_bf16 v[104:107], v[168:171], v[176:179], v[104:107]
  ds_read_b128 v[24:27], v2 offset:12288
  v_mfma_f32_16x16x32_bf16 v[136:139], v[200:203], v[176:179], v[136:139]
  v_mfma_f32_16x16x32_bf16 v[104:107], v[76:79], v[208:211], v[104:107]
  ds_read_b128 v[176:179], v0 offset:46080
  v_mfma_f32_16x16x32_bf16 v[136:139], v[172:175], v[208:211], v[136:139]
  v_mfma_f32_16x16x32_bf16 v[104:107], v[204:207], v[180:183], v[104:107]
  ds_read_b128 v[208:211], v0 offset:54272
  v_mfma_f32_16x16x32_bf16 v[136:139], v[80:83], v[180:183], v[136:139]
  v_mfma_f32_16x16x32_bf16 v[104:107], v[84:87], v[212:215], v[104:107]
  ds_read_b128 v[180:183], v0 offset:62464
  v_mfma_f32_16x16x32_bf16 v[136:139], v[216:219], v[212:215], v[136:139]
  v_mfma_f32_16x16x32_bf16 v[104:107], v[220:223], v[244:247], v[104:107]
  ds_read_b128 v[212:215], v1 offset:5120
  v_mfma_f32_16x16x32_bf16 v[136:139], v[224:227], v[244:247], v[136:139]
  v_mfma_f32_16x16x32_bf16 v[104:107], v[228:231], v[4:7], v[104:107]
  ds_read_b128 v[244:247], v1 offset:13312
  v_mfma_f32_16x16x32_bf16 v[136:139], v[232:235], v[4:7], v[136:139]
  v_mfma_f32_16x16x32_bf16 v[104:107], v[236:239], v[8:11], v[104:107]
  ds_read_b128 v[4:7], v1 offset:21504
  v_mfma_f32_16x16x32_bf16 v[136:139], v[240:243], v[8:11], v[136:139]
  s_waitcnt lgkmcnt(10)
  v_mfma_f32_16x16x32_bf16 v[104:107], v[28:31], v[12:15], v[104:107]
  ds_read_b128 v[8:11], v1 offset:29696
  v_mfma_f32_16x16x32_bf16 v[136:139], v[32:35], v[12:15], v[136:139]
  s_waitcnt lgkmcnt(10)
  v_mfma_f32_16x16x32_bf16 v[104:107], v[36:39], v[16:19], v[104:107]
  ds_read_b128 v[12:15], v1 offset:37888
  v_mfma_f32_16x16x32_bf16 v[136:139], v[40:43], v[16:19], v[136:139]
  s_waitcnt lgkmcnt(10)
  v_mfma_f32_16x16x32_bf16 v[104:107], v[44:47], v[20:23], v[104:107]
  ds_read_b128 v[16:19], v1 offset:46080
  v_mfma_f32_16x16x32_bf16 v[136:139], v[48:51], v[20:23], v[136:139]
  s_waitcnt lgkmcnt(9)
  v_mfma_f32_16x16x32_bf16 v[104:107], v[52:55], v[24:27], v[104:107]
  ds_read_b128 v[20:23], v1 offset:54272
  v_mfma_f32_16x16x32_bf16 v[136:139], v[56:59], v[24:27], v[136:139]
  s_waitcnt lgkmcnt(9)
  v_mfma_f32_16x16x32_bf16 v[108:111], v[160:163], v[176:179], v[108:111]
  ds_read_b128 v[24:27], v1 offset:62464
  v_mfma_f32_16x16x32_bf16 v[140:143], v[192:195], v[176:179], v[140:143]
  s_waitcnt lgkmcnt(9)
  v_mfma_f32_16x16x32_bf16 v[108:111], v[164:167], v[208:211], v[108:111]
  ds_read_b128 v[176:179], v2 offset:5120
  s_waitcnt vmcnt(2)
  v_mov_b32 v248, 25
  ds_write_b32 v251, v248
  s_add_u32 s30, s26, 73728
  v_cvt_pk_bf16_f32 v104, v104, v105
  v_cvt_pk_bf16_f32 v105, v106, v107
  v_cvt_pk_bf16_f32 v106, v136, v137
  v_cvt_pk_bf16_f32 v107, v138, v139
  buffer_store_dwordx4 v[104:107], v3, s[8:11], s30 offen sc1
  v_mfma_f32_16x16x32_bf16 v[140:143], v[196:199], v[208:211], v[140:143]
  s_waitcnt lgkmcnt(10)
  v_mfma_f32_16x16x32_bf16 v[108:111], v[168:171], v[180:183], v[108:111]
  ds_read_b128 v[208:211], v2 offset:13312
  v_mfma_f32_16x16x32_bf16 v[140:143], v[200:203], v[180:183], v[140:143]
  s_waitcnt lgkmcnt(10)
  v_mfma_f32_16x16x32_bf16 v[108:111], v[76:79], v[212:215], v[108:111]
  ds_read_b128 v[180:183], v0 offset:47104
  v_mfma_f32_16x16x32_bf16 v[140:143], v[172:175], v[212:215], v[140:143]
  s_waitcnt lgkmcnt(10)
  v_mfma_f32_16x16x32_bf16 v[108:111], v[204:207], v[244:247], v[108:111]
  ds_read_b128 v[212:215], v0 offset:55296
  v_mfma_f32_16x16x32_bf16 v[140:143], v[80:83], v[244:247], v[140:143]
  s_waitcnt lgkmcnt(10)
  v_mfma_f32_16x16x32_bf16 v[108:111], v[84:87], v[4:7], v[108:111]
  ds_read_b128 v[244:247], v0 offset:63488
  v_mfma_f32_16x16x32_bf16 v[140:143], v[216:219], v[4:7], v[140:143]
  s_waitcnt lgkmcnt(10)
  v_mfma_f32_16x16x32_bf16 v[108:111], v[220:223], v[8:11], v[108:111]
  ds_read_b128 v[4:7], v1 offset:6144
  v_mfma_f32_16x16x32_bf16 v[140:143], v[224:227], v[8:11], v[140:143]
  s_waitcnt lgkmcnt(10)
  v_mfma_f32_16x16x32_bf16 v[108:111], v[228:231], v[12:15], v[108:111]
  ds_read_b128 v[8:11], v1 offset:14336
  v_mfma_f32_16x16x32_bf16 v[140:143], v[232:235], v[12:15], v[140:143]
  s_waitcnt lgkmcnt(10)
  v_mfma_f32_16x16x32_bf16 v[108:111], v[236:239], v[16:19], v[108:111]
  ds_read_b128 v[12:15], v1 offset:22528
  v_mfma_f32_16x16x32_bf16 v[140:143], v[240:243], v[16:19], v[140:143]
  s_waitcnt lgkmcnt(10)
  v_mfma_f32_16x16x32_bf16 v[108:111], v[28:31], v[20:23], v[108:111]
  ds_read_b128 v[16:19], v1 offset:30720
  v_mfma_f32_16x16x32_bf16 v[140:143], v[32:35], v[20:23], v[140:143]
  s_waitcnt lgkmcnt(10)
  v_mfma_f32_16x16x32_bf16 v[108:111], v[36:39], v[24:27], v[108:111]
  ds_read_b128 v[20:23], v1 offset:38912
  v_mfma_f32_16x16x32_bf16 v[140:143], v[40:43], v[24:27], v[140:143]
  s_waitcnt lgkmcnt(10)
  v_mfma_f32_16x16x32_bf16 v[108:111], v[44:47], v[176:179], v[108:111]
  ds_read_b128 v[24:27], v1 offset:47104
  v_mfma_f32_16x16x32_bf16 v[140:143], v[48:51], v[176:179], v[140:143]
  s_waitcnt lgkmcnt(9)
  v_mfma_f32_16x16x32_bf16 v[108:111], v[52:55], v[208:211], v[108:111]
  ds_read_b128 v[176:179], v1 offset:55296
  v_mfma_f32_16x16x32_bf16 v[140:143], v[56:59], v[208:211], v[140:143]
  s_waitcnt lgkmcnt(9)
  v_mfma_f32_16x16x32_bf16 v[112:115], v[160:163], v[180:183], v[112:115]
  ds_read_b128 v[208:211], v1 offset:63488
  v_mfma_f32_16x16x32_bf16 v[144:147], v[192:195], v[180:183], v[144:147]
  s_waitcnt lgkmcnt(9)
  v_mfma_f32_16x16x32_bf16 v[112:115], v[164:167], v[212:215], v[112:115]
  ds_read_b128 v[180:183], v2 offset:6144
  s_waitcnt vmcnt(2)
  v_mov_b32 v248, 26
  ds_write_b32 v251, v248
  s_add_u32 s30, s16, 92160
  v_cvt_pk_bf16_f32 v108, v108, v109
  v_cvt_pk_bf16_f32 v109, v110, v111
  v_cvt_pk_bf16_f32 v110, v140, v141
  v_cvt_pk_bf16_f32 v111, v142, v143
  buffer_store_dwordx4 v[108:111], v3, s[8:11], s30 offen sc1
  v_mfma_f32_16x16x32_bf16 v[144:147], v[196:199], v[212:215], v[144:147]
  s_waitcnt lgkmcnt(10)
  v_mfma_f32_16x16x32_bf16 v[112:115], v[168:171], v[244:247], v[112:115]
  ds_read_b128 v[212:215], v2 offset:14336
  v_mfma_f32_16x16x32_bf16 v[144:147], v[200:203], v[244:247], v[144:147]
  s_waitcnt lgkmcnt(10)
  v_mfma_f32_16x16x32_bf16 v[112:115], v[76:79], v[4:7], v[112:115]
  ds_read_b128 v[244:247], v0 offset:48128
  v_mfma_f32_16x16x32_bf16 v[144:147], v[172:175], v[4:7], v[144:147]
  s_waitcnt lgkmcnt(10)
  v_mfma_f32_16x16x32_bf16 v[112:115], v[204:207], v[8:11], v[112:115]
  ds_read_b128 v[4:7], v0 offset:56320
  v_mfma_f32_16x16x32_bf16 v[144:147], v[80:83], v[8:11], v[144:147]
  s_waitcnt lgkmcnt(10)
  v_mfma_f32_16x16x32_bf16 v[112:115], v[84:87], v[12:15], v[112:115]
  ds_read_b128 v[8:11], v0 offset:64512
  v_mfma_f32_16x16x32_bf16 v[144:147], v[216:219], v[12:15], v[144:147]
  s_waitcnt lgkmcnt(10)
  v_mfma_f32_16x16x32_bf16 v[112:115], v[220:223], v[16:19], v[112:115]
  ds_read_b128 v[12:15], v1 offset:7168
  v_mfma_f32_16x16x32_bf16 v[144:147], v[224:227], v[16:19], v[144:147]
  s_waitcnt lgkmcnt(10)
  v_mfma_f32_16x16x32_bf16 v[112:115], v[228:231], v[20:23], v[112:115]
  ds_read_b128 v[16:19], v1 offset:15360
  v_mfma_f32_16x16x32_bf16 v[144:147], v[232:235], v[20:23], v[144:147]
  s_waitcnt lgkmcnt(10)
  v_mfma_f32_16x16x32_bf16 v[112:115], v[236:239], v[24:27], v[112:115]
  ds_read_b128 v[20:23], v1 offset:23552
  v_mfma_f32_16x16x32_bf16 v[144:147], v[240:243], v[24:27], v[144:147]
  s_waitcnt lgkmcnt(10)
  v_mfma_f32_16x16x32_bf16 v[112:115], v[28:31], v[176:179], v[112:115]
  ds_read_b128 v[24:27], v1 offset:31744
  v_mfma_f32_16x16x32_bf16 v[144:147], v[32:35], v[176:179], v[144:147]
  s_waitcnt lgkmcnt(10)
  v_mfma_f32_16x16x32_bf16 v[112:115], v[36:39], v[208:211], v[112:115]
  ds_read_b128 v[176:179], v1 offset:39936
  v_mfma_f32_16x16x32_bf16 v[144:147], v[40:43], v[208:211], v[144:147]
  s_waitcnt lgkmcnt(10)
  v_mfma_f32_16x16x32_bf16 v[112:115], v[44:47], v[180:183], v[112:115]
  ds_read_b128 v[208:211], v1 offset:48128
  v_mfma_f32_16x16x32_bf16 v[144:147], v[48:51], v[180:183], v[144:147]
  s_waitcnt lgkmcnt(9)
  v_mfma_f32_16x16x32_bf16 v[112:115], v[52:55], v[212:215], v[112:115]
  ds_read_b128 v[180:183], v1 offset:56320
  v_mfma_f32_16x16x32_bf16 v[144:147], v[56:59], v[212:215], v[144:147]
  s_waitcnt lgkmcnt(9)
  v_mfma_f32_16x16x32_bf16 v[116:119], v[160:163], v[244:247], v[116:119]
  ds_read_b128 v[212:215], v1 offset:64512
  v_mfma_f32_16x16x32_bf16 v[148:151], v[192:195], v[244:247], v[148:151]
  s_waitcnt lgkmcnt(9)
  v_mfma_f32_16x16x32_bf16 v[116:119], v[164:167], v[4:7], v[116:119]
  ds_read_b128 v[244:247], v2 offset:7168
  s_waitcnt vmcnt(2)
  v_mov_b32 v248, 27
  ds_write_b32 v251, v248
  s_add_u32 s30, s26, 110592
  v_cvt_pk_bf16_f32 v112, v112, v113
  v_cvt_pk_bf16_f32 v113, v114, v115
  v_cvt_pk_bf16_f32 v114, v144, v145
  v_cvt_pk_bf16_f32 v115, v146, v147
  buffer_store_dwordx4 v[112:115], v3, s[8:11], s30 offen sc1
  v_mfma_f32_16x16x32_bf16 v[148:151], v[196:199], v[4:7], v[148:151]
  s_waitcnt lgkmcnt(10)
  v_mfma_f32_16x16x32_bf16 v[116:119], v[168:171], v[8:11], v[116:119]
  ds_read_b128 v[4:7], v2 offset:15360
  v_mfma_f32_16x16x32_bf16 v[148:151], v[200:203], v[8:11], v[148:151]
  s_waitcnt lgkmcnt(10)
  v_mfma_f32_16x16x32_bf16 v[116:119], v[76:79], v[12:15], v[116:119]
  v_mfma_f32_16x16x32_bf16 v[148:151], v[172:175], v[12:15], v[148:151]
  s_waitcnt lgkmcnt(9)
  v_mfma_f32_16x16x32_bf16 v[116:119], v[204:207], v[16:19], v[116:119]
  v_mfma_f32_16x16x32_bf16 v[148:151], v[80:83], v[16:19], v[148:151]
  s_waitcnt lgkmcnt(8)
  v_mfma_f32_16x16x32_bf16 v[116:119], v[84:87], v[20:23], v[116:119]
  v_mfma_f32_16x16x32_bf16 v[148:151], v[216:219], v[20:23], v[148:151]
  s_waitcnt lgkmcnt(7)
  v_mfma_f32_16x16x32_bf16 v[116:119], v[220:223], v[24:27], v[116:119]
  v_mfma_f32_16x16x32_bf16 v[148:151], v[224:227], v[24:27], v[148:151]
  s_waitcnt lgkmcnt(6)
  v_mfma_f32_16x16x32_bf16 v[116:119], v[228:231], v[176:179], v[116:119]
  v_mfma_f32_16x16x32_bf16 v[148:151], v[232:235], v[176:179], v[148:151]
  s_waitcnt lgkmcnt(5)
  v_mfma_f32_16x16x32_bf16 v[116:119], v[236:239], v[208:211], v[116:119]
  v_mfma_f32_16x16x32_bf16 v[148:151], v[240:243], v[208:211], v[148:151]
  s_waitcnt lgkmcnt(4)
  v_mfma_f32_16x16x32_bf16 v[116:119], v[28:31], v[180:183], v[116:119]
  v_mfma_f32_16x16x32_bf16 v[148:151], v[32:35], v[180:183], v[148:151]
  s_waitcnt lgkmcnt(3)
  v_mfma_f32_16x16x32_bf16 v[116:119], v[36:39], v[212:215], v[116:119]
  v_mfma_f32_16x16x32_bf16 v[148:151], v[40:43], v[212:215], v[148:151]
  s_waitcnt lgkmcnt(2)
  v_mfma_f32_16x16x32_bf16 v[116:119], v[44:47], v[244:247], v[116:119]
  v_mfma_f32_16x16x32_bf16 v[148:151], v[48:51], v[244:247], v[148:151]
  s_waitcnt lgkmcnt(0)
  v_mfma_f32_16x16x32_bf16 v[116:119], v[52:55], v[4:7], v[116:119]
  v_mfma_f32_16x16x32_bf16 v[148:151], v[56:59], v[4:7], v[148:151]
  s_waitcnt vmcnt(2)
  v_mov_b32 v248, 28
  ds_write_b32 v251, v248
  s_add_u32 s30, s16, 129024
  s_nop 2
  v_cvt_pk_bf16_f32 v116, v116, v117
  v_cvt_pk_bf16_f32 v117, v118, v119
  v_cvt_pk_bf16_f32 v118, v148, v149
  v_cvt_pk_bf16_f32 v119, v150, v151
  buffer_store_dwordx4 v[116:119], v3, s[8:11], s30 offen sc1
  s_waitcnt vmcnt(2)
  v_mov_b32 v248, 29
  ds_write_b32 v251, v248
  s_waitcnt vmcnt(1)
  v_mov_b32 v248, 30
  ds_write_b32 v251, v248
  s_branch per_seam
per_wds:
  s_mov_b32 s31, 0x40000
per_wdl:
  buffer_load_dword v89, v88, s[8:11], s6 offen sc1
  s_waitcnt vmcnt(0)
  v_cmp_ne_u32 vcc, s96, v89
  s_cbranch_vccz per_wdr
  s_sleep 1
  s_sub_u32 s31, s31, 1
  s_cbranch_scc0 per_wdl
  s_branch per_wdr
per_B_x0s:
  s_mov_b32 s31, 0x100000
per_B_x0l:
  ds_read_b32 v250, v254 offset:0
  s_waitcnt lgkmcnt(0)
  v_cmp_gt_u32 vcc, 1, v250
  s_cbranch_vccz per_B_x0r
  s_sub_u32 s31, s31, 1
  s_cbranch_scc0 per_B_x0l
  s_branch per_B_x0r
per_B_x1s:
  s_mov_b32 s31, 0x100000
per_B_x1l:
  ds_read_b32 v250, v254 offset:1024
  s_waitcnt lgkmcnt(0)
  v_cmp_gt_u32 vcc, 4, v250
  s_cbranch_vccz per_B_x1r
  s_sub_u32 s31, s31, 1
  s_cbranch_scc0 per_B_x1l
  s_branch per_B_x1r
per_B_x2s:
  s_mov_b32 s31, 0x100000
per_B_x2l:
  ds_read_b32 v250, v254 offset:1024
  s_waitcnt lgkmcnt(0)
  v_cmp_gt_u32 vcc, 18, v250
  s_cbranch_vccz per_B_x2r
  s_sub_u32 s31, s31, 1
  s_cbranch_scc0 per_B_x2l
  s_branch per_B_x2r
per_B_x3s:
  s_mov_b32 s31, 0x100000
per_B_x3l:
  ds_read_b32 v250, v254 offset:0
  s_waitcnt lgkmcnt(0)
  v_cmp_gt_u32 vcc, 2, v250
  s_cbranch_vccz per_B_x3r
  s_sub_u32 s31, s31, 1
  s_cbranch_scc0 per_B_x3l
  s_branch per_B_x3r
per_B_x4s:
  s_mov_b32 s31, 0x100000
per_B_x4l:
  ds_read_b32 v250, v254 offset:1024
  s_waitcnt lgkmcnt(0)
  v_cmp_gt_u32 vcc, 21, v250
  s_cbranch_vccz per_B_x4r
  s_sub_u32 s31, s31, 1
  s_cbranch_scc0 per_B_x4l
  s_branch per_B_x4r
per_B_x5s:
  s_mov_b32 s31, 0x100000
per_B_x5l:
  s_sleep 1
  ds_read_b32 v250, v254 offset:0
  s_waitcnt lgkmcnt(0)
  v_cmp_gt_u32 vcc, 3, v250
  s_cbranch_vccz per_B_x5r
  s_sub_u32 s31, s31, 1
  s_cbranch_scc0 per_B_x5l
  s_branch per_B_x5r
per_B_x6s:
  s_mov_b32 s31, 0x100000
per_B_x6l:
  s_sleep 1
  ds_read_b32 v250, v254 offset:0
  s_waitcnt lgkmcnt(0)
  v_cmp_gt_u32 vcc, 4, v250
  s_cbranch_vccz per_B_x6r
  s_sub_u32 s31, s31, 1
  s_cbranch_scc0 per_B_x6l
  s_branch per_B_x6r
per_B_x7s:
  s_mov_b32 s31, 0x100000
per_B_x7l:
  s_sleep 1
  ds_read_b32 v250, v254 offset:0
  s_waitcnt lgkmcnt(0)
  v_cmp_gt_u32 vcc, 5, v250
  s_cbranch_vccz per_B_x7r
  s_sub_u32 s31, s31, 1
  s_cbranch_scc0 per_B_x7l
  s_branch per_B_x7r
per_B_x8s:
  s_mov_b32 s31, 0x100000
per_B_x8l:
  s_sleep 1
  ds_read_b32 v250, v254 offset:1024
  s_waitcnt lgkmcnt(0)
  v_cmp_gt_u32 vcc, 22, v250
  s_cbranch_vccz per_B_x8r
  s_sub_u32 s31, s31, 1
  s_cbranch_scc0 per_B_x8l
  s_branch per_B_x8r
per_B_x9s:
  s_mov_b32 s31, 0x100000
per_B_x9l:
  s_sleep 1
  ds_read_b32 v250, v254 offset:0
  s_waitcnt lgkmcnt(0)
  v_cmp_gt_u32 vcc, 6, v250
  s_cbranch_vccz per_B_x9r
  s_sub_u32 s31, s31, 1
  s_cbranch_scc0 per_B_x9l
  s_branch per_B_x9r
per_B_x10s:
  s_mov_b32 s31, 0x100000
per_B_x10l:
  s_sleep 1
  ds_read_b32 v250, v254 offset:1024
  s_waitcnt lgkmcnt(0)
  v_cmp_gt_u32 vcc, 23, v250
  s_cbranch_vccz per_B_x10r
  s_sub_u32 s31, s31, 1
  s_cbranch_scc0 per_B_x10l
  s_branch per_B_x10r
per_B_x11s:
  s_mov_b32 s31, 0x100000
per_B_x11l:
  s_sleep 1
  ds_read_b32 v250, v254 offset:0
  s_waitcnt lgkmcnt(0)
  v_cmp_gt_u32 vcc, 7, v250
  s_cbranch_vccz per_B_x11r
  s_sub_u32 s31, s31, 1
  s_cbranch_scc0 per_B_x11l
  s_branch per_B_x11r
per_end:
  s_endpgm
.section .rodata,"a"
.p2align 6
.amdhsa_kernel interleave_layers__ssm_conv_h3__geglu_ffn__prompt_kernel
  .amdhsa_next_free_vgpr 256
  .amdhsa_next_free_sgpr 102
  .amdhsa_accum_offset 256
  .amdhsa_group_segment_fixed_size 0
  .amdhsa_kernarg_size 104
  .amdhsa_user_sgpr_count 2
  .amdhsa_user_sgpr_kernarg_segment_ptr 1
  .amdhsa_system_sgpr_workgroup_id_x 1
.end_amdhsa_kernel
```
